```python
import torch

def _softmax(x, axis=-1):
    return torch.softmax(x, dim=axis)

def _gelu(x):
    return torch.nn.functional.gelu(x, approximate='tanh')

def _silu(x):
    return torch.nn.functional.silu(x)

def _sigmoid(x):
    return torch.sigmoid(x)

def _layernorm(x, axis=-1, eps=1e-05):
    m = x.mean(dim=axis, keepdim=True)
    v = x.var(dim=axis, keepdim=True, unbiased=False)
    return (x - m) / torch.sqrt(v + eps)

def _scatter_add(tgt, idx, src, axis=0):
    return tgt.clone().index_add_(axis, idx, src)

def _segment_sum(src, seg, n):
    out = torch.zeros((n,) + src.shape[1:], dtype=src.dtype)
    return out.index_add_(0, seg, src)

def _pad(x, pw):
    flat = tuple((v for pair in reversed(pw) for v in pair))
    return torch.nn.functional.pad(x, flat)
kernel_name = 'adaLN_cond__spectral_fnet__dense_activation_relu__prompt'

def setup_inputs():

    _w = lambda a: (lambda t: t.to(torch.bfloat16) if t.is_floating_point() else t)(torch.as_tensor(a))

    def _A_setup():
        B, S, D = (1, 2048, 640)
        ns = torch.arange(S)[:, None] * torch.arange(S)[None, :]
        nd = torch.arange(D)[:, None] * torch.arange(D)[None, :]
        Ws_re = torch.cos(-2.0 * torch.pi * ns / S).to(float)
        Ws_im = torch.sin(-2.0 * torch.pi * ns / S).to(float)
        Wd_re = torch.cos(-2.0 * torch.pi * nd / D).to(float)
        Wd_im = torch.sin(-2.0 * torch.pi * nd / D).to(float)
        return {'x': _w((lambda *s: torch.randn(*s, dtype=torch.bfloat16) * 0.1)(B, S, D)), 'dft_seq_re': _w(Ws_re), 'dft_seq_im': _w(Ws_im), 'dft_hid_re': _w(Wd_re), 'dft_hid_im': _w(Wd_im)}
    _A_in = _A_setup()

    def _B_setup():
        B, S, D, Dff = (1, 2048, 640, 1536)
        return {'x': _w((lambda *s: torch.randn(*s, dtype=torch.bfloat16) * 0.1)(B, S, D)), 'w1': _w((lambda *s: torch.randn(*s, dtype=torch.bfloat16) * 3.2)(D, Dff)), 'w2': _w((lambda *s: torch.randn(*s, dtype=torch.bfloat16) * 3.2)(Dff, D))}
    _B_in = _B_setup()
    return {'A_x': _A_in['x'], 'A_dft_seq_re': _A_in['dft_seq_re'], 'A_dft_seq_im': _A_in['dft_seq_im'], 'A_dft_hid_re': _A_in['dft_hid_re'], 'A_dft_hid_im': _A_in['dft_hid_im'], 'B_x': _B_in['x'], 'B_w1': _B_in['w1'], 'B_w2': _B_in['w2'], 'c': _w((lambda *s: torch.randn(*s, dtype=torch.bfloat16) * 0.4)(1, 640) * 8.0), 'w_mod': _w((lambda *s: torch.randn(*s, dtype=torch.bfloat16) * 0.4)(640, 6 * 640) * 640 ** (-0.5) * 8.0)}

def reference(A_x, A_dft_seq_re, A_dft_seq_im, A_dft_hid_re, A_dft_hid_im, B_x, B_w1, B_w2, c, w_mod):

    def _A_ref(x, dft_seq_re, dft_seq_im, dft_hid_re, dft_hid_im):
        a = torch.einsum('bsd,ed->bse', x, dft_hid_re)
        b = torch.einsum('bsd,ed->bse', x, dft_hid_im)
        y = torch.einsum('ts,bse->bte', dft_seq_re, a) - torch.einsum('ts,bse->bte', dft_seq_im, b)
        return y

    def _B_ref(x, w1, w2):
        h = torch.einsum('bsd,df->bsf', x, w1)
        zero = torch.zeros_like(h)
        h = torch.maximum(h, zero)
        return torch.einsum('bsf,fd->bsd', h, w2)
    x = A_x
    mod = (_silu(c) @ w_mod).reshape(c.shape[0], 6, 1, -1)
    sa, ca, ga, sb, cb, gb = (mod[:, 0].clone(), mod[:, 1].clone(), mod[:, 2].clone(), mod[:, 3].clone(), mod[:, 4].clone(), mod[:, 5].clone())
    h = _layernorm(x, axis=-1) * (1 + ca) + sa
    x = x + ga * _A_ref(h, A_dft_seq_re, A_dft_seq_im, A_dft_hid_re, A_dft_hid_im)
    h = _layernorm(x, axis=-1) * (1 + cb) + sb
    x = x + gb * _B_ref(h, B_w1, B_w2)
    return x
```

```asm
; @launch kernel=prep_kernel grid=(416,1,1) block=(256,1,1) lds=10240
; @launch kernel=gemma_kernel grid=(256,1,1) block=(512,1,1) lds=163840
; @launch kernel=gemmb_kernel grid=(256,1,1) block=(512,1,1) lds=159744
; @launch kernel=ln2_kernel grid=(736,1,1) block=(256,1,1) lds=10240
; @launch kernel=gemmc_kernel grid=(256,1,1) block=(512,1,1) lds=143360
; @launch kernel=gemmd_kernel grid=(256,1,1) block=(512,1,1) lds=147456
.amdgcn_target "amdgcn-amd-amdhsa--gfx950"
.text
.globl prep_kernel
.p2align 8
.type prep_kernel,@function
prep_kernel:
    s_cmp_ge_u32 s2, 416
    s_cbranch_scc1 prep_kernel_end
    s_cmp_lt_u32 s2, 408
    s_cbranch_scc1 prep_kernel_nocp
    s_getpc_b64 s[4:5]
prep_kernel_pcref:
    s_sub_u32 s4, s4, prep_kernel_pcref - prep_kernel
    s_subb_u32 s5, s5, 0
    v_lshlrev_b32 v1, 4, v0
    s_mov_b32 s6, code_end_label - prep_kernel - 16
    v_min_u32 v2, s6, v1
    global_load_dwordx4 v[4:7], v2, s[4:5] offset:0
    v_add_u32 v1, 0x1000, v1
    v_min_u32 v2, s6, v1
    global_load_dwordx4 v[8:11], v2, s[4:5] offset:0
    v_add_u32 v1, 0x1000, v1
    v_min_u32 v2, s6, v1
    global_load_dwordx4 v[12:15], v2, s[4:5] offset:0
    v_add_u32 v1, 0x1000, v1
    v_min_u32 v2, s6, v1
    global_load_dwordx4 v[16:19], v2, s[4:5] offset:0
    v_add_u32 v1, 0x1000, v1
    v_min_u32 v2, s6, v1
    global_load_dwordx4 v[20:23], v2, s[4:5] offset:0
    v_add_u32 v1, 0x1000, v1
    v_min_u32 v2, s6, v1
    global_load_dwordx4 v[24:27], v2, s[4:5] offset:0
    v_add_u32 v1, 0x1000, v1
    v_min_u32 v2, s6, v1
    global_load_dwordx4 v[28:31], v2, s[4:5] offset:0
    v_add_u32 v1, 0x1000, v1
    v_min_u32 v2, s6, v1
    global_load_dwordx4 v[32:35], v2, s[4:5] offset:0
    v_add_u32 v1, 0x1000, v1
    v_min_u32 v2, s6, v1
    global_load_dwordx4 v[36:39], v2, s[4:5] offset:0
    v_add_u32 v1, 0x1000, v1
    v_min_u32 v2, s6, v1
    global_load_dwordx4 v[40:43], v2, s[4:5] offset:0
    v_add_u32 v1, 0x1000, v1
    v_min_u32 v2, s6, v1
    global_load_dwordx4 v[44:47], v2, s[4:5] offset:0
    v_add_u32 v1, 0x1000, v1
    v_min_u32 v2, s6, v1
    global_load_dwordx4 v[48:51], v2, s[4:5] offset:0
    v_add_u32 v1, 0x1000, v1
    s_endpgm
prep_kernel_nocp:
    s_cmp_ge_u32 s2, 152
    s_cbranch_scc1 prep_kernel_ln
    s_cmp_ge_u32 s2, 146
    s_cbranch_scc1 prep_kernel_end
    s_cmp_ge_u32 s2, 120
    s_cbranch_scc1 prep_kernel_pf
    s_load_dwordx2 s[4:5], s[0:1], 96
    s_load_dwordx4 s[32:35], s[0:1], 64
    s_waitcnt lgkmcnt(0)
    s_and_b32 s6, s2, 7
    s_mul_i32 s6, s6, 15
    s_lshr_b32 s7, s2, 3
    s_add_u32 s6, s6, s7
    s_mov_b32 s8, s34
    s_mov_b32 s9, s35
    s_mov_b32 s10, 4915200
    s_mov_b32 s11, 0x00020000
    s_mov_b32 s12, s32
    s_mov_b32 s13, s33
    s_mov_b32 s14, 1280
    s_mov_b32 s15, 0x00020000
    s_mov_b32 s16, s4
    s_mov_b32 s17, s5
    s_mov_b32 s18, 7680
    s_mov_b32 s19, 0x00020000
    v_lshrrev_b32 v1, 2, v0
    v_and_b32 v2, 3, v0
    s_movk_i32 s20, 7680
    v_mul_lo_u32 v3, v1, s20
    v_lshl_add_u32 v3, v2, 4, v3
    s_lshl_b32 s21, s6, 6
    v_add_u32 v3, s21, v3
    v_lshlrev_b32 v4, 1, v1
    buffer_load_ushort v10, v4, s[12:15], 0 offen offset:0
    buffer_load_ushort v11, v4, s[12:15], 0 offen offset:128
    buffer_load_ushort v12, v4, s[12:15], 0 offen offset:256
    buffer_load_ushort v13, v4, s[12:15], 0 offen offset:384
    buffer_load_ushort v14, v4, s[12:15], 0 offen offset:512
    buffer_load_ushort v15, v4, s[12:15], 0 offen offset:640
    buffer_load_ushort v16, v4, s[12:15], 0 offen offset:768
    buffer_load_ushort v17, v4, s[12:15], 0 offen offset:896
    buffer_load_ushort v18, v4, s[12:15], 0 offen offset:1024
    buffer_load_ushort v19, v4, s[12:15], 0 offen offset:1152
    s_mov_b32 s22, 0
    buffer_load_dwordx4 v[20:23], v3, s[8:11], s22 offen
    s_mov_b32 s22, 491520
    buffer_load_dwordx4 v[24:27], v3, s[8:11], s22 offen
    s_mov_b32 s22, 983040
    buffer_load_dwordx4 v[28:31], v3, s[8:11], s22 offen
    s_mov_b32 s22, 1474560
    buffer_load_dwordx4 v[32:35], v3, s[8:11], s22 offen
    s_mov_b32 s22, 1966080
    buffer_load_dwordx4 v[36:39], v3, s[8:11], s22 offen
    s_mov_b32 s22, 2457600
    buffer_load_dwordx4 v[40:43], v3, s[8:11], s22 offen
    s_mov_b32 s22, 2949120
    buffer_load_dwordx4 v[44:47], v3, s[8:11], s22 offen
    s_mov_b32 s22, 3440640
    buffer_load_dwordx4 v[48:51], v3, s[8:11], s22 offen
    s_mov_b32 s22, 3932160
    buffer_load_dwordx4 v[52:55], v3, s[8:11], s22 offen
    s_mov_b32 s22, 4423680
    buffer_load_dwordx4 v[56:59], v3, s[8:11], s22 offen
    v_mov_b32 v60, 0
    v_mov_b32 v61, 0
    v_mov_b32 v62, 0
    v_mov_b32 v63, 0
    v_mov_b32 v64, 0
    v_mov_b32 v65, 0
    v_mov_b32 v66, 0
    v_mov_b32 v67, 0
    s_waitcnt vmcnt(10)
    s_mov_b32 s23, 0xbfb8aa3b
    s_mov_b32 s24, 0xb2a57060
    s_mov_b32 s25, 0x3f317218
    s_mov_b32 s26, 0x42fc0000
    v_lshlrev_b32 v10, 16, v10
    v_mul_f32 v70, s23, v10
    v_fma_f32 v71, v10, s23, -v70
    v_fma_f32 v71, v10, s24, v71
    v_min_f32 v70, s26, v70
    v_exp_f32 v70, v70
    v_mul_f32 v71, s25, v71
    v_fma_f32 v70, v70, v71, v70
    v_add_f32 v70, 1.0, v70
    v_rcp_f32 v71, v70
    s_nop 0
    v_fma_f32 v68, -v70, v71, 1.0
    v_fma_f32 v71, v68, v71, v71
    v_mul_f32 v68, v10, v71
    v_fma_f32 v69, -v70, v68, v10
    v_fma_f32 v70, v69, v71, v68
    v_cvt_pk_bf16_f32 v70, v70, v70
    v_lshlrev_b32 v10, 16, v70
    v_lshlrev_b32 v11, 16, v11
    v_mul_f32 v70, s23, v11
    v_fma_f32 v71, v11, s23, -v70
    v_fma_f32 v71, v11, s24, v71
    v_min_f32 v70, s26, v70
    v_exp_f32 v70, v70
    v_mul_f32 v71, s25, v71
    v_fma_f32 v70, v70, v71, v70
    v_add_f32 v70, 1.0, v70
    v_rcp_f32 v71, v70
    s_nop 0
    v_fma_f32 v68, -v70, v71, 1.0
    v_fma_f32 v71, v68, v71, v71
    v_mul_f32 v68, v11, v71
    v_fma_f32 v69, -v70, v68, v11
    v_fma_f32 v70, v69, v71, v68
    v_cvt_pk_bf16_f32 v70, v70, v70
    v_lshlrev_b32 v11, 16, v70
    v_lshlrev_b32 v12, 16, v12
    v_mul_f32 v70, s23, v12
    v_fma_f32 v71, v12, s23, -v70
    v_fma_f32 v71, v12, s24, v71
    v_min_f32 v70, s26, v70
    v_exp_f32 v70, v70
    v_mul_f32 v71, s25, v71
    v_fma_f32 v70, v70, v71, v70
    v_add_f32 v70, 1.0, v70
    v_rcp_f32 v71, v70
    s_nop 0
    v_fma_f32 v68, -v70, v71, 1.0
    v_fma_f32 v71, v68, v71, v71
    v_mul_f32 v68, v12, v71
    v_fma_f32 v69, -v70, v68, v12
    v_fma_f32 v70, v69, v71, v68
    v_cvt_pk_bf16_f32 v70, v70, v70
    v_lshlrev_b32 v12, 16, v70
    v_lshlrev_b32 v13, 16, v13
    v_mul_f32 v70, s23, v13
    v_fma_f32 v71, v13, s23, -v70
    v_fma_f32 v71, v13, s24, v71
    v_min_f32 v70, s26, v70
    v_exp_f32 v70, v70
    v_mul_f32 v71, s25, v71
    v_fma_f32 v70, v70, v71, v70
    v_add_f32 v70, 1.0, v70
    v_rcp_f32 v71, v70
    s_nop 0
    v_fma_f32 v68, -v70, v71, 1.0
    v_fma_f32 v71, v68, v71, v71
    v_mul_f32 v68, v13, v71
    v_fma_f32 v69, -v70, v68, v13
    v_fma_f32 v70, v69, v71, v68
    v_cvt_pk_bf16_f32 v70, v70, v70
    v_lshlrev_b32 v13, 16, v70
    v_lshlrev_b32 v14, 16, v14
    v_mul_f32 v70, s23, v14
    v_fma_f32 v71, v14, s23, -v70
    v_fma_f32 v71, v14, s24, v71
    v_min_f32 v70, s26, v70
    v_exp_f32 v70, v70
    v_mul_f32 v71, s25, v71
    v_fma_f32 v70, v70, v71, v70
    v_add_f32 v70, 1.0, v70
    v_rcp_f32 v71, v70
    s_nop 0
    v_fma_f32 v68, -v70, v71, 1.0
    v_fma_f32 v71, v68, v71, v71
    v_mul_f32 v68, v14, v71
    v_fma_f32 v69, -v70, v68, v14
    v_fma_f32 v70, v69, v71, v68
    v_cvt_pk_bf16_f32 v70, v70, v70
    v_lshlrev_b32 v14, 16, v70
    v_lshlrev_b32 v15, 16, v15
    v_mul_f32 v70, s23, v15
    v_fma_f32 v71, v15, s23, -v70
    v_fma_f32 v71, v15, s24, v71
    v_min_f32 v70, s26, v70
    v_exp_f32 v70, v70
    v_mul_f32 v71, s25, v71
    v_fma_f32 v70, v70, v71, v70
    v_add_f32 v70, 1.0, v70
    v_rcp_f32 v71, v70
    s_nop 0
    v_fma_f32 v68, -v70, v71, 1.0
    v_fma_f32 v71, v68, v71, v71
    v_mul_f32 v68, v15, v71
    v_fma_f32 v69, -v70, v68, v15
    v_fma_f32 v70, v69, v71, v68
    v_cvt_pk_bf16_f32 v70, v70, v70
    v_lshlrev_b32 v15, 16, v70
    v_lshlrev_b32 v16, 16, v16
    v_mul_f32 v70, s23, v16
    v_fma_f32 v71, v16, s23, -v70
    v_fma_f32 v71, v16, s24, v71
    v_min_f32 v70, s26, v70
    v_exp_f32 v70, v70
    v_mul_f32 v71, s25, v71
    v_fma_f32 v70, v70, v71, v70
    v_add_f32 v70, 1.0, v70
    v_rcp_f32 v71, v70
    s_nop 0
    v_fma_f32 v68, -v70, v71, 1.0
    v_fma_f32 v71, v68, v71, v71
    v_mul_f32 v68, v16, v71
    v_fma_f32 v69, -v70, v68, v16
    v_fma_f32 v70, v69, v71, v68
    v_cvt_pk_bf16_f32 v70, v70, v70
    v_lshlrev_b32 v16, 16, v70
    v_lshlrev_b32 v17, 16, v17
    v_mul_f32 v70, s23, v17
    v_fma_f32 v71, v17, s23, -v70
    v_fma_f32 v71, v17, s24, v71
    v_min_f32 v70, s26, v70
    v_exp_f32 v70, v70
    v_mul_f32 v71, s25, v71
    v_fma_f32 v70, v70, v71, v70
    v_add_f32 v70, 1.0, v70
    v_rcp_f32 v71, v70
    s_nop 0
    v_fma_f32 v68, -v70, v71, 1.0
    v_fma_f32 v71, v68, v71, v71
    v_mul_f32 v68, v17, v71
    v_fma_f32 v69, -v70, v68, v17
    v_fma_f32 v70, v69, v71, v68
    v_cvt_pk_bf16_f32 v70, v70, v70
    v_lshlrev_b32 v17, 16, v70
    v_lshlrev_b32 v18, 16, v18
    v_mul_f32 v70, s23, v18
    v_fma_f32 v71, v18, s23, -v70
    v_fma_f32 v71, v18, s24, v71
    v_min_f32 v70, s26, v70
    v_exp_f32 v70, v70
    v_mul_f32 v71, s25, v71
    v_fma_f32 v70, v70, v71, v70
    v_add_f32 v70, 1.0, v70
    v_rcp_f32 v71, v70
    s_nop 0
    v_fma_f32 v68, -v70, v71, 1.0
    v_fma_f32 v71, v68, v71, v71
    v_mul_f32 v68, v18, v71
    v_fma_f32 v69, -v70, v68, v18
    v_fma_f32 v70, v69, v71, v68
    v_cvt_pk_bf16_f32 v70, v70, v70
    v_lshlrev_b32 v18, 16, v70
    v_lshlrev_b32 v19, 16, v19
    v_mul_f32 v70, s23, v19
    v_fma_f32 v71, v19, s23, -v70
    v_fma_f32 v71, v19, s24, v71
    v_min_f32 v70, s26, v70
    v_exp_f32 v70, v70
    v_mul_f32 v71, s25, v71
    v_fma_f32 v70, v70, v71, v70
    v_add_f32 v70, 1.0, v70
    v_rcp_f32 v71, v70
    s_nop 0
    v_fma_f32 v68, -v70, v71, 1.0
    v_fma_f32 v71, v68, v71, v71
    v_mul_f32 v68, v19, v71
    v_fma_f32 v69, -v70, v68, v19
    v_fma_f32 v70, v69, v71, v68
    v_cvt_pk_bf16_f32 v70, v70, v70
    v_lshlrev_b32 v19, 16, v70
    s_waitcnt vmcnt(9)
    v_lshlrev_b32 v70, 16, v20
    v_and_b32 v71, 0xffff0000, v20
    v_fmac_f32 v60, v10, v70
    v_fmac_f32 v61, v10, v71
    v_lshlrev_b32 v70, 16, v21
    v_and_b32 v71, 0xffff0000, v21
    v_fmac_f32 v62, v10, v70
    v_fmac_f32 v63, v10, v71
    v_lshlrev_b32 v70, 16, v22
    v_and_b32 v71, 0xffff0000, v22
    v_fmac_f32 v64, v10, v70
    v_fmac_f32 v65, v10, v71
    v_lshlrev_b32 v70, 16, v23
    v_and_b32 v71, 0xffff0000, v23
    v_fmac_f32 v66, v10, v70
    v_fmac_f32 v67, v10, v71
    s_waitcnt vmcnt(8)
    v_lshlrev_b32 v70, 16, v24
    v_and_b32 v71, 0xffff0000, v24
    v_fmac_f32 v60, v11, v70
    v_fmac_f32 v61, v11, v71
    v_lshlrev_b32 v70, 16, v25
    v_and_b32 v71, 0xffff0000, v25
    v_fmac_f32 v62, v11, v70
    v_fmac_f32 v63, v11, v71
    v_lshlrev_b32 v70, 16, v26
    v_and_b32 v71, 0xffff0000, v26
    v_fmac_f32 v64, v11, v70
    v_fmac_f32 v65, v11, v71
    v_lshlrev_b32 v70, 16, v27
    v_and_b32 v71, 0xffff0000, v27
    v_fmac_f32 v66, v11, v70
    v_fmac_f32 v67, v11, v71
    s_waitcnt vmcnt(7)
    v_lshlrev_b32 v70, 16, v28
    v_and_b32 v71, 0xffff0000, v28
    v_fmac_f32 v60, v12, v70
    v_fmac_f32 v61, v12, v71
    v_lshlrev_b32 v70, 16, v29
    v_and_b32 v71, 0xffff0000, v29
    v_fmac_f32 v62, v12, v70
    v_fmac_f32 v63, v12, v71
    v_lshlrev_b32 v70, 16, v30
    v_and_b32 v71, 0xffff0000, v30
    v_fmac_f32 v64, v12, v70
    v_fmac_f32 v65, v12, v71
    v_lshlrev_b32 v70, 16, v31
    v_and_b32 v71, 0xffff0000, v31
    v_fmac_f32 v66, v12, v70
    v_fmac_f32 v67, v12, v71
    s_waitcnt vmcnt(6)
    v_lshlrev_b32 v70, 16, v32
    v_and_b32 v71, 0xffff0000, v32
    v_fmac_f32 v60, v13, v70
    v_fmac_f32 v61, v13, v71
    v_lshlrev_b32 v70, 16, v33
    v_and_b32 v71, 0xffff0000, v33
    v_fmac_f32 v62, v13, v70
    v_fmac_f32 v63, v13, v71
    v_lshlrev_b32 v70, 16, v34
    v_and_b32 v71, 0xffff0000, v34
    v_fmac_f32 v64, v13, v70
    v_fmac_f32 v65, v13, v71
    v_lshlrev_b32 v70, 16, v35
    v_and_b32 v71, 0xffff0000, v35
    v_fmac_f32 v66, v13, v70
    v_fmac_f32 v67, v13, v71
    s_waitcnt vmcnt(5)
    v_lshlrev_b32 v70, 16, v36
    v_and_b32 v71, 0xffff0000, v36
    v_fmac_f32 v60, v14, v70
    v_fmac_f32 v61, v14, v71
    v_lshlrev_b32 v70, 16, v37
    v_and_b32 v71, 0xffff0000, v37
    v_fmac_f32 v62, v14, v70
    v_fmac_f32 v63, v14, v71
    v_lshlrev_b32 v70, 16, v38
    v_and_b32 v71, 0xffff0000, v38
    v_fmac_f32 v64, v14, v70
    v_fmac_f32 v65, v14, v71
    v_lshlrev_b32 v70, 16, v39
    v_and_b32 v71, 0xffff0000, v39
    v_fmac_f32 v66, v14, v70
    v_fmac_f32 v67, v14, v71
    s_waitcnt vmcnt(4)
    v_lshlrev_b32 v70, 16, v40
    v_and_b32 v71, 0xffff0000, v40
    v_fmac_f32 v60, v15, v70
    v_fmac_f32 v61, v15, v71
    v_lshlrev_b32 v70, 16, v41
    v_and_b32 v71, 0xffff0000, v41
    v_fmac_f32 v62, v15, v70
    v_fmac_f32 v63, v15, v71
    v_lshlrev_b32 v70, 16, v42
    v_and_b32 v71, 0xffff0000, v42
    v_fmac_f32 v64, v15, v70
    v_fmac_f32 v65, v15, v71
    v_lshlrev_b32 v70, 16, v43
    v_and_b32 v71, 0xffff0000, v43
    v_fmac_f32 v66, v15, v70
    v_fmac_f32 v67, v15, v71
    s_waitcnt vmcnt(3)
    v_lshlrev_b32 v70, 16, v44
    v_and_b32 v71, 0xffff0000, v44
    v_fmac_f32 v60, v16, v70
    v_fmac_f32 v61, v16, v71
    v_lshlrev_b32 v70, 16, v45
    v_and_b32 v71, 0xffff0000, v45
    v_fmac_f32 v62, v16, v70
    v_fmac_f32 v63, v16, v71
    v_lshlrev_b32 v70, 16, v46
    v_and_b32 v71, 0xffff0000, v46
    v_fmac_f32 v64, v16, v70
    v_fmac_f32 v65, v16, v71
    v_lshlrev_b32 v70, 16, v47
    v_and_b32 v71, 0xffff0000, v47
    v_fmac_f32 v66, v16, v70
    v_fmac_f32 v67, v16, v71
    s_waitcnt vmcnt(2)
    v_lshlrev_b32 v70, 16, v48
    v_and_b32 v71, 0xffff0000, v48
    v_fmac_f32 v60, v17, v70
    v_fmac_f32 v61, v17, v71
    v_lshlrev_b32 v70, 16, v49
    v_and_b32 v71, 0xffff0000, v49
    v_fmac_f32 v62, v17, v70
    v_fmac_f32 v63, v17, v71
    v_lshlrev_b32 v70, 16, v50
    v_and_b32 v71, 0xffff0000, v50
    v_fmac_f32 v64, v17, v70
    v_fmac_f32 v65, v17, v71
    v_lshlrev_b32 v70, 16, v51
    v_and_b32 v71, 0xffff0000, v51
    v_fmac_f32 v66, v17, v70
    v_fmac_f32 v67, v17, v71
    s_waitcnt vmcnt(1)
    v_lshlrev_b32 v70, 16, v52
    v_and_b32 v71, 0xffff0000, v52
    v_fmac_f32 v60, v18, v70
    v_fmac_f32 v61, v18, v71
    v_lshlrev_b32 v70, 16, v53
    v_and_b32 v71, 0xffff0000, v53
    v_fmac_f32 v62, v18, v70
    v_fmac_f32 v63, v18, v71
    v_lshlrev_b32 v70, 16, v54
    v_and_b32 v71, 0xffff0000, v54
    v_fmac_f32 v64, v18, v70
    v_fmac_f32 v65, v18, v71
    v_lshlrev_b32 v70, 16, v55
    v_and_b32 v71, 0xffff0000, v55
    v_fmac_f32 v66, v18, v70
    v_fmac_f32 v67, v18, v71
    s_waitcnt vmcnt(0)
    v_lshlrev_b32 v70, 16, v56
    v_and_b32 v71, 0xffff0000, v56
    v_fmac_f32 v60, v19, v70
    v_fmac_f32 v61, v19, v71
    v_lshlrev_b32 v70, 16, v57
    v_and_b32 v71, 0xffff0000, v57
    v_fmac_f32 v62, v19, v70
    v_fmac_f32 v63, v19, v71
    v_lshlrev_b32 v70, 16, v58
    v_and_b32 v71, 0xffff0000, v58
    v_fmac_f32 v64, v19, v70
    v_fmac_f32 v65, v19, v71
    v_lshlrev_b32 v70, 16, v59
    v_and_b32 v71, 0xffff0000, v59
    v_fmac_f32 v66, v19, v70
    v_fmac_f32 v67, v19, v71
    v_lshlrev_b32 v5, 7, v1
    v_lshl_add_u32 v5, v2, 5, v5
    ds_write_b128 v5, v[60:63]
    ds_write_b128 v5, v[64:67] offset:16
    s_waitcnt lgkmcnt(0)
    s_barrier
    v_and_b32 v6, 31, v0
    v_lshrrev_b32 v7, 5, v0
    v_lshlrev_b32 v8, 10, v7
    v_lshl_add_u32 v8, v6, 2, v8
    ds_read_b32 v20, v8 offset:0
    ds_read_b32 v21, v8 offset:128
    ds_read_b32 v22, v8 offset:256
    ds_read_b32 v23, v8 offset:384
    ds_read_b32 v24, v8 offset:512
    ds_read_b32 v25, v8 offset:640
    ds_read_b32 v26, v8 offset:768
    ds_read_b32 v27, v8 offset:896
    s_waitcnt lgkmcnt(0)
    v_add_f32 v20, v20, v21
    v_add_f32 v22, v22, v23
    v_add_f32 v24, v24, v25
    v_add_f32 v26, v26, v27
    v_add_f32 v20, v20, v22
    v_add_f32 v24, v24, v26
    v_add_f32 v20, v20, v24
    v_lshlrev_b32 v9, 2, v0
    ds_write_b32 v9, v20 offset:8192
    s_waitcnt lgkmcnt(0)
    s_barrier
    v_lshlrev_b32 v9, 2, v6
    ds_read_b32 v20, v9 offset:8192
    ds_read_b32 v21, v9 offset:8320
    ds_read_b32 v22, v9 offset:8448
    ds_read_b32 v23, v9 offset:8576
    ds_read_b32 v24, v9 offset:8704
    ds_read_b32 v25, v9 offset:8832
    ds_read_b32 v26, v9 offset:8960
    ds_read_b32 v27, v9 offset:9088
    s_waitcnt lgkmcnt(0)
    v_add_f32 v20, v20, v21
    v_add_f32 v22, v22, v23
    v_add_f32 v24, v24, v25
    v_add_f32 v26, v26, v27
    v_add_f32 v20, v20, v22
    v_add_f32 v24, v24, v26
    v_add_f32 v20, v20, v24
    v_cvt_pk_bf16_f32 v20, v20, v20
    v_lshlrev_b32 v21, 16, v20
    v_add_f32 v22, 1.0, v21
    v_cvt_pk_bf16_f32 v22, v22, v22
    v_lshlrev_b32 v22, 16, v22
    s_mul_i32 s26, s6, 3277
    s_lshr_b32 s26, s26, 16
    s_cmp_eq_u32 s26, 1
    s_cselect_b32 s27, 1, 0
    s_cmp_eq_u32 s26, 4
    s_cselect_b32 s27, 1, s27
    s_cmp_eq_u32 s27, 1
    s_cbranch_scc0 prep_kernel_gnc
    v_mov_b32 v21, v22
prep_kernel_gnc:
    s_add_u32 s28, s4, 65536
    s_addc_u32 s29, s5, 0
    s_mov_b32 s30, 15360
    s_mov_b32 s31, 0x00020000
    v_lshlrev_b32 v9, 1, v6
    v_add_u32 v9, s21, v9
    v_lshlrev_b32 v10, 1, v9
    v_cmp_gt_u32 vcc, 32, v0
    s_and_saveexec_b64 s[24:25], vcc
    s_cbranch_execz prep_kernel_end
    buffer_store_short v20, v9, s[16:19], 0 offen
    buffer_store_dword v21, v10, s[28:31], 0 offen
    s_branch prep_kernel_end
prep_kernel_pf:
    s_load_dwordx8 s[28:35], s[0:1], 8
    s_sub_u32 s6, s2, 120
    s_waitcnt lgkmcnt(0)
    s_mov_b32 s8, s32
    s_mov_b32 s9, s33
    s_mov_b32 s10, 819200
    s_mov_b32 s11, 0x00020000
    s_cmp_lt_u32 s6, 13
    s_cbranch_scc1 prep_kernel_pfgo
    s_sub_u32 s6, s6, 13
    s_mov_b32 s8, s34
    s_mov_b32 s9, s35
prep_kernel_pfgo:
    s_lshl_b32 s6, s6, 16
    v_lshlrev_b32 v1, 4, v0
    v_add_u32 v1, s6, v1
    s_mov_b32 s7, 0
    buffer_load_dwordx4 v[4:7], v1, s[8:11], s7 offen
    s_mov_b32 s7, 4096
    buffer_load_dwordx4 v[8:11], v1, s[8:11], s7 offen
    s_mov_b32 s7, 8192
    buffer_load_dwordx4 v[12:15], v1, s[8:11], s7 offen
    s_mov_b32 s7, 12288
    buffer_load_dwordx4 v[16:19], v1, s[8:11], s7 offen
    s_mov_b32 s7, 16384
    buffer_load_dwordx4 v[20:23], v1, s[8:11], s7 offen
    s_mov_b32 s7, 20480
    buffer_load_dwordx4 v[24:27], v1, s[8:11], s7 offen
    s_mov_b32 s7, 24576
    buffer_load_dwordx4 v[28:31], v1, s[8:11], s7 offen
    s_mov_b32 s7, 28672
    buffer_load_dwordx4 v[32:35], v1, s[8:11], s7 offen
    s_mov_b32 s7, 32768
    buffer_load_dwordx4 v[36:39], v1, s[8:11], s7 offen
    s_mov_b32 s7, 36864
    buffer_load_dwordx4 v[40:43], v1, s[8:11], s7 offen
    s_mov_b32 s7, 40960
    buffer_load_dwordx4 v[44:47], v1, s[8:11], s7 offen
    s_mov_b32 s7, 45056
    buffer_load_dwordx4 v[48:51], v1, s[8:11], s7 offen
    s_mov_b32 s7, 49152
    buffer_load_dwordx4 v[52:55], v1, s[8:11], s7 offen
    s_mov_b32 s7, 53248
    buffer_load_dwordx4 v[56:59], v1, s[8:11], s7 offen
    s_mov_b32 s7, 57344
    buffer_load_dwordx4 v[60:63], v1, s[8:11], s7 offen
    s_mov_b32 s7, 61440
    buffer_load_dwordx4 v[64:67], v1, s[8:11], s7 offen
    s_branch prep_kernel_end
prep_kernel_ln:
    s_load_dwordx2 s[4:5], s[0:1], 96
    s_load_dwordx2 s[6:7], s[0:1], 0
    s_sub_u32 s3, s2, 152
    s_and_b32 s20, s3, 7
    s_lshl_b32 s20, s20, 5
    s_lshr_b32 s3, s3, 3
    s_add_u32 s3, s3, s20
    v_lshrrev_b32 v1, 5, v0
    s_lshl_b32 s3, s3, 3
    v_add_u32 v1, s3, v1
    v_and_b32 v2, 31, v0
    v_lshlrev_b32 v2, 3, v2
    s_movk_i32 s3, 1280
    v_mul_lo_u32 v1, v1, s3
    v_add_u32 v1, v1, v2
    s_waitcnt lgkmcnt(0)
    s_mov_b32 s8, s6
    s_mov_b32 s9, s7
    s_mov_b32 s10, 2621440
    s_mov_b32 s11, 0x00020000
    s_add_u32 s16, s4, 4063232
    s_addc_u32 s17, s5, 0
    s_mov_b32 s18, 2621440
    s_mov_b32 s19, 0x00020000
    buffer_load_dwordx2 v[10:11], v1, s[8:11], 0 offen offset:0
    buffer_load_dwordx2 v[12:13], v1, s[8:11], 0 offen offset:256
    buffer_load_dwordx2 v[14:15], v1, s[8:11], 0 offen offset:512
    buffer_load_dwordx2 v[16:17], v1, s[8:11], 0 offen offset:768
    buffer_load_dwordx2 v[18:19], v1, s[8:11], 0 offen offset:1024
    s_waitcnt vmcnt(0)
    v_lshlrev_b32 v20, 16, v10
    v_and_b32 v21, 0xffff0000, v10
    v_lshlrev_b32 v22, 16, v11
    v_and_b32 v23, 0xffff0000, v11
    v_lshlrev_b32 v24, 16, v12
    v_and_b32 v25, 0xffff0000, v12
    v_lshlrev_b32 v26, 16, v13
    v_and_b32 v27, 0xffff0000, v13
    v_lshlrev_b32 v28, 16, v14
    v_and_b32 v29, 0xffff0000, v14
    v_lshlrev_b32 v30, 16, v15
    v_and_b32 v31, 0xffff0000, v15
    v_lshlrev_b32 v32, 16, v16
    v_and_b32 v33, 0xffff0000, v16
    v_lshlrev_b32 v34, 16, v17
    v_and_b32 v35, 0xffff0000, v17
    v_lshlrev_b32 v36, 16, v18
    v_and_b32 v37, 0xffff0000, v18
    v_lshlrev_b32 v38, 16, v19
    v_and_b32 v39, 0xffff0000, v19
    v_add_f32 v50, v20, v21
    v_add_f32 v51, v22, v23
    v_add_f32 v50, v50, v24
    v_add_f32 v51, v51, v25
    v_add_f32 v50, v50, v26
    v_add_f32 v51, v51, v27
    v_add_f32 v50, v50, v28
    v_add_f32 v51, v51, v29
    v_add_f32 v50, v50, v30
    v_add_f32 v51, v51, v31
    v_add_f32 v50, v50, v32
    v_add_f32 v51, v51, v33
    v_add_f32 v50, v50, v34
    v_add_f32 v51, v51, v35
    v_add_f32 v50, v50, v36
    v_add_f32 v51, v51, v37
    v_add_f32 v50, v50, v38
    v_add_f32 v51, v51, v39
    v_add_f32 v50, v50, v51
    s_nop 1
    v_add_f32_dpp v51, v50, v50 quad_perm:[1,0,3,2] row_mask:0xf bank_mask:0xf
    s_nop 1
    v_add_f32_dpp v50, v51, v51 quad_perm:[2,3,0,1] row_mask:0xf bank_mask:0xf
    s_nop 1
    v_add_f32_dpp v51, v50, v50 row_half_mirror row_mask:0xf bank_mask:0xf
    s_nop 1
    v_add_f32_dpp v50, v51, v51 row_mirror row_mask:0xf bank_mask:0xf
    ds_swizzle_b32 v51, v50 offset:0x401F
    s_waitcnt lgkmcnt(0)
    v_add_f32 v50, v50, v51
    v_mul_f32 v52, 0x3acccccd, v50
    v_sub_f32 v51, v20, v52
    v_mul_f32 v50, v51, v51
    v_sub_f32 v51, v21, v52
    v_mul_f32 v53, v51, v51
    v_sub_f32 v51, v22, v52
    v_fmac_f32 v50, v51, v51
    v_sub_f32 v51, v23, v52
    v_fmac_f32 v53, v51, v51
    v_sub_f32 v51, v24, v52
    v_fmac_f32 v50, v51, v51
    v_sub_f32 v51, v25, v52
    v_fmac_f32 v53, v51, v51
    v_sub_f32 v51, v26, v52
    v_fmac_f32 v50, v51, v51
    v_sub_f32 v51, v27, v52
    v_fmac_f32 v53, v51, v51
    v_sub_f32 v51, v28, v52
    v_fmac_f32 v50, v51, v51
    v_sub_f32 v51, v29, v52
    v_fmac_f32 v53, v51, v51
    v_sub_f32 v51, v30, v52
    v_fmac_f32 v50, v51, v51
    v_sub_f32 v51, v31, v52
    v_fmac_f32 v53, v51, v51
    v_sub_f32 v51, v32, v52
    v_fmac_f32 v50, v51, v51
    v_sub_f32 v51, v33, v52
    v_fmac_f32 v53, v51, v51
    v_sub_f32 v51, v34, v52
    v_fmac_f32 v50, v51, v51
    v_sub_f32 v51, v35, v52
    v_fmac_f32 v53, v51, v51
    v_sub_f32 v51, v36, v52
    v_fmac_f32 v50, v51, v51
    v_sub_f32 v51, v37, v52
    v_fmac_f32 v53, v51, v51
    v_sub_f32 v51, v38, v52
    v_fmac_f32 v50, v51, v51
    v_sub_f32 v51, v39, v52
    v_fmac_f32 v53, v51, v51
    v_add_f32 v50, v50, v53
    s_nop 1
    v_add_f32_dpp v51, v50, v50 quad_perm:[1,0,3,2] row_mask:0xf bank_mask:0xf
    s_nop 1
    v_add_f32_dpp v50, v51, v51 quad_perm:[2,3,0,1] row_mask:0xf bank_mask:0xf
    s_nop 1
    v_add_f32_dpp v51, v50, v50 row_half_mirror row_mask:0xf bank_mask:0xf
    s_nop 1
    v_add_f32_dpp v50, v51, v51 row_mirror row_mask:0xf bank_mask:0xf
    ds_swizzle_b32 v51, v50 offset:0x401F
    s_waitcnt lgkmcnt(0)
    v_add_f32 v50, v50, v51
    v_mul_f32 v50, 0x3acccccd, v50
    v_cvt_pk_bf16_f32 v51, v52, v50
    v_lshlrev_b32 v52, 16, v51
    v_and_b32 v50, 0xffff0000, v51
    v_add_f32 v50, 0x3727c5ac, v50
    v_cvt_pk_bf16_f32 v51, v50, v50
    v_lshlrev_b32 v50, 16, v51
    v_sqrt_f32 v50, v50
    s_nop 0
    v_cvt_pk_bf16_f32 v51, v50, v50
    v_lshlrev_b32 v50, 16, v51
    v_rcp_f32 v53, v50
    s_nop 0
    v_sub_f32 v54, v20, v52
    v_sub_f32 v55, v21, v52
    v_cvt_pk_bf16_f32 v51, v54, v55
    v_lshlrev_b32 v54, 16, v51
    v_and_b32 v55, 0xffff0000, v51
    v_mul_f32 v54, v54, v53
    v_mul_f32 v55, v55, v53
    v_cvt_pk_bf16_f32 v40, v54, v55
    v_sub_f32 v54, v22, v52
    v_sub_f32 v55, v23, v52
    v_cvt_pk_bf16_f32 v51, v54, v55
    v_lshlrev_b32 v54, 16, v51
    v_and_b32 v55, 0xffff0000, v51
    v_mul_f32 v54, v54, v53
    v_mul_f32 v55, v55, v53
    v_cvt_pk_bf16_f32 v41, v54, v55
    v_sub_f32 v54, v24, v52
    v_sub_f32 v55, v25, v52
    v_cvt_pk_bf16_f32 v51, v54, v55
    v_lshlrev_b32 v54, 16, v51
    v_and_b32 v55, 0xffff0000, v51
    v_mul_f32 v54, v54, v53
    v_mul_f32 v55, v55, v53
    v_cvt_pk_bf16_f32 v42, v54, v55
    v_sub_f32 v54, v26, v52
    v_sub_f32 v55, v27, v52
    v_cvt_pk_bf16_f32 v51, v54, v55
    v_lshlrev_b32 v54, 16, v51
    v_and_b32 v55, 0xffff0000, v51
    v_mul_f32 v54, v54, v53
    v_mul_f32 v55, v55, v53
    v_cvt_pk_bf16_f32 v43, v54, v55
    v_sub_f32 v54, v28, v52
    v_sub_f32 v55, v29, v52
    v_cvt_pk_bf16_f32 v51, v54, v55
    v_lshlrev_b32 v54, 16, v51
    v_and_b32 v55, 0xffff0000, v51
    v_mul_f32 v54, v54, v53
    v_mul_f32 v55, v55, v53
    v_cvt_pk_bf16_f32 v44, v54, v55
    v_sub_f32 v54, v30, v52
    v_sub_f32 v55, v31, v52
    v_cvt_pk_bf16_f32 v51, v54, v55
    v_lshlrev_b32 v54, 16, v51
    v_and_b32 v55, 0xffff0000, v51
    v_mul_f32 v54, v54, v53
    v_mul_f32 v55, v55, v53
    v_cvt_pk_bf16_f32 v45, v54, v55
    v_sub_f32 v54, v32, v52
    v_sub_f32 v55, v33, v52
    v_cvt_pk_bf16_f32 v51, v54, v55
    v_lshlrev_b32 v54, 16, v51
    v_and_b32 v55, 0xffff0000, v51
    v_mul_f32 v54, v54, v53
    v_mul_f32 v55, v55, v53
    v_cvt_pk_bf16_f32 v46, v54, v55
    v_sub_f32 v54, v34, v52
    v_sub_f32 v55, v35, v52
    v_cvt_pk_bf16_f32 v51, v54, v55
    v_lshlrev_b32 v54, 16, v51
    v_and_b32 v55, 0xffff0000, v51
    v_mul_f32 v54, v54, v53
    v_mul_f32 v55, v55, v53
    v_cvt_pk_bf16_f32 v47, v54, v55
    v_sub_f32 v54, v36, v52
    v_sub_f32 v55, v37, v52
    v_cvt_pk_bf16_f32 v51, v54, v55
    v_lshlrev_b32 v54, 16, v51
    v_and_b32 v55, 0xffff0000, v51
    v_mul_f32 v54, v54, v53
    v_mul_f32 v55, v55, v53
    v_cvt_pk_bf16_f32 v48, v54, v55
    v_sub_f32 v54, v38, v52
    v_sub_f32 v55, v39, v52
    v_cvt_pk_bf16_f32 v51, v54, v55
    v_lshlrev_b32 v54, 16, v51
    v_and_b32 v55, 0xffff0000, v51
    v_mul_f32 v54, v54, v53
    v_mul_f32 v55, v55, v53
    v_cvt_pk_bf16_f32 v49, v54, v55
    buffer_store_dwordx2 v[40:41], v1, s[16:19], 0 offen offset:0
    buffer_store_dwordx2 v[42:43], v1, s[16:19], 0 offen offset:256
    buffer_store_dwordx2 v[44:45], v1, s[16:19], 0 offen offset:512
    buffer_store_dwordx2 v[46:47], v1, s[16:19], 0 offen offset:768
    buffer_store_dwordx2 v[48:49], v1, s[16:19], 0 offen offset:1024
prep_kernel_end:
    s_endpgm
.globl gemma_kernel
.p2align 8
.type gemma_kernel,@function
gemma_kernel:
    s_cmp_ge_u32 s2, 256
    s_cbranch_scc1 gemma_kernel_end
    s_load_dwordx2 s[48:49], s[0:1], 96
    s_load_dwordx4 s[52:55], s[0:1], 24
    v_lshrrev_b32 v1, 6, v0
    s_nop 0
    v_readfirstlane_b32 s40, v1
    v_and_b32 v1, 63, v0
    v_and_b32 v2, 15, v1
    v_lshrrev_b32 v3, 4, v1
    s_and_b32 s3, s2, 7
    s_lshr_b32 s4, s2, 3
    s_and_b32 s5, s3, 1
    s_lshl_b32 s5, s5, 2
    s_and_b32 s6, s4, 3
    s_add_u32 s5, s5, s6
    s_lshr_b32 s6, s3, 1
    s_lshl_b32 s6, s6, 3
    s_lshr_b32 s7, s4, 2
    s_add_u32 s6, s6, s7
    s_lshl_b32 s44, s40, 3
    v_add_u32 v4, s44, v3
    s_movk_i32 s45, 1280
    v_mul_lo_u32 v5, v4, s45
    v_lshl_add_u32 v5, v2, 4, v5
    v_lshlrev_b32 v6, 4, v2
    s_waitcnt lgkmcnt(0)
    s_cmp_ge_u32 s5, 4
    s_cselect_b32 s8, s54, s52
    s_cselect_b32 s9, s55, s53
    s_mov_b32 s10, 204800
    s_mov_b32 s11, 0x00020000
    s_and_b32 s7, s5, 3
    s_mul_i32 s7, s7, 204800
    s_add_u32 s8, s8, s7
    s_addc_u32 s9, s9, 0
    s_add_u32 s12, s48, 4063232
    s_addc_u32 s13, s49, 0
    s_mov_b32 s14, 81920
    s_mov_b32 s15, 0x00020000
    s_mul_i32 s7, s6, 81920
    s_add_u32 s12, s12, s7
    s_addc_u32 s13, s13, 0
    s_mov_b32 s20, s48
    s_mov_b32 s21, s49
    s_mov_b32 s22, 7680
    s_mov_b32 s23, 0x00020000
    s_movk_i32 s45, 5120
    buffer_load_dwordx4 v[16:19], v5, s[12:15], 0 offen offset:0
    buffer_load_dwordx4 v[20:23], v5, s[12:15], 0 offen offset:256
    buffer_load_dwordx4 v[24:27], v5, s[12:15], 0 offen offset:512
    buffer_load_dwordx4 v[28:31], v5, s[12:15], 0 offen offset:768
    buffer_load_dwordx4 v[32:35], v5, s[12:15], 0 offen offset:1024
    buffer_load_dwordx4 v[36:39], v5, s[12:15], s45 offen offset:0
    buffer_load_dwordx4 v[40:43], v5, s[12:15], s45 offen offset:256
    buffer_load_dwordx4 v[44:47], v5, s[12:15], s45 offen offset:512
    buffer_load_dwordx4 v[48:51], v5, s[12:15], s45 offen offset:768
    buffer_load_dwordx4 v[52:55], v5, s[12:15], s45 offen offset:1024
    buffer_load_dwordx4 v[56:59], v6, s[20:23], 0 offen offset:1280
    buffer_load_dwordx4 v[60:63], v6, s[20:23], 0 offen offset:1536
    buffer_load_dwordx4 v[64:67], v6, s[20:23], 0 offen offset:1792
    buffer_load_dwordx4 v[68:71], v6, s[20:23], 0 offen offset:2048
    buffer_load_dwordx4 v[72:75], v6, s[20:23], 0 offen offset:2304
    buffer_load_dwordx4 v[76:79], v6, s[20:23], 0 offen offset:0
    buffer_load_dwordx4 v[80:83], v6, s[20:23], 0 offen offset:256
    buffer_load_dwordx4 v[84:87], v6, s[20:23], 0 offen offset:512
    buffer_load_dwordx4 v[88:91], v6, s[20:23], 0 offen offset:768
    buffer_load_dwordx4 v[92:95], v6, s[20:23], 0 offen offset:1024
    s_add_u32 s16, s48, 6684672
    s_addc_u32 s17, s49, 0
    s_mov_b32 s18, 655360
    s_mov_b32 s19, 0x00020000
    s_mul_i32 s7, s5, 655360
    s_add_u32 s16, s16, s7
    s_addc_u32 s17, s17, 0
    s_lshl_b32 s7, s6, 7
    s_add_u32 s16, s16, s7
    s_addc_u32 s17, s17, 0
    s_and_b32 s41, s40, 3
    v_lshrrev_b32 v8, 3, v1
    v_and_b32 v9, 7, v1
    v_xor_b32 v9, v9, v3
    s_and_b32 s44, s41, 1
    s_lshl_b32 s44, s44, 2
    v_xor_b32 v9, s44, v9
    s_lshl_b32 s44, s41, 3
    v_add_u32 v8, s44, v8
    s_movk_i32 s45, 1280
    v_mul_lo_u32 v8, v8, s45
    v_lshl_add_u32 v8, v9, 4, v8
    s_lshl_b32 s42, s41, 10
    s_add_u32 s42, s42, 81920
    s_cmp_lt_u32 s40, 4
    s_cbranch_scc1 gemma_kernel_p0
    s_add_u32 m0, s42, 0
    s_mov_b32 s46, 0
    buffer_load_dwordx4 v8, s[8:11], s46 offen lds
    s_add_u32 m0, s42, 4096
    s_mov_b32 s46, 40960
    buffer_load_dwordx4 v8, s[8:11], s46 offen lds
    s_add_u32 m0, s42, 8192
    s_mov_b32 s46, 81920
    buffer_load_dwordx4 v8, s[8:11], s46 offen lds
    s_add_u32 m0, s42, 12288
    s_mov_b32 s46, 122880
    buffer_load_dwordx4 v8, s[8:11], s46 offen lds
    s_add_u32 m0, s42, 16384
    s_mov_b32 s46, 163840
    buffer_load_dwordx4 v8, s[8:11], s46 offen lds
    s_add_u32 m0, s42, 20480
    s_mov_b32 s46, 128
    buffer_load_dwordx4 v8, s[8:11], s46 offen lds
    s_add_u32 m0, s42, 24576
    s_mov_b32 s46, 41088
    buffer_load_dwordx4 v8, s[8:11], s46 offen lds
    s_add_u32 m0, s42, 28672
    s_mov_b32 s46, 82048
    buffer_load_dwordx4 v8, s[8:11], s46 offen lds
    s_add_u32 m0, s42, 32768
    s_mov_b32 s46, 123008
    buffer_load_dwordx4 v8, s[8:11], s46 offen lds
    s_add_u32 m0, s42, 36864
    s_mov_b32 s46, 163968
    buffer_load_dwordx4 v8, s[8:11], s46 offen lds
    s_add_u32 m0, s42, 40960
    s_mov_b32 s46, 256
    buffer_load_dwordx4 v8, s[8:11], s46 offen lds
    s_add_u32 m0, s42, 45056
    s_mov_b32 s46, 41216
    buffer_load_dwordx4 v8, s[8:11], s46 offen lds
    s_add_u32 m0, s42, 49152
    s_mov_b32 s46, 82176
    buffer_load_dwordx4 v8, s[8:11], s46 offen lds
    s_add_u32 m0, s42, 53248
    s_mov_b32 s46, 123136
    buffer_load_dwordx4 v8, s[8:11], s46 offen lds
    s_add_u32 m0, s42, 57344
    s_mov_b32 s46, 164096
    buffer_load_dwordx4 v8, s[8:11], s46 offen lds
    s_add_u32 m0, s42, 61440
    s_mov_b32 s46, 384
    buffer_load_dwordx4 v8, s[8:11], s46 offen lds
    s_add_u32 m0, s42, 65536
    s_mov_b32 s46, 41344
    buffer_load_dwordx4 v8, s[8:11], s46 offen lds
    s_add_u32 m0, s42, 69632
    s_mov_b32 s46, 82304
    buffer_load_dwordx4 v8, s[8:11], s46 offen lds
    s_add_u32 m0, s42, 73728
    s_mov_b32 s46, 123264
    buffer_load_dwordx4 v8, s[8:11], s46 offen lds
    s_add_u32 m0, s42, 77824
    s_mov_b32 s46, 164224
    buffer_load_dwordx4 v8, s[8:11], s46 offen lds
    s_waitcnt vmcnt(20)
    s_branch gemma_kernel_p0b
gemma_kernel_p0:
    s_waitcnt vmcnt(0)
gemma_kernel_p0b:
    v_lshrrev_b32 v10, 1, v3
    s_and_b32 s44, s40, 3
    s_lshl_b32 s44, s44, 1
    v_or_b32 v10, s44, v10
    v_and_b32 v11, 7, v2
    v_xor_b32 v10, v10, v11
    v_lshlrev_b32 v10, 4, v10
    v_lshl_add_u32 v10, v4, 7, v10
    v_lshrrev_b32 v11, 3, v2
    v_lshl_add_u32 v10, v11, 13, v10
    v_add_u32 v11, 0x8000, v10
    v_lshlrev_b32 v96, 16, v56
    v_and_b32 v97, 0xffff0000, v56
    v_add_f32 v96, 1.0, v96
    v_add_f32 v97, 1.0, v97
    v_cvt_pk_bf16_f32 v102, v96, v97
    v_lshlrev_b32 v96, 16, v102
    v_and_b32 v97, 0xffff0000, v102
    v_lshlrev_b32 v98, 16, v76
    v_and_b32 v99, 0xffff0000, v76
    v_lshlrev_b32 v100, 16, v16
    v_and_b32 v101, 0xffff0000, v16
    v_mul_f32 v100, v100, v96
    v_mul_f32 v101, v101, v97
    v_cvt_pk_bf16_f32 v102, v100, v101
    v_lshlrev_b32 v100, 16, v102
    v_and_b32 v101, 0xffff0000, v102
    v_add_f32 v100, v100, v98
    v_add_f32 v101, v101, v99
    v_cvt_pk_bf16_f32 v16, v100, v101
    v_lshlrev_b32 v100, 16, v36
    v_and_b32 v101, 0xffff0000, v36
    v_mul_f32 v100, v100, v96
    v_mul_f32 v101, v101, v97
    v_cvt_pk_bf16_f32 v102, v100, v101
    v_lshlrev_b32 v100, 16, v102
    v_and_b32 v101, 0xffff0000, v102
    v_add_f32 v100, v100, v98
    v_add_f32 v101, v101, v99
    v_cvt_pk_bf16_f32 v36, v100, v101
    v_lshlrev_b32 v96, 16, v57
    v_and_b32 v97, 0xffff0000, v57
    v_add_f32 v96, 1.0, v96
    v_add_f32 v97, 1.0, v97
    v_cvt_pk_bf16_f32 v102, v96, v97
    v_lshlrev_b32 v96, 16, v102
    v_and_b32 v97, 0xffff0000, v102
    v_lshlrev_b32 v98, 16, v77
    v_and_b32 v99, 0xffff0000, v77
    v_lshlrev_b32 v100, 16, v17
    v_and_b32 v101, 0xffff0000, v17
    v_mul_f32 v100, v100, v96
    v_mul_f32 v101, v101, v97
    v_cvt_pk_bf16_f32 v102, v100, v101
    v_lshlrev_b32 v100, 16, v102
    v_and_b32 v101, 0xffff0000, v102
    v_add_f32 v100, v100, v98
    v_add_f32 v101, v101, v99
    v_cvt_pk_bf16_f32 v17, v100, v101
    v_lshlrev_b32 v100, 16, v37
    v_and_b32 v101, 0xffff0000, v37
    v_mul_f32 v100, v100, v96
    v_mul_f32 v101, v101, v97
    v_cvt_pk_bf16_f32 v102, v100, v101
    v_lshlrev_b32 v100, 16, v102
    v_and_b32 v101, 0xffff0000, v102
    v_add_f32 v100, v100, v98
    v_add_f32 v101, v101, v99
    v_cvt_pk_bf16_f32 v37, v100, v101
    v_lshlrev_b32 v96, 16, v58
    v_and_b32 v97, 0xffff0000, v58
    v_add_f32 v96, 1.0, v96
    v_add_f32 v97, 1.0, v97
    v_cvt_pk_bf16_f32 v102, v96, v97
    v_lshlrev_b32 v96, 16, v102
    v_and_b32 v97, 0xffff0000, v102
    v_lshlrev_b32 v98, 16, v78
    v_and_b32 v99, 0xffff0000, v78
    v_lshlrev_b32 v100, 16, v18
    v_and_b32 v101, 0xffff0000, v18
    v_mul_f32 v100, v100, v96
    v_mul_f32 v101, v101, v97
    v_cvt_pk_bf16_f32 v102, v100, v101
    v_lshlrev_b32 v100, 16, v102
    v_and_b32 v101, 0xffff0000, v102
    v_add_f32 v100, v100, v98
    v_add_f32 v101, v101, v99
    v_cvt_pk_bf16_f32 v18, v100, v101
    v_lshlrev_b32 v100, 16, v38
    v_and_b32 v101, 0xffff0000, v38
    v_mul_f32 v100, v100, v96
    v_mul_f32 v101, v101, v97
    v_cvt_pk_bf16_f32 v102, v100, v101
    v_lshlrev_b32 v100, 16, v102
    v_and_b32 v101, 0xffff0000, v102
    v_add_f32 v100, v100, v98
    v_add_f32 v101, v101, v99
    v_cvt_pk_bf16_f32 v38, v100, v101
    v_lshlrev_b32 v96, 16, v59
    v_and_b32 v97, 0xffff0000, v59
    v_add_f32 v96, 1.0, v96
    v_add_f32 v97, 1.0, v97
    v_cvt_pk_bf16_f32 v102, v96, v97
    v_lshlrev_b32 v96, 16, v102
    v_and_b32 v97, 0xffff0000, v102
    v_lshlrev_b32 v98, 16, v79
    v_and_b32 v99, 0xffff0000, v79
    v_lshlrev_b32 v100, 16, v19
    v_and_b32 v101, 0xffff0000, v19
    v_mul_f32 v100, v100, v96
    v_mul_f32 v101, v101, v97
    v_cvt_pk_bf16_f32 v102, v100, v101
    v_lshlrev_b32 v100, 16, v102
    v_and_b32 v101, 0xffff0000, v102
    v_add_f32 v100, v100, v98
    v_add_f32 v101, v101, v99
    v_cvt_pk_bf16_f32 v19, v100, v101
    v_lshlrev_b32 v100, 16, v39
    v_and_b32 v101, 0xffff0000, v39
    v_mul_f32 v100, v100, v96
    v_mul_f32 v101, v101, v97
    v_cvt_pk_bf16_f32 v102, v100, v101
    v_lshlrev_b32 v100, 16, v102
    v_and_b32 v101, 0xffff0000, v102
    v_add_f32 v100, v100, v98
    v_add_f32 v101, v101, v99
    v_cvt_pk_bf16_f32 v39, v100, v101
    ds_write_b128 v10, v[16:19] offset:0
    ds_write_b128 v10, v[36:39] offset:512
    v_lshlrev_b32 v96, 16, v60
    v_and_b32 v97, 0xffff0000, v60
    v_add_f32 v96, 1.0, v96
    v_add_f32 v97, 1.0, v97
    v_cvt_pk_bf16_f32 v102, v96, v97
    v_lshlrev_b32 v96, 16, v102
    v_and_b32 v97, 0xffff0000, v102
    v_lshlrev_b32 v98, 16, v80
    v_and_b32 v99, 0xffff0000, v80
    v_lshlrev_b32 v100, 16, v20
    v_and_b32 v101, 0xffff0000, v20
    v_mul_f32 v100, v100, v96
    v_mul_f32 v101, v101, v97
    v_cvt_pk_bf16_f32 v102, v100, v101
    v_lshlrev_b32 v100, 16, v102
    v_and_b32 v101, 0xffff0000, v102
    v_add_f32 v100, v100, v98
    v_add_f32 v101, v101, v99
    v_cvt_pk_bf16_f32 v20, v100, v101
    v_lshlrev_b32 v100, 16, v40
    v_and_b32 v101, 0xffff0000, v40
    v_mul_f32 v100, v100, v96
    v_mul_f32 v101, v101, v97
    v_cvt_pk_bf16_f32 v102, v100, v101
    v_lshlrev_b32 v100, 16, v102
    v_and_b32 v101, 0xffff0000, v102
    v_add_f32 v100, v100, v98
    v_add_f32 v101, v101, v99
    v_cvt_pk_bf16_f32 v40, v100, v101
    v_lshlrev_b32 v96, 16, v61
    v_and_b32 v97, 0xffff0000, v61
    v_add_f32 v96, 1.0, v96
    v_add_f32 v97, 1.0, v97
    v_cvt_pk_bf16_f32 v102, v96, v97
    v_lshlrev_b32 v96, 16, v102
    v_and_b32 v97, 0xffff0000, v102
    v_lshlrev_b32 v98, 16, v81
    v_and_b32 v99, 0xffff0000, v81
    v_lshlrev_b32 v100, 16, v21
    v_and_b32 v101, 0xffff0000, v21
    v_mul_f32 v100, v100, v96
    v_mul_f32 v101, v101, v97
    v_cvt_pk_bf16_f32 v102, v100, v101
    v_lshlrev_b32 v100, 16, v102
    v_and_b32 v101, 0xffff0000, v102
    v_add_f32 v100, v100, v98
    v_add_f32 v101, v101, v99
    v_cvt_pk_bf16_f32 v21, v100, v101
    v_lshlrev_b32 v100, 16, v41
    v_and_b32 v101, 0xffff0000, v41
    v_mul_f32 v100, v100, v96
    v_mul_f32 v101, v101, v97
    v_cvt_pk_bf16_f32 v102, v100, v101
    v_lshlrev_b32 v100, 16, v102
    v_and_b32 v101, 0xffff0000, v102
    v_add_f32 v100, v100, v98
    v_add_f32 v101, v101, v99
    v_cvt_pk_bf16_f32 v41, v100, v101
    v_lshlrev_b32 v96, 16, v62
    v_and_b32 v97, 0xffff0000, v62
    v_add_f32 v96, 1.0, v96
    v_add_f32 v97, 1.0, v97
    v_cvt_pk_bf16_f32 v102, v96, v97
    v_lshlrev_b32 v96, 16, v102
    v_and_b32 v97, 0xffff0000, v102
    v_lshlrev_b32 v98, 16, v82
    v_and_b32 v99, 0xffff0000, v82
    v_lshlrev_b32 v100, 16, v22
    v_and_b32 v101, 0xffff0000, v22
    v_mul_f32 v100, v100, v96
    v_mul_f32 v101, v101, v97
    v_cvt_pk_bf16_f32 v102, v100, v101
    v_lshlrev_b32 v100, 16, v102
    v_and_b32 v101, 0xffff0000, v102
    v_add_f32 v100, v100, v98
    v_add_f32 v101, v101, v99
    v_cvt_pk_bf16_f32 v22, v100, v101
    v_lshlrev_b32 v100, 16, v42
    v_and_b32 v101, 0xffff0000, v42
    v_mul_f32 v100, v100, v96
    v_mul_f32 v101, v101, v97
    v_cvt_pk_bf16_f32 v102, v100, v101
    v_lshlrev_b32 v100, 16, v102
    v_and_b32 v101, 0xffff0000, v102
    v_add_f32 v100, v100, v98
    v_add_f32 v101, v101, v99
    v_cvt_pk_bf16_f32 v42, v100, v101
    v_lshlrev_b32 v96, 16, v63
    v_and_b32 v97, 0xffff0000, v63
    v_add_f32 v96, 1.0, v96
    v_add_f32 v97, 1.0, v97
    v_cvt_pk_bf16_f32 v102, v96, v97
    v_lshlrev_b32 v96, 16, v102
    v_and_b32 v97, 0xffff0000, v102
    v_lshlrev_b32 v98, 16, v83
    v_and_b32 v99, 0xffff0000, v83
    v_lshlrev_b32 v100, 16, v23
    v_and_b32 v101, 0xffff0000, v23
    v_mul_f32 v100, v100, v96
    v_mul_f32 v101, v101, v97
    v_cvt_pk_bf16_f32 v102, v100, v101
    v_lshlrev_b32 v100, 16, v102
    v_and_b32 v101, 0xffff0000, v102
    v_add_f32 v100, v100, v98
    v_add_f32 v101, v101, v99
    v_cvt_pk_bf16_f32 v23, v100, v101
    v_lshlrev_b32 v100, 16, v43
    v_and_b32 v101, 0xffff0000, v43
    v_mul_f32 v100, v100, v96
    v_mul_f32 v101, v101, v97
    v_cvt_pk_bf16_f32 v102, v100, v101
    v_lshlrev_b32 v100, 16, v102
    v_and_b32 v101, 0xffff0000, v102
    v_add_f32 v100, v100, v98
    v_add_f32 v101, v101, v99
    v_cvt_pk_bf16_f32 v43, v100, v101
    ds_write_b128 v10, v[20:23] offset:16384
    ds_write_b128 v10, v[40:43] offset:16896
    v_lshlrev_b32 v96, 16, v64
    v_and_b32 v97, 0xffff0000, v64
    v_add_f32 v96, 1.0, v96
    v_add_f32 v97, 1.0, v97
    v_cvt_pk_bf16_f32 v102, v96, v97
    v_lshlrev_b32 v96, 16, v102
    v_and_b32 v97, 0xffff0000, v102
    v_lshlrev_b32 v98, 16, v84
    v_and_b32 v99, 0xffff0000, v84
    v_lshlrev_b32 v100, 16, v24
    v_and_b32 v101, 0xffff0000, v24
    v_mul_f32 v100, v100, v96
    v_mul_f32 v101, v101, v97
    v_cvt_pk_bf16_f32 v102, v100, v101
    v_lshlrev_b32 v100, 16, v102
    v_and_b32 v101, 0xffff0000, v102
    v_add_f32 v100, v100, v98
    v_add_f32 v101, v101, v99
    v_cvt_pk_bf16_f32 v24, v100, v101
    v_lshlrev_b32 v100, 16, v44
    v_and_b32 v101, 0xffff0000, v44
    v_mul_f32 v100, v100, v96
    v_mul_f32 v101, v101, v97
    v_cvt_pk_bf16_f32 v102, v100, v101
    v_lshlrev_b32 v100, 16, v102
    v_and_b32 v101, 0xffff0000, v102
    v_add_f32 v100, v100, v98
    v_add_f32 v101, v101, v99
    v_cvt_pk_bf16_f32 v44, v100, v101
    v_lshlrev_b32 v96, 16, v65
    v_and_b32 v97, 0xffff0000, v65
    v_add_f32 v96, 1.0, v96
    v_add_f32 v97, 1.0, v97
    v_cvt_pk_bf16_f32 v102, v96, v97
    v_lshlrev_b32 v96, 16, v102
    v_and_b32 v97, 0xffff0000, v102
    v_lshlrev_b32 v98, 16, v85
    v_and_b32 v99, 0xffff0000, v85
    v_lshlrev_b32 v100, 16, v25
    v_and_b32 v101, 0xffff0000, v25
    v_mul_f32 v100, v100, v96
    v_mul_f32 v101, v101, v97
    v_cvt_pk_bf16_f32 v102, v100, v101
    v_lshlrev_b32 v100, 16, v102
    v_and_b32 v101, 0xffff0000, v102
    v_add_f32 v100, v100, v98
    v_add_f32 v101, v101, v99
    v_cvt_pk_bf16_f32 v25, v100, v101
    v_lshlrev_b32 v100, 16, v45
    v_and_b32 v101, 0xffff0000, v45
    v_mul_f32 v100, v100, v96
    v_mul_f32 v101, v101, v97
    v_cvt_pk_bf16_f32 v102, v100, v101
    v_lshlrev_b32 v100, 16, v102
    v_and_b32 v101, 0xffff0000, v102
    v_add_f32 v100, v100, v98
    v_add_f32 v101, v101, v99
    v_cvt_pk_bf16_f32 v45, v100, v101
    v_lshlrev_b32 v96, 16, v66
    v_and_b32 v97, 0xffff0000, v66
    v_add_f32 v96, 1.0, v96
    v_add_f32 v97, 1.0, v97
    v_cvt_pk_bf16_f32 v102, v96, v97
    v_lshlrev_b32 v96, 16, v102
    v_and_b32 v97, 0xffff0000, v102
    v_lshlrev_b32 v98, 16, v86
    v_and_b32 v99, 0xffff0000, v86
    v_lshlrev_b32 v100, 16, v26
    v_and_b32 v101, 0xffff0000, v26
    v_mul_f32 v100, v100, v96
    v_mul_f32 v101, v101, v97
    v_cvt_pk_bf16_f32 v102, v100, v101
    v_lshlrev_b32 v100, 16, v102
    v_and_b32 v101, 0xffff0000, v102
    v_add_f32 v100, v100, v98
    v_add_f32 v101, v101, v99
    v_cvt_pk_bf16_f32 v26, v100, v101
    v_lshlrev_b32 v100, 16, v46
    v_and_b32 v101, 0xffff0000, v46
    v_mul_f32 v100, v100, v96
    v_mul_f32 v101, v101, v97
    v_cvt_pk_bf16_f32 v102, v100, v101
    v_lshlrev_b32 v100, 16, v102
    v_and_b32 v101, 0xffff0000, v102
    v_add_f32 v100, v100, v98
    v_add_f32 v101, v101, v99
    v_cvt_pk_bf16_f32 v46, v100, v101
    v_lshlrev_b32 v96, 16, v67
    v_and_b32 v97, 0xffff0000, v67
    v_add_f32 v96, 1.0, v96
    v_add_f32 v97, 1.0, v97
    v_cvt_pk_bf16_f32 v102, v96, v97
    v_lshlrev_b32 v96, 16, v102
    v_and_b32 v97, 0xffff0000, v102
    v_lshlrev_b32 v98, 16, v87
    v_and_b32 v99, 0xffff0000, v87
    v_lshlrev_b32 v100, 16, v27
    v_and_b32 v101, 0xffff0000, v27
    v_mul_f32 v100, v100, v96
    v_mul_f32 v101, v101, v97
    v_cvt_pk_bf16_f32 v102, v100, v101
    v_lshlrev_b32 v100, 16, v102
    v_and_b32 v101, 0xffff0000, v102
    v_add_f32 v100, v100, v98
    v_add_f32 v101, v101, v99
    v_cvt_pk_bf16_f32 v27, v100, v101
    v_lshlrev_b32 v100, 16, v47
    v_and_b32 v101, 0xffff0000, v47
    v_mul_f32 v100, v100, v96
    v_mul_f32 v101, v101, v97
    v_cvt_pk_bf16_f32 v102, v100, v101
    v_lshlrev_b32 v100, 16, v102
    v_and_b32 v101, 0xffff0000, v102
    v_add_f32 v100, v100, v98
    v_add_f32 v101, v101, v99
    v_cvt_pk_bf16_f32 v47, v100, v101
    ds_write_b128 v11, v[24:27] offset:0
    ds_write_b128 v11, v[44:47] offset:512
    v_lshlrev_b32 v96, 16, v68
    v_and_b32 v97, 0xffff0000, v68
    v_add_f32 v96, 1.0, v96
    v_add_f32 v97, 1.0, v97
    v_cvt_pk_bf16_f32 v102, v96, v97
    v_lshlrev_b32 v96, 16, v102
    v_and_b32 v97, 0xffff0000, v102
    v_lshlrev_b32 v98, 16, v88
    v_and_b32 v99, 0xffff0000, v88
    v_lshlrev_b32 v100, 16, v28
    v_and_b32 v101, 0xffff0000, v28
    v_mul_f32 v100, v100, v96
    v_mul_f32 v101, v101, v97
    v_cvt_pk_bf16_f32 v102, v100, v101
    v_lshlrev_b32 v100, 16, v102
    v_and_b32 v101, 0xffff0000, v102
    v_add_f32 v100, v100, v98
    v_add_f32 v101, v101, v99
    v_cvt_pk_bf16_f32 v28, v100, v101
    v_lshlrev_b32 v100, 16, v48
    v_and_b32 v101, 0xffff0000, v48
    v_mul_f32 v100, v100, v96
    v_mul_f32 v101, v101, v97
    v_cvt_pk_bf16_f32 v102, v100, v101
    v_lshlrev_b32 v100, 16, v102
    v_and_b32 v101, 0xffff0000, v102
    v_add_f32 v100, v100, v98
    v_add_f32 v101, v101, v99
    v_cvt_pk_bf16_f32 v48, v100, v101
    v_lshlrev_b32 v96, 16, v69
    v_and_b32 v97, 0xffff0000, v69
    v_add_f32 v96, 1.0, v96
    v_add_f32 v97, 1.0, v97
    v_cvt_pk_bf16_f32 v102, v96, v97
    v_lshlrev_b32 v96, 16, v102
    v_and_b32 v97, 0xffff0000, v102
    v_lshlrev_b32 v98, 16, v89
    v_and_b32 v99, 0xffff0000, v89
    v_lshlrev_b32 v100, 16, v29
    v_and_b32 v101, 0xffff0000, v29
    v_mul_f32 v100, v100, v96
    v_mul_f32 v101, v101, v97
    v_cvt_pk_bf16_f32 v102, v100, v101
    v_lshlrev_b32 v100, 16, v102
    v_and_b32 v101, 0xffff0000, v102
    v_add_f32 v100, v100, v98
    v_add_f32 v101, v101, v99
    v_cvt_pk_bf16_f32 v29, v100, v101
    v_lshlrev_b32 v100, 16, v49
    v_and_b32 v101, 0xffff0000, v49
    v_mul_f32 v100, v100, v96
    v_mul_f32 v101, v101, v97
    v_cvt_pk_bf16_f32 v102, v100, v101
    v_lshlrev_b32 v100, 16, v102
    v_and_b32 v101, 0xffff0000, v102
    v_add_f32 v100, v100, v98
    v_add_f32 v101, v101, v99
    v_cvt_pk_bf16_f32 v49, v100, v101
    v_lshlrev_b32 v96, 16, v70
    v_and_b32 v97, 0xffff0000, v70
    v_add_f32 v96, 1.0, v96
    v_add_f32 v97, 1.0, v97
    v_cvt_pk_bf16_f32 v102, v96, v97
    v_lshlrev_b32 v96, 16, v102
    v_and_b32 v97, 0xffff0000, v102
    v_lshlrev_b32 v98, 16, v90
    v_and_b32 v99, 0xffff0000, v90
    v_lshlrev_b32 v100, 16, v30
    v_and_b32 v101, 0xffff0000, v30
    v_mul_f32 v100, v100, v96
    v_mul_f32 v101, v101, v97
    v_cvt_pk_bf16_f32 v102, v100, v101
    v_lshlrev_b32 v100, 16, v102
    v_and_b32 v101, 0xffff0000, v102
    v_add_f32 v100, v100, v98
    v_add_f32 v101, v101, v99
    v_cvt_pk_bf16_f32 v30, v100, v101
    v_lshlrev_b32 v100, 16, v50
    v_and_b32 v101, 0xffff0000, v50
    v_mul_f32 v100, v100, v96
    v_mul_f32 v101, v101, v97
    v_cvt_pk_bf16_f32 v102, v100, v101
    v_lshlrev_b32 v100, 16, v102
    v_and_b32 v101, 0xffff0000, v102
    v_add_f32 v100, v100, v98
    v_add_f32 v101, v101, v99
    v_cvt_pk_bf16_f32 v50, v100, v101
    v_lshlrev_b32 v96, 16, v71
    v_and_b32 v97, 0xffff0000, v71
    v_add_f32 v96, 1.0, v96
    v_add_f32 v97, 1.0, v97
    v_cvt_pk_bf16_f32 v102, v96, v97
    v_lshlrev_b32 v96, 16, v102
    v_and_b32 v97, 0xffff0000, v102
    v_lshlrev_b32 v98, 16, v91
    v_and_b32 v99, 0xffff0000, v91
    v_lshlrev_b32 v100, 16, v31
    v_and_b32 v101, 0xffff0000, v31
    v_mul_f32 v100, v100, v96
    v_mul_f32 v101, v101, v97
    v_cvt_pk_bf16_f32 v102, v100, v101
    v_lshlrev_b32 v100, 16, v102
    v_and_b32 v101, 0xffff0000, v102
    v_add_f32 v100, v100, v98
    v_add_f32 v101, v101, v99
    v_cvt_pk_bf16_f32 v31, v100, v101
    v_lshlrev_b32 v100, 16, v51
    v_and_b32 v101, 0xffff0000, v51
    v_mul_f32 v100, v100, v96
    v_mul_f32 v101, v101, v97
    v_cvt_pk_bf16_f32 v102, v100, v101
    v_lshlrev_b32 v100, 16, v102
    v_and_b32 v101, 0xffff0000, v102
    v_add_f32 v100, v100, v98
    v_add_f32 v101, v101, v99
    v_cvt_pk_bf16_f32 v51, v100, v101
    ds_write_b128 v11, v[28:31] offset:16384
    ds_write_b128 v11, v[48:51] offset:16896
    v_lshlrev_b32 v96, 16, v72
    v_and_b32 v97, 0xffff0000, v72
    v_add_f32 v96, 1.0, v96
    v_add_f32 v97, 1.0, v97
    v_cvt_pk_bf16_f32 v102, v96, v97
    v_lshlrev_b32 v96, 16, v102
    v_and_b32 v97, 0xffff0000, v102
    v_lshlrev_b32 v98, 16, v92
    v_and_b32 v99, 0xffff0000, v92
    v_lshlrev_b32 v100, 16, v32
    v_and_b32 v101, 0xffff0000, v32
    v_mul_f32 v100, v100, v96
    v_mul_f32 v101, v101, v97
    v_cvt_pk_bf16_f32 v102, v100, v101
    v_lshlrev_b32 v100, 16, v102
    v_and_b32 v101, 0xffff0000, v102
    v_add_f32 v100, v100, v98
    v_add_f32 v101, v101, v99
    v_cvt_pk_bf16_f32 v32, v100, v101
    v_lshlrev_b32 v100, 16, v52
    v_and_b32 v101, 0xffff0000, v52
    v_mul_f32 v100, v100, v96
    v_mul_f32 v101, v101, v97
    v_cvt_pk_bf16_f32 v102, v100, v101
    v_lshlrev_b32 v100, 16, v102
    v_and_b32 v101, 0xffff0000, v102
    v_add_f32 v100, v100, v98
    v_add_f32 v101, v101, v99
    v_cvt_pk_bf16_f32 v52, v100, v101
    v_lshlrev_b32 v96, 16, v73
    v_and_b32 v97, 0xffff0000, v73
    v_add_f32 v96, 1.0, v96
    v_add_f32 v97, 1.0, v97
    v_cvt_pk_bf16_f32 v102, v96, v97
    v_lshlrev_b32 v96, 16, v102
    v_and_b32 v97, 0xffff0000, v102
    v_lshlrev_b32 v98, 16, v93
    v_and_b32 v99, 0xffff0000, v93
    v_lshlrev_b32 v100, 16, v33
    v_and_b32 v101, 0xffff0000, v33
    v_mul_f32 v100, v100, v96
    v_mul_f32 v101, v101, v97
    v_cvt_pk_bf16_f32 v102, v100, v101
    v_lshlrev_b32 v100, 16, v102
    v_and_b32 v101, 0xffff0000, v102
    v_add_f32 v100, v100, v98
    v_add_f32 v101, v101, v99
    v_cvt_pk_bf16_f32 v33, v100, v101
    v_lshlrev_b32 v100, 16, v53
    v_and_b32 v101, 0xffff0000, v53
    v_mul_f32 v100, v100, v96
    v_mul_f32 v101, v101, v97
    v_cvt_pk_bf16_f32 v102, v100, v101
    v_lshlrev_b32 v100, 16, v102
    v_and_b32 v101, 0xffff0000, v102
    v_add_f32 v100, v100, v98
    v_add_f32 v101, v101, v99
    v_cvt_pk_bf16_f32 v53, v100, v101
    v_lshlrev_b32 v96, 16, v74
    v_and_b32 v97, 0xffff0000, v74
    v_add_f32 v96, 1.0, v96
    v_add_f32 v97, 1.0, v97
    v_cvt_pk_bf16_f32 v102, v96, v97
    v_lshlrev_b32 v96, 16, v102
    v_and_b32 v97, 0xffff0000, v102
    v_lshlrev_b32 v98, 16, v94
    v_and_b32 v99, 0xffff0000, v94
    v_lshlrev_b32 v100, 16, v34
    v_and_b32 v101, 0xffff0000, v34
    v_mul_f32 v100, v100, v96
    v_mul_f32 v101, v101, v97
    v_cvt_pk_bf16_f32 v102, v100, v101
    v_lshlrev_b32 v100, 16, v102
    v_and_b32 v101, 0xffff0000, v102
    v_add_f32 v100, v100, v98
    v_add_f32 v101, v101, v99
    v_cvt_pk_bf16_f32 v34, v100, v101
    v_lshlrev_b32 v100, 16, v54
    v_and_b32 v101, 0xffff0000, v54
    v_mul_f32 v100, v100, v96
    v_mul_f32 v101, v101, v97
    v_cvt_pk_bf16_f32 v102, v100, v101
    v_lshlrev_b32 v100, 16, v102
    v_and_b32 v101, 0xffff0000, v102
    v_add_f32 v100, v100, v98
    v_add_f32 v101, v101, v99
    v_cvt_pk_bf16_f32 v54, v100, v101
    v_lshlrev_b32 v96, 16, v75
    v_and_b32 v97, 0xffff0000, v75
    v_add_f32 v96, 1.0, v96
    v_add_f32 v97, 1.0, v97
    v_cvt_pk_bf16_f32 v102, v96, v97
    v_lshlrev_b32 v96, 16, v102
    v_and_b32 v97, 0xffff0000, v102
    v_lshlrev_b32 v98, 16, v95
    v_and_b32 v99, 0xffff0000, v95
    v_lshlrev_b32 v100, 16, v35
    v_and_b32 v101, 0xffff0000, v35
    v_mul_f32 v100, v100, v96
    v_mul_f32 v101, v101, v97
    v_cvt_pk_bf16_f32 v102, v100, v101
    v_lshlrev_b32 v100, 16, v102
    v_and_b32 v101, 0xffff0000, v102
    v_add_f32 v100, v100, v98
    v_add_f32 v101, v101, v99
    v_cvt_pk_bf16_f32 v35, v100, v101
    v_lshlrev_b32 v100, 16, v55
    v_and_b32 v101, 0xffff0000, v55
    v_mul_f32 v100, v100, v96
    v_mul_f32 v101, v101, v97
    v_cvt_pk_bf16_f32 v102, v100, v101
    v_lshlrev_b32 v100, 16, v102
    v_and_b32 v101, 0xffff0000, v102
    v_add_f32 v100, v100, v98
    v_add_f32 v101, v101, v99
    v_cvt_pk_bf16_f32 v55, v100, v101
    ds_write_b128 v11, v[32:35] offset:32768
    ds_write_b128 v11, v[52:55] offset:33280
    s_cmp_lt_u32 s40, 4
    s_cbranch_scc1 gemma_kernel_comp
    s_waitcnt vmcnt(15) lgkmcnt(0)
    s_barrier
    s_waitcnt vmcnt(10)
    s_barrier
    s_add_u32 m0, s42, 0
    s_mov_b32 s46, 512
    buffer_load_dwordx4 v8, s[8:11], s46 offen lds
    s_add_u32 m0, s42, 4096
    s_mov_b32 s46, 41472
    buffer_load_dwordx4 v8, s[8:11], s46 offen lds
    s_add_u32 m0, s42, 8192
    s_mov_b32 s46, 82432
    buffer_load_dwordx4 v8, s[8:11], s46 offen lds
    s_add_u32 m0, s42, 12288
    s_mov_b32 s46, 123392
    buffer_load_dwordx4 v8, s[8:11], s46 offen lds
    s_add_u32 m0, s42, 16384
    s_mov_b32 s46, 164352
    buffer_load_dwordx4 v8, s[8:11], s46 offen lds
    s_waitcnt vmcnt(10)
    s_barrier
    s_add_u32 m0, s42, 20480
    s_mov_b32 s46, 640
    buffer_load_dwordx4 v8, s[8:11], s46 offen lds
    s_add_u32 m0, s42, 24576
    s_mov_b32 s46, 41600
    buffer_load_dwordx4 v8, s[8:11], s46 offen lds
    s_add_u32 m0, s42, 28672
    s_mov_b32 s46, 82560
    buffer_load_dwordx4 v8, s[8:11], s46 offen lds
    s_add_u32 m0, s42, 32768
    s_mov_b32 s46, 123520
    buffer_load_dwordx4 v8, s[8:11], s46 offen lds
    s_add_u32 m0, s42, 36864
    s_mov_b32 s46, 164480
    buffer_load_dwordx4 v8, s[8:11], s46 offen lds
    s_waitcnt vmcnt(10)
    s_barrier
    s_add_u32 m0, s42, 40960
    s_mov_b32 s46, 768
    buffer_load_dwordx4 v8, s[8:11], s46 offen lds
    s_add_u32 m0, s42, 45056
    s_mov_b32 s46, 41728
    buffer_load_dwordx4 v8, s[8:11], s46 offen lds
    s_add_u32 m0, s42, 49152
    s_mov_b32 s46, 82688
    buffer_load_dwordx4 v8, s[8:11], s46 offen lds
    s_add_u32 m0, s42, 53248
    s_mov_b32 s46, 123648
    buffer_load_dwordx4 v8, s[8:11], s46 offen lds
    s_add_u32 m0, s42, 57344
    s_mov_b32 s46, 164608
    buffer_load_dwordx4 v8, s[8:11], s46 offen lds
    s_waitcnt vmcnt(10)
    s_barrier
    s_add_u32 m0, s42, 61440
    s_mov_b32 s46, 896
    buffer_load_dwordx4 v8, s[8:11], s46 offen lds
    s_add_u32 m0, s42, 65536
    s_mov_b32 s46, 41856
    buffer_load_dwordx4 v8, s[8:11], s46 offen lds
    s_add_u32 m0, s42, 69632
    s_mov_b32 s46, 82816
    buffer_load_dwordx4 v8, s[8:11], s46 offen lds
    s_add_u32 m0, s42, 73728
    s_mov_b32 s46, 123776
    buffer_load_dwordx4 v8, s[8:11], s46 offen lds
    s_add_u32 m0, s42, 77824
    s_mov_b32 s46, 164736
    buffer_load_dwordx4 v8, s[8:11], s46 offen lds
    s_waitcnt vmcnt(10)
    s_barrier
    s_add_u32 m0, s42, 0
    s_mov_b32 s46, 1024
    buffer_load_dwordx4 v8, s[8:11], s46 offen lds
    s_add_u32 m0, s42, 4096
    s_mov_b32 s46, 41984
    buffer_load_dwordx4 v8, s[8:11], s46 offen lds
    s_add_u32 m0, s42, 8192
    s_mov_b32 s46, 82944
    buffer_load_dwordx4 v8, s[8:11], s46 offen lds
    s_add_u32 m0, s42, 12288
    s_mov_b32 s46, 123904
    buffer_load_dwordx4 v8, s[8:11], s46 offen lds
    s_add_u32 m0, s42, 16384
    s_mov_b32 s46, 164864
    buffer_load_dwordx4 v8, s[8:11], s46 offen lds
    s_waitcnt vmcnt(10)
    s_barrier
    s_add_u32 m0, s42, 20480
    s_mov_b32 s46, 1152
    buffer_load_dwordx4 v8, s[8:11], s46 offen lds
    s_add_u32 m0, s42, 24576
    s_mov_b32 s46, 42112
    buffer_load_dwordx4 v8, s[8:11], s46 offen lds
    s_add_u32 m0, s42, 28672
    s_mov_b32 s46, 83072
    buffer_load_dwordx4 v8, s[8:11], s46 offen lds
    s_add_u32 m0, s42, 32768
    s_mov_b32 s46, 124032
    buffer_load_dwordx4 v8, s[8:11], s46 offen lds
    s_add_u32 m0, s42, 36864
    s_mov_b32 s46, 164992
    buffer_load_dwordx4 v8, s[8:11], s46 offen lds
    s_waitcnt vmcnt(10)
    s_barrier
    s_waitcnt vmcnt(5)
    s_barrier
    s_waitcnt vmcnt(0)
    s_barrier
    s_endpgm
gemma_kernel_comp:
    s_and_b32 s42, s40, 1
    s_lshr_b32 s43, s40, 1
    v_lshrrev_b32 v4, 1, v2
    v_xor_b32 v4, v4, v3
    v_and_b32 v5, 12, v2
    v_lshlrev_b32 v5, 1, v5
    v_and_b32 v6, 3, v2
    v_or_b32 v5, v5, v6
    s_mul_i32 s44, s42, 10240
    s_add_u32 s44, s44, 81920
    s_lshl_b32 s45, s43, 12
    v_xor_b32 v6, 0, v4
    v_lshlrev_b32 v6, 4, v6
    v_lshl_add_u32 v7, v2, 7, v6
    v_add_u32 v7, s44, v7
    v_add_u32 v8, 0, v7
    v_add_u32 v10, 20480, v7
    v_add_u32 v12, 40960, v7
    v_add_u32 v14, 61440, v7
    v_lshl_add_u32 v7, v5, 7, v6
    v_add_u32 v16, s45, v7
    v_add_u32 v18, 0xa000, v16
    v_xor_b32 v6, 4, v4
    v_lshlrev_b32 v6, 4, v6
    v_lshl_add_u32 v7, v2, 7, v6
    v_add_u32 v7, s44, v7
    v_add_u32 v9, 0, v7
    v_add_u32 v11, 20480, v7
    v_add_u32 v13, 40960, v7
    v_add_u32 v15, 61440, v7
    v_lshl_add_u32 v7, v5, 7, v6
    v_add_u32 v17, s45, v7
    v_add_u32 v19, 0xa000, v17
    s_waitcnt lgkmcnt(0)
    s_barrier
    ds_read_b128 v[44:47], v16 offset:0
    ds_read_b128 v[48:51], v16 offset:512
    ds_read_b128 v[24:27], v8 offset:0
    ds_read_b128 v[28:31], v8 offset:2048
    ds_read_b128 v[32:35], v8 offset:4096
    ds_read_b128 v[36:39], v8 offset:6144
    ds_read_b128 v[40:43], v8 offset:8192
    ds_read_b128 v[72:75], v17 offset:0
    ds_read_b128 v[76:79], v17 offset:512
    ds_read_b128 v[52:55], v9 offset:0
    ds_read_b128 v[56:59], v9 offset:2048
    ds_read_b128 v[60:63], v9 offset:4096
    ds_read_b128 v[64:67], v9 offset:6144
    ds_read_b128 v[68:71], v9 offset:8192
    s_waitcnt lgkmcnt(7)
    v_mfma_f32_16x16x32_bf16 a[0:3], v[44:47], v[24:27], 0
    v_mfma_f32_16x16x32_bf16 a[4:7], v[48:51], v[24:27], 0
    v_mfma_f32_16x16x32_bf16 a[8:11], v[44:47], v[28:31], 0
    v_mfma_f32_16x16x32_bf16 a[12:15], v[48:51], v[28:31], 0
    v_mfma_f32_16x16x32_bf16 a[16:19], v[44:47], v[32:35], 0
    v_mfma_f32_16x16x32_bf16 a[20:23], v[48:51], v[32:35], 0
    v_mfma_f32_16x16x32_bf16 a[24:27], v[44:47], v[36:39], 0
    v_mfma_f32_16x16x32_bf16 a[28:31], v[48:51], v[36:39], 0
    v_mfma_f32_16x16x32_bf16 a[32:35], v[44:47], v[40:43], 0
    v_mfma_f32_16x16x32_bf16 a[36:39], v[48:51], v[40:43], 0
    s_waitcnt lgkmcnt(0)
    s_barrier
    ds_read_b128 v[44:47], v16 offset:8192
    ds_read_b128 v[48:51], v16 offset:8704
    ds_read_b128 v[24:27], v10 offset:0
    ds_read_b128 v[28:31], v10 offset:2048
    ds_read_b128 v[32:35], v10 offset:4096
    ds_read_b128 v[36:39], v10 offset:6144
    ds_read_b128 v[40:43], v10 offset:8192
    v_mfma_f32_16x16x32_bf16 a[0:3], v[72:75], v[52:55], a[0:3]
    v_mfma_f32_16x16x32_bf16 a[4:7], v[76:79], v[52:55], a[4:7]
    v_mfma_f32_16x16x32_bf16 a[8:11], v[72:75], v[56:59], a[8:11]
    v_mfma_f32_16x16x32_bf16 a[12:15], v[76:79], v[56:59], a[12:15]
    v_mfma_f32_16x16x32_bf16 a[16:19], v[72:75], v[60:63], a[16:19]
    v_mfma_f32_16x16x32_bf16 a[20:23], v[76:79], v[60:63], a[20:23]
    v_mfma_f32_16x16x32_bf16 a[24:27], v[72:75], v[64:67], a[24:27]
    v_mfma_f32_16x16x32_bf16 a[28:31], v[76:79], v[64:67], a[28:31]
    v_mfma_f32_16x16x32_bf16 a[32:35], v[72:75], v[68:71], a[32:35]
    v_mfma_f32_16x16x32_bf16 a[36:39], v[76:79], v[68:71], a[36:39]
    ds_read_b128 v[72:75], v17 offset:8192
    ds_read_b128 v[76:79], v17 offset:8704
    ds_read_b128 v[52:55], v11 offset:0
    ds_read_b128 v[56:59], v11 offset:2048
    ds_read_b128 v[60:63], v11 offset:4096
    ds_read_b128 v[64:67], v11 offset:6144
    ds_read_b128 v[68:71], v11 offset:8192
    s_waitcnt lgkmcnt(7)
    v_mfma_f32_16x16x32_bf16 a[0:3], v[44:47], v[24:27], a[0:3]
    v_mfma_f32_16x16x32_bf16 a[4:7], v[48:51], v[24:27], a[4:7]
    v_mfma_f32_16x16x32_bf16 a[8:11], v[44:47], v[28:31], a[8:11]
    v_mfma_f32_16x16x32_bf16 a[12:15], v[48:51], v[28:31], a[12:15]
    v_mfma_f32_16x16x32_bf16 a[16:19], v[44:47], v[32:35], a[16:19]
    v_mfma_f32_16x16x32_bf16 a[20:23], v[48:51], v[32:35], a[20:23]
    v_mfma_f32_16x16x32_bf16 a[24:27], v[44:47], v[36:39], a[24:27]
    v_mfma_f32_16x16x32_bf16 a[28:31], v[48:51], v[36:39], a[28:31]
    v_mfma_f32_16x16x32_bf16 a[32:35], v[44:47], v[40:43], a[32:35]
    v_mfma_f32_16x16x32_bf16 a[36:39], v[48:51], v[40:43], a[36:39]
    s_waitcnt lgkmcnt(0)
    s_barrier
    ds_read_b128 v[44:47], v16 offset:16384
    ds_read_b128 v[48:51], v16 offset:16896
    ds_read_b128 v[24:27], v12 offset:0
    ds_read_b128 v[28:31], v12 offset:2048
    ds_read_b128 v[32:35], v12 offset:4096
    ds_read_b128 v[36:39], v12 offset:6144
    ds_read_b128 v[40:43], v12 offset:8192
    v_mfma_f32_16x16x32_bf16 a[0:3], v[72:75], v[52:55], a[0:3]
    v_mfma_f32_16x16x32_bf16 a[4:7], v[76:79], v[52:55], a[4:7]
    v_mfma_f32_16x16x32_bf16 a[8:11], v[72:75], v[56:59], a[8:11]
    v_mfma_f32_16x16x32_bf16 a[12:15], v[76:79], v[56:59], a[12:15]
    v_mfma_f32_16x16x32_bf16 a[16:19], v[72:75], v[60:63], a[16:19]
    v_mfma_f32_16x16x32_bf16 a[20:23], v[76:79], v[60:63], a[20:23]
    v_mfma_f32_16x16x32_bf16 a[24:27], v[72:75], v[64:67], a[24:27]
    v_mfma_f32_16x16x32_bf16 a[28:31], v[76:79], v[64:67], a[28:31]
    v_mfma_f32_16x16x32_bf16 a[32:35], v[72:75], v[68:71], a[32:35]
    v_mfma_f32_16x16x32_bf16 a[36:39], v[76:79], v[68:71], a[36:39]
    ds_read_b128 v[72:75], v17 offset:16384
    ds_read_b128 v[76:79], v17 offset:16896
    ds_read_b128 v[52:55], v13 offset:0
    ds_read_b128 v[56:59], v13 offset:2048
    ds_read_b128 v[60:63], v13 offset:4096
    ds_read_b128 v[64:67], v13 offset:6144
    ds_read_b128 v[68:71], v13 offset:8192
    s_waitcnt lgkmcnt(7)
    v_mfma_f32_16x16x32_bf16 a[0:3], v[44:47], v[24:27], a[0:3]
    v_mfma_f32_16x16x32_bf16 a[4:7], v[48:51], v[24:27], a[4:7]
    v_mfma_f32_16x16x32_bf16 a[8:11], v[44:47], v[28:31], a[8:11]
    v_mfma_f32_16x16x32_bf16 a[12:15], v[48:51], v[28:31], a[12:15]
    v_mfma_f32_16x16x32_bf16 a[16:19], v[44:47], v[32:35], a[16:19]
    v_mfma_f32_16x16x32_bf16 a[20:23], v[48:51], v[32:35], a[20:23]
    v_mfma_f32_16x16x32_bf16 a[24:27], v[44:47], v[36:39], a[24:27]
    v_mfma_f32_16x16x32_bf16 a[28:31], v[48:51], v[36:39], a[28:31]
    v_mfma_f32_16x16x32_bf16 a[32:35], v[44:47], v[40:43], a[32:35]
    v_mfma_f32_16x16x32_bf16 a[36:39], v[48:51], v[40:43], a[36:39]
    s_waitcnt lgkmcnt(0)
    s_barrier
    ds_read_b128 v[44:47], v16 offset:24576
    ds_read_b128 v[48:51], v16 offset:25088
    ds_read_b128 v[24:27], v14 offset:0
    ds_read_b128 v[28:31], v14 offset:2048
    ds_read_b128 v[32:35], v14 offset:4096
    ds_read_b128 v[36:39], v14 offset:6144
    ds_read_b128 v[40:43], v14 offset:8192
    v_mfma_f32_16x16x32_bf16 a[0:3], v[72:75], v[52:55], a[0:3]
    v_mfma_f32_16x16x32_bf16 a[4:7], v[76:79], v[52:55], a[4:7]
    v_mfma_f32_16x16x32_bf16 a[8:11], v[72:75], v[56:59], a[8:11]
    v_mfma_f32_16x16x32_bf16 a[12:15], v[76:79], v[56:59], a[12:15]
    v_mfma_f32_16x16x32_bf16 a[16:19], v[72:75], v[60:63], a[16:19]
    v_mfma_f32_16x16x32_bf16 a[20:23], v[76:79], v[60:63], a[20:23]
    v_mfma_f32_16x16x32_bf16 a[24:27], v[72:75], v[64:67], a[24:27]
    v_mfma_f32_16x16x32_bf16 a[28:31], v[76:79], v[64:67], a[28:31]
    v_mfma_f32_16x16x32_bf16 a[32:35], v[72:75], v[68:71], a[32:35]
    v_mfma_f32_16x16x32_bf16 a[36:39], v[76:79], v[68:71], a[36:39]
    ds_read_b128 v[72:75], v17 offset:24576
    ds_read_b128 v[76:79], v17 offset:25088
    ds_read_b128 v[52:55], v15 offset:0
    ds_read_b128 v[56:59], v15 offset:2048
    ds_read_b128 v[60:63], v15 offset:4096
    ds_read_b128 v[64:67], v15 offset:6144
    ds_read_b128 v[68:71], v15 offset:8192
    s_waitcnt lgkmcnt(7)
    v_mfma_f32_16x16x32_bf16 a[0:3], v[44:47], v[24:27], a[0:3]
    v_mfma_f32_16x16x32_bf16 a[4:7], v[48:51], v[24:27], a[4:7]
    v_mfma_f32_16x16x32_bf16 a[8:11], v[44:47], v[28:31], a[8:11]
    v_mfma_f32_16x16x32_bf16 a[12:15], v[48:51], v[28:31], a[12:15]
    v_mfma_f32_16x16x32_bf16 a[16:19], v[44:47], v[32:35], a[16:19]
    v_mfma_f32_16x16x32_bf16 a[20:23], v[48:51], v[32:35], a[20:23]
    v_mfma_f32_16x16x32_bf16 a[24:27], v[44:47], v[36:39], a[24:27]
    v_mfma_f32_16x16x32_bf16 a[28:31], v[48:51], v[36:39], a[28:31]
    v_mfma_f32_16x16x32_bf16 a[32:35], v[44:47], v[40:43], a[32:35]
    v_mfma_f32_16x16x32_bf16 a[36:39], v[48:51], v[40:43], a[36:39]
    s_waitcnt lgkmcnt(0)
    s_barrier
    ds_read_b128 v[44:47], v16 offset:32768
    ds_read_b128 v[48:51], v16 offset:33280
    ds_read_b128 v[24:27], v8 offset:0
    ds_read_b128 v[28:31], v8 offset:2048
    ds_read_b128 v[32:35], v8 offset:4096
    ds_read_b128 v[36:39], v8 offset:6144
    ds_read_b128 v[40:43], v8 offset:8192
    v_mfma_f32_16x16x32_bf16 a[0:3], v[72:75], v[52:55], a[0:3]
    v_mfma_f32_16x16x32_bf16 a[4:7], v[76:79], v[52:55], a[4:7]
    v_mfma_f32_16x16x32_bf16 a[8:11], v[72:75], v[56:59], a[8:11]
    v_mfma_f32_16x16x32_bf16 a[12:15], v[76:79], v[56:59], a[12:15]
    v_mfma_f32_16x16x32_bf16 a[16:19], v[72:75], v[60:63], a[16:19]
    v_mfma_f32_16x16x32_bf16 a[20:23], v[76:79], v[60:63], a[20:23]
    v_mfma_f32_16x16x32_bf16 a[24:27], v[72:75], v[64:67], a[24:27]
    v_mfma_f32_16x16x32_bf16 a[28:31], v[76:79], v[64:67], a[28:31]
    v_mfma_f32_16x16x32_bf16 a[32:35], v[72:75], v[68:71], a[32:35]
    v_mfma_f32_16x16x32_bf16 a[36:39], v[76:79], v[68:71], a[36:39]
    ds_read_b128 v[72:75], v17 offset:32768
    ds_read_b128 v[76:79], v17 offset:33280
    ds_read_b128 v[52:55], v9 offset:0
    ds_read_b128 v[56:59], v9 offset:2048
    ds_read_b128 v[60:63], v9 offset:4096
    ds_read_b128 v[64:67], v9 offset:6144
    ds_read_b128 v[68:71], v9 offset:8192
    s_waitcnt lgkmcnt(7)
    v_mfma_f32_16x16x32_bf16 a[0:3], v[44:47], v[24:27], a[0:3]
    v_mfma_f32_16x16x32_bf16 a[4:7], v[48:51], v[24:27], a[4:7]
    v_mfma_f32_16x16x32_bf16 a[8:11], v[44:47], v[28:31], a[8:11]
    v_mfma_f32_16x16x32_bf16 a[12:15], v[48:51], v[28:31], a[12:15]
    v_mfma_f32_16x16x32_bf16 a[16:19], v[44:47], v[32:35], a[16:19]
    v_mfma_f32_16x16x32_bf16 a[20:23], v[48:51], v[32:35], a[20:23]
    v_mfma_f32_16x16x32_bf16 a[24:27], v[44:47], v[36:39], a[24:27]
    v_mfma_f32_16x16x32_bf16 a[28:31], v[48:51], v[36:39], a[28:31]
    v_mfma_f32_16x16x32_bf16 a[32:35], v[44:47], v[40:43], a[32:35]
    v_mfma_f32_16x16x32_bf16 a[36:39], v[48:51], v[40:43], a[36:39]
    s_waitcnt lgkmcnt(0)
    s_barrier
    ds_read_b128 v[44:47], v18 offset:0
    ds_read_b128 v[48:51], v18 offset:512
    ds_read_b128 v[24:27], v10 offset:0
    ds_read_b128 v[28:31], v10 offset:2048
    ds_read_b128 v[32:35], v10 offset:4096
    ds_read_b128 v[36:39], v10 offset:6144
    ds_read_b128 v[40:43], v10 offset:8192
    v_mfma_f32_16x16x32_bf16 a[0:3], v[72:75], v[52:55], a[0:3]
    v_mfma_f32_16x16x32_bf16 a[4:7], v[76:79], v[52:55], a[4:7]
    v_mfma_f32_16x16x32_bf16 a[8:11], v[72:75], v[56:59], a[8:11]
    v_mfma_f32_16x16x32_bf16 a[12:15], v[76:79], v[56:59], a[12:15]
    v_mfma_f32_16x16x32_bf16 a[16:19], v[72:75], v[60:63], a[16:19]
    v_mfma_f32_16x16x32_bf16 a[20:23], v[76:79], v[60:63], a[20:23]
    v_mfma_f32_16x16x32_bf16 a[24:27], v[72:75], v[64:67], a[24:27]
    v_mfma_f32_16x16x32_bf16 a[28:31], v[76:79], v[64:67], a[28:31]
    v_mfma_f32_16x16x32_bf16 a[32:35], v[72:75], v[68:71], a[32:35]
    v_mfma_f32_16x16x32_bf16 a[36:39], v[76:79], v[68:71], a[36:39]
    ds_read_b128 v[72:75], v19 offset:0
    ds_read_b128 v[76:79], v19 offset:512
    ds_read_b128 v[52:55], v11 offset:0
    ds_read_b128 v[56:59], v11 offset:2048
    ds_read_b128 v[60:63], v11 offset:4096
    ds_read_b128 v[64:67], v11 offset:6144
    ds_read_b128 v[68:71], v11 offset:8192
    s_waitcnt lgkmcnt(7)
    v_mfma_f32_16x16x32_bf16 a[0:3], v[44:47], v[24:27], a[0:3]
    v_mfma_f32_16x16x32_bf16 a[4:7], v[48:51], v[24:27], a[4:7]
    v_mfma_f32_16x16x32_bf16 a[8:11], v[44:47], v[28:31], a[8:11]
    v_mfma_f32_16x16x32_bf16 a[12:15], v[48:51], v[28:31], a[12:15]
    v_mfma_f32_16x16x32_bf16 a[16:19], v[44:47], v[32:35], a[16:19]
    v_mfma_f32_16x16x32_bf16 a[20:23], v[48:51], v[32:35], a[20:23]
    v_mfma_f32_16x16x32_bf16 a[24:27], v[44:47], v[36:39], a[24:27]
    v_mfma_f32_16x16x32_bf16 a[28:31], v[48:51], v[36:39], a[28:31]
    v_mfma_f32_16x16x32_bf16 a[32:35], v[44:47], v[40:43], a[32:35]
    v_mfma_f32_16x16x32_bf16 a[36:39], v[48:51], v[40:43], a[36:39]
    s_waitcnt lgkmcnt(0)
    s_barrier
    ds_read_b128 v[44:47], v18 offset:8192
    ds_read_b128 v[48:51], v18 offset:8704
    ds_read_b128 v[24:27], v12 offset:0
    ds_read_b128 v[28:31], v12 offset:2048
    ds_read_b128 v[32:35], v12 offset:4096
    ds_read_b128 v[36:39], v12 offset:6144
    ds_read_b128 v[40:43], v12 offset:8192
    v_mfma_f32_16x16x32_bf16 a[0:3], v[72:75], v[52:55], a[0:3]
    v_mfma_f32_16x16x32_bf16 a[4:7], v[76:79], v[52:55], a[4:7]
    v_mfma_f32_16x16x32_bf16 a[8:11], v[72:75], v[56:59], a[8:11]
    v_mfma_f32_16x16x32_bf16 a[12:15], v[76:79], v[56:59], a[12:15]
    v_mfma_f32_16x16x32_bf16 a[16:19], v[72:75], v[60:63], a[16:19]
    v_mfma_f32_16x16x32_bf16 a[20:23], v[76:79], v[60:63], a[20:23]
    v_mfma_f32_16x16x32_bf16 a[24:27], v[72:75], v[64:67], a[24:27]
    v_mfma_f32_16x16x32_bf16 a[28:31], v[76:79], v[64:67], a[28:31]
    v_mfma_f32_16x16x32_bf16 a[32:35], v[72:75], v[68:71], a[32:35]
    v_mfma_f32_16x16x32_bf16 a[36:39], v[76:79], v[68:71], a[36:39]
    ds_read_b128 v[72:75], v19 offset:8192
    ds_read_b128 v[76:79], v19 offset:8704
    ds_read_b128 v[52:55], v13 offset:0
    ds_read_b128 v[56:59], v13 offset:2048
    ds_read_b128 v[60:63], v13 offset:4096
    ds_read_b128 v[64:67], v13 offset:6144
    ds_read_b128 v[68:71], v13 offset:8192
    s_waitcnt lgkmcnt(7)
    v_mfma_f32_16x16x32_bf16 a[0:3], v[44:47], v[24:27], a[0:3]
    v_mfma_f32_16x16x32_bf16 a[4:7], v[48:51], v[24:27], a[4:7]
    v_mfma_f32_16x16x32_bf16 a[8:11], v[44:47], v[28:31], a[8:11]
    v_mfma_f32_16x16x32_bf16 a[12:15], v[48:51], v[28:31], a[12:15]
    v_mfma_f32_16x16x32_bf16 a[16:19], v[44:47], v[32:35], a[16:19]
    v_mfma_f32_16x16x32_bf16 a[20:23], v[48:51], v[32:35], a[20:23]
    v_mfma_f32_16x16x32_bf16 a[24:27], v[44:47], v[36:39], a[24:27]
    v_mfma_f32_16x16x32_bf16 a[28:31], v[48:51], v[36:39], a[28:31]
    v_mfma_f32_16x16x32_bf16 a[32:35], v[44:47], v[40:43], a[32:35]
    v_mfma_f32_16x16x32_bf16 a[36:39], v[48:51], v[40:43], a[36:39]
    s_waitcnt lgkmcnt(0)
    s_barrier
    ds_read_b128 v[44:47], v18 offset:16384
    ds_read_b128 v[48:51], v18 offset:16896
    ds_read_b128 v[24:27], v14 offset:0
    ds_read_b128 v[28:31], v14 offset:2048
    ds_read_b128 v[32:35], v14 offset:4096
    ds_read_b128 v[36:39], v14 offset:6144
    ds_read_b128 v[40:43], v14 offset:8192
    v_mfma_f32_16x16x32_bf16 a[0:3], v[72:75], v[52:55], a[0:3]
    v_mfma_f32_16x16x32_bf16 a[4:7], v[76:79], v[52:55], a[4:7]
    v_mfma_f32_16x16x32_bf16 a[8:11], v[72:75], v[56:59], a[8:11]
    v_mfma_f32_16x16x32_bf16 a[12:15], v[76:79], v[56:59], a[12:15]
    v_mfma_f32_16x16x32_bf16 a[16:19], v[72:75], v[60:63], a[16:19]
    v_mfma_f32_16x16x32_bf16 a[20:23], v[76:79], v[60:63], a[20:23]
    v_mfma_f32_16x16x32_bf16 a[24:27], v[72:75], v[64:67], a[24:27]
    v_mfma_f32_16x16x32_bf16 a[28:31], v[76:79], v[64:67], a[28:31]
    v_mfma_f32_16x16x32_bf16 a[32:35], v[72:75], v[68:71], a[32:35]
    v_mfma_f32_16x16x32_bf16 a[36:39], v[76:79], v[68:71], a[36:39]
    ds_read_b128 v[72:75], v19 offset:16384
    ds_read_b128 v[76:79], v19 offset:16896
    ds_read_b128 v[52:55], v15 offset:0
    ds_read_b128 v[56:59], v15 offset:2048
    ds_read_b128 v[60:63], v15 offset:4096
    ds_read_b128 v[64:67], v15 offset:6144
    ds_read_b128 v[68:71], v15 offset:8192
    s_waitcnt lgkmcnt(7)
    v_mfma_f32_16x16x32_bf16 a[0:3], v[44:47], v[24:27], a[0:3]
    v_mfma_f32_16x16x32_bf16 a[4:7], v[48:51], v[24:27], a[4:7]
    v_mfma_f32_16x16x32_bf16 a[8:11], v[44:47], v[28:31], a[8:11]
    v_mfma_f32_16x16x32_bf16 a[12:15], v[48:51], v[28:31], a[12:15]
    v_mfma_f32_16x16x32_bf16 a[16:19], v[44:47], v[32:35], a[16:19]
    v_mfma_f32_16x16x32_bf16 a[20:23], v[48:51], v[32:35], a[20:23]
    v_mfma_f32_16x16x32_bf16 a[24:27], v[44:47], v[36:39], a[24:27]
    v_mfma_f32_16x16x32_bf16 a[28:31], v[48:51], v[36:39], a[28:31]
    v_mfma_f32_16x16x32_bf16 a[32:35], v[44:47], v[40:43], a[32:35]
    v_mfma_f32_16x16x32_bf16 a[36:39], v[48:51], v[40:43], a[36:39]
    s_waitcnt lgkmcnt(0)
    s_barrier
    ds_read_b128 v[44:47], v18 offset:24576
    ds_read_b128 v[48:51], v18 offset:25088
    ds_read_b128 v[24:27], v8 offset:0
    ds_read_b128 v[28:31], v8 offset:2048
    ds_read_b128 v[32:35], v8 offset:4096
    ds_read_b128 v[36:39], v8 offset:6144
    ds_read_b128 v[40:43], v8 offset:8192
    v_mfma_f32_16x16x32_bf16 a[0:3], v[72:75], v[52:55], a[0:3]
    v_mfma_f32_16x16x32_bf16 a[4:7], v[76:79], v[52:55], a[4:7]
    v_mfma_f32_16x16x32_bf16 a[8:11], v[72:75], v[56:59], a[8:11]
    v_mfma_f32_16x16x32_bf16 a[12:15], v[76:79], v[56:59], a[12:15]
    v_mfma_f32_16x16x32_bf16 a[16:19], v[72:75], v[60:63], a[16:19]
    v_mfma_f32_16x16x32_bf16 a[20:23], v[76:79], v[60:63], a[20:23]
    v_mfma_f32_16x16x32_bf16 a[24:27], v[72:75], v[64:67], a[24:27]
    v_mfma_f32_16x16x32_bf16 a[28:31], v[76:79], v[64:67], a[28:31]
    v_mfma_f32_16x16x32_bf16 a[32:35], v[72:75], v[68:71], a[32:35]
    v_mfma_f32_16x16x32_bf16 a[36:39], v[76:79], v[68:71], a[36:39]
    ds_read_b128 v[72:75], v19 offset:24576
    ds_read_b128 v[76:79], v19 offset:25088
    ds_read_b128 v[52:55], v9 offset:0
    ds_read_b128 v[56:59], v9 offset:2048
    ds_read_b128 v[60:63], v9 offset:4096
    ds_read_b128 v[64:67], v9 offset:6144
    ds_read_b128 v[68:71], v9 offset:8192
    s_waitcnt lgkmcnt(7)
    v_mfma_f32_16x16x32_bf16 a[0:3], v[44:47], v[24:27], a[0:3]
    v_mfma_f32_16x16x32_bf16 a[4:7], v[48:51], v[24:27], a[4:7]
    v_mfma_f32_16x16x32_bf16 a[8:11], v[44:47], v[28:31], a[8:11]
    v_mfma_f32_16x16x32_bf16 a[12:15], v[48:51], v[28:31], a[12:15]
    v_mfma_f32_16x16x32_bf16 a[16:19], v[44:47], v[32:35], a[16:19]
    v_mfma_f32_16x16x32_bf16 a[20:23], v[48:51], v[32:35], a[20:23]
    v_mfma_f32_16x16x32_bf16 a[24:27], v[44:47], v[36:39], a[24:27]
    v_mfma_f32_16x16x32_bf16 a[28:31], v[48:51], v[36:39], a[28:31]
    v_mfma_f32_16x16x32_bf16 a[32:35], v[44:47], v[40:43], a[32:35]
    v_mfma_f32_16x16x32_bf16 a[36:39], v[48:51], v[40:43], a[36:39]
    s_waitcnt lgkmcnt(0)
    s_barrier
    ds_read_b128 v[44:47], v18 offset:32768
    ds_read_b128 v[48:51], v18 offset:33280
    ds_read_b128 v[24:27], v10 offset:0
    ds_read_b128 v[28:31], v10 offset:2048
    ds_read_b128 v[32:35], v10 offset:4096
    ds_read_b128 v[36:39], v10 offset:6144
    ds_read_b128 v[40:43], v10 offset:8192
    v_mfma_f32_16x16x32_bf16 a[0:3], v[72:75], v[52:55], a[0:3]
    v_mfma_f32_16x16x32_bf16 a[4:7], v[76:79], v[52:55], a[4:7]
    v_mfma_f32_16x16x32_bf16 a[8:11], v[72:75], v[56:59], a[8:11]
    v_mfma_f32_16x16x32_bf16 a[12:15], v[76:79], v[56:59], a[12:15]
    v_mfma_f32_16x16x32_bf16 a[16:19], v[72:75], v[60:63], a[16:19]
    v_mfma_f32_16x16x32_bf16 a[20:23], v[76:79], v[60:63], a[20:23]
    v_mfma_f32_16x16x32_bf16 a[24:27], v[72:75], v[64:67], a[24:27]
    v_mfma_f32_16x16x32_bf16 a[28:31], v[76:79], v[64:67], a[28:31]
    v_mfma_f32_16x16x32_bf16 a[32:35], v[72:75], v[68:71], a[32:35]
    v_mfma_f32_16x16x32_bf16 a[36:39], v[76:79], v[68:71], a[36:39]
    ds_read_b128 v[72:75], v19 offset:32768
    ds_read_b128 v[76:79], v19 offset:33280
    ds_read_b128 v[52:55], v11 offset:0
    ds_read_b128 v[56:59], v11 offset:2048
    ds_read_b128 v[60:63], v11 offset:4096
    ds_read_b128 v[64:67], v11 offset:6144
    ds_read_b128 v[68:71], v11 offset:8192
    s_waitcnt lgkmcnt(7)
    v_mfma_f32_16x16x32_bf16 a[0:3], v[44:47], v[24:27], a[0:3]
    v_mfma_f32_16x16x32_bf16 a[4:7], v[48:51], v[24:27], a[4:7]
    v_mfma_f32_16x16x32_bf16 a[8:11], v[44:47], v[28:31], a[8:11]
    v_mfma_f32_16x16x32_bf16 a[12:15], v[48:51], v[28:31], a[12:15]
    v_mfma_f32_16x16x32_bf16 a[16:19], v[44:47], v[32:35], a[16:19]
    v_mfma_f32_16x16x32_bf16 a[20:23], v[48:51], v[32:35], a[20:23]
    v_mfma_f32_16x16x32_bf16 a[24:27], v[44:47], v[36:39], a[24:27]
    v_mfma_f32_16x16x32_bf16 a[28:31], v[48:51], v[36:39], a[28:31]
    v_mfma_f32_16x16x32_bf16 a[32:35], v[44:47], v[40:43], a[32:35]
    v_mfma_f32_16x16x32_bf16 a[36:39], v[48:51], v[40:43], a[36:39]
    s_waitcnt lgkmcnt(0)
    v_mfma_f32_16x16x32_bf16 a[0:3], v[72:75], v[52:55], a[0:3]
    v_mfma_f32_16x16x32_bf16 a[4:7], v[76:79], v[52:55], a[4:7]
    v_mfma_f32_16x16x32_bf16 a[8:11], v[72:75], v[56:59], a[8:11]
    v_mfma_f32_16x16x32_bf16 a[12:15], v[76:79], v[56:59], a[12:15]
    v_mfma_f32_16x16x32_bf16 a[16:19], v[72:75], v[60:63], a[16:19]
    v_mfma_f32_16x16x32_bf16 a[20:23], v[76:79], v[60:63], a[20:23]
    v_mfma_f32_16x16x32_bf16 a[24:27], v[72:75], v[64:67], a[24:27]
    v_mfma_f32_16x16x32_bf16 a[28:31], v[76:79], v[64:67], a[28:31]
    v_mfma_f32_16x16x32_bf16 a[32:35], v[72:75], v[68:71], a[32:35]
    v_mfma_f32_16x16x32_bf16 a[36:39], v[76:79], v[68:71], a[36:39]
    s_nop 7
    s_nop 7
    s_mul_i32 s44, s42, 80
    v_add_u32 v4, s44, v2
    v_lshlrev_b32 v4, 12, v4
    v_lshl_add_u32 v4, v3, 4, v4
    s_lshl_b32 s46, s43, 6
    v_add_u32 v4, s46, v4
    v_accvgpr_read_b32 v24, a0
    v_accvgpr_read_b32 v25, a1
    v_cvt_pk_bf16_f32 v80, v24, v25
    v_accvgpr_read_b32 v24, a2
    v_accvgpr_read_b32 v25, a3
    v_cvt_pk_bf16_f32 v81, v24, v25
    v_accvgpr_read_b32 v24, a4
    v_accvgpr_read_b32 v25, a5
    v_cvt_pk_bf16_f32 v82, v24, v25
    v_accvgpr_read_b32 v24, a6
    v_accvgpr_read_b32 v25, a7
    v_cvt_pk_bf16_f32 v83, v24, v25
    s_mov_b32 s46, 0
    buffer_store_dwordx4 v[80:83], v4, s[16:19], s46 offen
    v_accvgpr_read_b32 v24, a8
    v_accvgpr_read_b32 v25, a9
    v_cvt_pk_bf16_f32 v84, v24, v25
    v_accvgpr_read_b32 v24, a10
    v_accvgpr_read_b32 v25, a11
    v_cvt_pk_bf16_f32 v85, v24, v25
    v_accvgpr_read_b32 v24, a12
    v_accvgpr_read_b32 v25, a13
    v_cvt_pk_bf16_f32 v86, v24, v25
    v_accvgpr_read_b32 v24, a14
    v_accvgpr_read_b32 v25, a15
    v_cvt_pk_bf16_f32 v87, v24, v25
    s_mov_b32 s46, 65536
    buffer_store_dwordx4 v[84:87], v4, s[16:19], s46 offen
    v_accvgpr_read_b32 v24, a16
    v_accvgpr_read_b32 v25, a17
    v_cvt_pk_bf16_f32 v88, v24, v25
    v_accvgpr_read_b32 v24, a18
    v_accvgpr_read_b32 v25, a19
    v_cvt_pk_bf16_f32 v89, v24, v25
    v_accvgpr_read_b32 v24, a20
    v_accvgpr_read_b32 v25, a21
    v_cvt_pk_bf16_f32 v90, v24, v25
    v_accvgpr_read_b32 v24, a22
    v_accvgpr_read_b32 v25, a23
    v_cvt_pk_bf16_f32 v91, v24, v25
    s_mov_b32 s46, 131072
    buffer_store_dwordx4 v[88:91], v4, s[16:19], s46 offen
    v_accvgpr_read_b32 v24, a24
    v_accvgpr_read_b32 v25, a25
    v_cvt_pk_bf16_f32 v92, v24, v25
    v_accvgpr_read_b32 v24, a26
    v_accvgpr_read_b32 v25, a27
    v_cvt_pk_bf16_f32 v93, v24, v25
    v_accvgpr_read_b32 v24, a28
    v_accvgpr_read_b32 v25, a29
    v_cvt_pk_bf16_f32 v94, v24, v25
    v_accvgpr_read_b32 v24, a30
    v_accvgpr_read_b32 v25, a31
    v_cvt_pk_bf16_f32 v95, v24, v25
    s_mov_b32 s46, 196608
    buffer_store_dwordx4 v[92:95], v4, s[16:19], s46 offen
    v_accvgpr_read_b32 v24, a32
    v_accvgpr_read_b32 v25, a33
    v_cvt_pk_bf16_f32 v96, v24, v25
    v_accvgpr_read_b32 v24, a34
    v_accvgpr_read_b32 v25, a35
    v_cvt_pk_bf16_f32 v97, v24, v25
    v_accvgpr_read_b32 v24, a36
    v_accvgpr_read_b32 v25, a37
    v_cvt_pk_bf16_f32 v98, v24, v25
    v_accvgpr_read_b32 v24, a38
    v_accvgpr_read_b32 v25, a39
    v_cvt_pk_bf16_f32 v99, v24, v25
    s_mov_b32 s46, 262144
    buffer_store_dwordx4 v[96:99], v4, s[16:19], s46 offen
gemma_kernel_end:
    s_endpgm
.globl gemmb_kernel
.p2align 8
.type gemmb_kernel,@function
gemmb_kernel:
    s_cmp_ge_u32 s2, 256
    s_cbranch_scc1 gemmb_kernel_end
    v_lshrrev_b32 v1, 6, v0
    s_nop 0
    v_readfirstlane_b32 s40, v1
    v_and_b32 v1, 63, v0
    v_and_b32 v2, 15, v1
    v_lshrrev_b32 v3, 4, v1
    s_load_dwordx2 s[48:49], s[0:1], 96
    s_load_dwordx2 s[50:51], s[0:1], 8
    s_load_dwordx2 s[52:53], s[0:1], 16
    s_waitcnt lgkmcnt(0)
    s_and_b32 s3, s2, 7
    s_lshr_b32 s4, s2, 3
    s_and_b32 s5, s3, 1
    s_lshr_b32 s6, s3, 1
    s_lshl_b32 s6, s6, 2
    s_and_b32 s7, s4, 3
    s_add_u32 s6, s6, s7
    s_lshr_b32 s7, s4, 2
    s_add_u32 s8, s48, 6684672
    s_addc_u32 s9, s49, 0
    s_mov_b32 s10, 327680
    s_mov_b32 s11, 0x00020000
    s_mul_i32 s20, s5, 2621440
    s_mul_i32 s21, s7, 327680
    s_add_u32 s20, s20, s21
    s_add_u32 s8, s8, s20
    s_addc_u32 s9, s9, 0
    s_cmp_eq_u32 s5, 1
    s_cselect_b32 s12, s52, s50
    s_cselect_b32 s13, s53, s51
    s_mov_b32 s14, 524288
    s_mov_b32 s15, 0x00020000
    s_mul_i32 s20, s6, 524288
    s_add_u32 s12, s12, s20
    s_addc_u32 s13, s13, 0
    s_add_u32 s16, s48, 11927552
    s_addc_u32 s17, s49, 0
    s_mov_b32 s18, 163840
    s_mov_b32 s19, 0x00020000
    s_mul_i32 s20, s5, 2621440
    s_mul_i32 s21, s6, 163840
    s_add_u32 s20, s20, s21
    s_mul_i32 s21, s7, 160
    s_add_u32 s20, s20, s21
    s_add_u32 s16, s16, s20
    s_addc_u32 s17, s17, 0
    s_cmp_lt_u32 s40, 4
    s_cbranch_scc1 gemmb_kernel_comp
    s_sub_u32 s40, s40, 4
    v_lshrrev_b32 v4, 3, v1
    v_and_b32 v5, 7, v1
    v_and_b32 v6, 1, v3
    v_xor_b32 v6, v6, v5
    v_xor_b32 v7, v3, v5
    s_movk_i32 s46, 4096
    v_mul_lo_u32 v26, v4, s46
    s_movk_i32 s46, 4096
    v_mul_lo_u32 v27, v4, s46
    s_mul_i32 s44, s40, 2
    s_mul_i32 s45, s40, 32768
    s_mul_i32 s64, s40, 1024
    v_xor_b32 v28, s44, v6
    v_lshl_add_u32 v28, v28, 4, v26
    v_add_u32 v8, s45, v28
    s_add_u32 m0, s64, 0
    s_movk_i32 s46, 0
    buffer_load_dwordx4 v8, s[8:11], s46 offen lds
    s_mul_i32 s44, s40, 2
    s_mul_i32 s45, s40, 32768
    s_add_u32 s45, s45, 131072
    s_mul_i32 s65, s40, 1024
    s_add_u32 s65, s65, 4096
    v_xor_b32 v28, s44, v6
    v_lshl_add_u32 v28, v28, 4, v26
    v_add_u32 v9, s45, v28
    s_add_u32 m0, s65, 0
    s_movk_i32 s46, 0
    buffer_load_dwordx4 v9, s[8:11], s46 offen lds
    s_mov_b32 s44, 0
    s_cmp_eq_u32 s40, 1
    s_cselect_b32 s44, 4, s44
    s_cmp_eq_u32 s40, 2
    s_cselect_b32 s44, 0, s44
    s_cmp_eq_u32 s40, 3
    s_cselect_b32 s44, 2, s44
    s_mov_b32 s45, 262144
    s_cmp_eq_u32 s40, 1
    s_cselect_b32 s45, 294912, s45
    s_cmp_eq_u32 s40, 2
    s_cselect_b32 s45, 128, s45
    s_cmp_eq_u32 s40, 3
    s_cselect_b32 s45, 32896, s45
    s_mul_i32 s66, s40, 1024
    s_add_u32 s66, s66, 8192
    s_mov_b32 s47, 0
    s_cmp_eq_u32 s40, 1
    s_cselect_b32 s47, 0, s47
    s_cmp_eq_u32 s40, 2
    s_cselect_b32 s47, 1, s47
    s_cmp_eq_u32 s40, 3
    s_cselect_b32 s47, 1, s47
    s_cmp_eq_u32 s47, 1
    s_cselect_b64 vcc, -1, 0
    v_cndmask_b32 v28, v7, v6, vcc
    v_xor_b32 v28, s44, v28
    v_lshl_add_u32 v28, v28, 4, v26
    v_add_u32 v10, s45, v28
    s_add_u32 m0, s66, 0
    s_movk_i32 s46, 0
    buffer_load_dwordx4 v10, s[8:11], s46 offen lds
    s_mov_b32 s44, 4
    s_cmp_eq_u32 s40, 1
    s_cselect_b32 s44, 6, s44
    s_cmp_eq_u32 s40, 2
    s_cselect_b32 s44, 0, s44
    s_cmp_eq_u32 s40, 3
    s_cselect_b32 s44, 2, s44
    s_mul_i32 s45, s40, 32768
    s_add_u32 s45, s45, 65664
    s_mul_i32 s67, s40, 1024
    s_add_u32 s67, s67, 12288
    v_xor_b32 v28, s44, v6
    v_lshl_add_u32 v28, v28, 4, v26
    v_add_u32 v11, s45, v28
    s_add_u32 m0, s67, 0
    s_movk_i32 s46, 0
    buffer_load_dwordx4 v11, s[8:11], s46 offen lds
    s_mov_b32 s44, 4
    s_cmp_eq_u32 s40, 1
    s_cselect_b32 s44, 6, s44
    s_cmp_eq_u32 s40, 2
    s_cselect_b32 s44, 0, s44
    s_cmp_eq_u32 s40, 3
    s_cselect_b32 s44, 4, s44
    s_mul_i32 s45, s40, 32768
    s_add_u32 s45, s45, 196736
    s_mul_i32 s68, s40, 1024
    s_add_u32 s68, s68, 16384
    s_mov_b32 s47, 1
    s_cmp_eq_u32 s40, 1
    s_cselect_b32 s47, 1, s47
    s_cmp_eq_u32 s40, 2
    s_cselect_b32 s47, 0, s47
    s_cmp_eq_u32 s40, 3
    s_cselect_b32 s47, 0, s47
    s_cmp_eq_u32 s47, 1
    s_cselect_b64 vcc, -1, 0
    v_cndmask_b32 v28, v7, v6, vcc
    v_xor_b32 v28, s44, v28
    v_lshl_add_u32 v28, v28, 4, v26
    v_add_u32 v12, s45, v28
    s_add_u32 m0, s68, 0
    s_movk_i32 s46, 0
    buffer_load_dwordx4 v12, s[8:11], s46 offen lds
    s_mov_b32 s44, 0
    s_cmp_eq_u32 s40, 1
    s_cselect_b32 s44, 4, s44
    s_cmp_eq_u32 s40, 2
    s_cselect_b32 s44, 0, s44
    s_cmp_eq_u32 s40, 3
    s_cselect_b32 s44, 4, s44
    s_mul_i32 s45, s40, 32768
    s_mul_i32 s69, s40, 1024
    s_add_u32 s69, s69, 20480
    v_xor_b32 v28, s44, v7
    v_lshl_add_u32 v28, v28, 4, v27
    v_add_u32 v13, s45, v28
    s_add_u32 m0, s69, 0
    s_movk_i32 s46, 0
    buffer_load_dwordx4 v13, s[12:15], s46 offen lds
    s_mov_b32 s44, 0
    s_cmp_eq_u32 s40, 1
    s_cselect_b32 s44, 4, s44
    s_cmp_eq_u32 s40, 2
    s_cselect_b32 s44, 0, s44
    s_cmp_eq_u32 s40, 3
    s_cselect_b32 s44, 4, s44
    s_mul_i32 s45, s40, 32768
    s_add_u32 s45, s45, 131072
    s_mul_i32 s70, s40, 1024
    s_add_u32 s70, s70, 24576
    v_xor_b32 v28, s44, v7
    v_lshl_add_u32 v28, v28, 4, v27
    v_add_u32 v14, s45, v28
    s_add_u32 m0, s70, 0
    s_movk_i32 s46, 0
    buffer_load_dwordx4 v14, s[12:15], s46 offen lds
    s_mov_b32 s44, 0
    s_cmp_eq_u32 s40, 1
    s_cselect_b32 s44, 4, s44
    s_cmp_eq_u32 s40, 2
    s_cselect_b32 s44, 0, s44
    s_cmp_eq_u32 s40, 3
    s_cselect_b32 s44, 4, s44
    s_mul_i32 s45, s40, 32768
    s_add_u32 s45, s45, 262144
    s_mul_i32 s71, s40, 1024
    s_add_u32 s71, s71, 28672
    v_xor_b32 v28, s44, v7
    v_lshl_add_u32 v28, v28, 4, v27
    v_add_u32 v15, s45, v28
    s_add_u32 m0, s71, 0
    s_movk_i32 s46, 0
    buffer_load_dwordx4 v15, s[12:15], s46 offen lds
    s_mov_b32 s44, 0
    s_cmp_eq_u32 s40, 1
    s_cselect_b32 s44, 4, s44
    s_cmp_eq_u32 s40, 2
    s_cselect_b32 s44, 0, s44
    s_cmp_eq_u32 s40, 3
    s_cselect_b32 s44, 4, s44
    s_mul_i32 s45, s40, 32768
    s_add_u32 s45, s45, 393216
    s_mul_i32 s72, s40, 1024
    s_add_u32 s72, s72, 32768
    v_xor_b32 v28, s44, v7
    v_lshl_add_u32 v28, v28, 4, v27
    v_add_u32 v16, s45, v28
    s_add_u32 m0, s72, 0
    s_movk_i32 s46, 0
    buffer_load_dwordx4 v16, s[12:15], s46 offen lds
    s_mov_b32 s44, 0
    s_cmp_eq_u32 s40, 1
    s_cselect_b32 s44, 4, s44
    s_cmp_eq_u32 s40, 2
    s_cselect_b32 s44, 0, s44
    s_cmp_eq_u32 s40, 3
    s_cselect_b32 s44, 4, s44
    s_mul_i32 s45, s40, 32768
    s_add_u32 s45, s45, 128
    s_mul_i32 s73, s40, 1024
    s_add_u32 s73, s73, 36864
    v_xor_b32 v28, s44, v7
    v_lshl_add_u32 v28, v28, 4, v27
    v_add_u32 v17, s45, v28
    s_add_u32 m0, s73, 0
    s_movk_i32 s46, 0
    buffer_load_dwordx4 v17, s[12:15], s46 offen lds
    s_mov_b32 s44, 0
    s_cmp_eq_u32 s40, 1
    s_cselect_b32 s44, 4, s44
    s_cmp_eq_u32 s40, 2
    s_cselect_b32 s44, 0, s44
    s_cmp_eq_u32 s40, 3
    s_cselect_b32 s44, 4, s44
    s_mul_i32 s45, s40, 32768
    s_add_u32 s45, s45, 131200
    s_mul_i32 s74, s40, 1024
    s_add_u32 s74, s74, 40960
    v_xor_b32 v28, s44, v7
    v_lshl_add_u32 v28, v28, 4, v27
    v_add_u32 v18, s45, v28
    s_add_u32 m0, s74, 0
    s_movk_i32 s46, 0
    buffer_load_dwordx4 v18, s[12:15], s46 offen lds
    s_mov_b32 s44, 0
    s_cmp_eq_u32 s40, 1
    s_cselect_b32 s44, 4, s44
    s_cmp_eq_u32 s40, 2
    s_cselect_b32 s44, 0, s44
    s_cmp_eq_u32 s40, 3
    s_cselect_b32 s44, 4, s44
    s_mul_i32 s45, s40, 32768
    s_add_u32 s45, s45, 262272
    s_mul_i32 s75, s40, 1024
    s_add_u32 s75, s75, 45056
    v_xor_b32 v28, s44, v7
    v_lshl_add_u32 v28, v28, 4, v27
    v_add_u32 v19, s45, v28
    s_add_u32 m0, s75, 0
    s_movk_i32 s46, 0
    buffer_load_dwordx4 v19, s[12:15], s46 offen lds
    s_mov_b32 s44, 0
    s_cmp_eq_u32 s40, 1
    s_cselect_b32 s44, 4, s44
    s_cmp_eq_u32 s40, 2
    s_cselect_b32 s44, 0, s44
    s_cmp_eq_u32 s40, 3
    s_cselect_b32 s44, 4, s44
    s_mul_i32 s45, s40, 32768
    s_add_u32 s45, s45, 393344
    s_mul_i32 s76, s40, 1024
    s_add_u32 s76, s76, 49152
    v_xor_b32 v28, s44, v7
    v_lshl_add_u32 v28, v28, 4, v27
    v_add_u32 v20, s45, v28
    s_add_u32 m0, s76, 0
    s_movk_i32 s46, 0
    buffer_load_dwordx4 v20, s[12:15], s46 offen lds
    s_add_u32 m0, s64, 53248
    s_movk_i32 s46, 256
    buffer_load_dwordx4 v8, s[8:11], s46 offen lds
    s_add_u32 m0, s65, 53248
    s_movk_i32 s46, 256
    buffer_load_dwordx4 v9, s[8:11], s46 offen lds
    s_add_u32 m0, s66, 53248
    s_movk_i32 s46, 256
    buffer_load_dwordx4 v10, s[8:11], s46 offen lds
    s_add_u32 m0, s67, 53248
    s_movk_i32 s46, 256
    buffer_load_dwordx4 v11, s[8:11], s46 offen lds
    s_add_u32 m0, s68, 53248
    s_movk_i32 s46, 256
    buffer_load_dwordx4 v12, s[8:11], s46 offen lds
    s_add_u32 m0, s69, 53248
    s_movk_i32 s46, 256
    buffer_load_dwordx4 v13, s[12:15], s46 offen lds
    s_add_u32 m0, s70, 53248
    s_movk_i32 s46, 256
    buffer_load_dwordx4 v14, s[12:15], s46 offen lds
    s_add_u32 m0, s71, 53248
    s_movk_i32 s46, 256
    buffer_load_dwordx4 v15, s[12:15], s46 offen lds
    s_add_u32 m0, s72, 53248
    s_movk_i32 s46, 256
    buffer_load_dwordx4 v16, s[12:15], s46 offen lds
    s_add_u32 m0, s73, 53248
    s_movk_i32 s46, 256
    buffer_load_dwordx4 v17, s[12:15], s46 offen lds
    s_add_u32 m0, s74, 53248
    s_movk_i32 s46, 256
    buffer_load_dwordx4 v18, s[12:15], s46 offen lds
    s_add_u32 m0, s75, 53248
    s_movk_i32 s46, 256
    buffer_load_dwordx4 v19, s[12:15], s46 offen lds
    s_add_u32 m0, s76, 53248
    s_movk_i32 s46, 256
    buffer_load_dwordx4 v20, s[12:15], s46 offen lds
    s_waitcnt vmcnt(13)
    s_barrier
    s_add_u32 m0, s64, 106496
    s_movk_i32 s46, 512
    buffer_load_dwordx4 v8, s[8:11], s46 offen lds
    s_add_u32 m0, s65, 106496
    s_movk_i32 s46, 512
    buffer_load_dwordx4 v9, s[8:11], s46 offen lds
    s_add_u32 m0, s66, 106496
    s_movk_i32 s46, 512
    buffer_load_dwordx4 v10, s[8:11], s46 offen lds
    s_add_u32 m0, s67, 106496
    s_movk_i32 s46, 512
    buffer_load_dwordx4 v11, s[8:11], s46 offen lds
    s_add_u32 m0, s68, 106496
    s_movk_i32 s46, 512
    buffer_load_dwordx4 v12, s[8:11], s46 offen lds
    s_add_u32 m0, s69, 106496
    s_movk_i32 s46, 512
    buffer_load_dwordx4 v13, s[12:15], s46 offen lds
    s_add_u32 m0, s70, 106496
    s_movk_i32 s46, 512
    buffer_load_dwordx4 v14, s[12:15], s46 offen lds
    s_add_u32 m0, s71, 106496
    s_movk_i32 s46, 512
    buffer_load_dwordx4 v15, s[12:15], s46 offen lds
    s_add_u32 m0, s72, 106496
    s_movk_i32 s46, 512
    buffer_load_dwordx4 v16, s[12:15], s46 offen lds
    s_add_u32 m0, s73, 106496
    s_movk_i32 s46, 512
    buffer_load_dwordx4 v17, s[12:15], s46 offen lds
    s_add_u32 m0, s74, 106496
    s_movk_i32 s46, 512
    buffer_load_dwordx4 v18, s[12:15], s46 offen lds
    s_add_u32 m0, s75, 106496
    s_movk_i32 s46, 512
    buffer_load_dwordx4 v19, s[12:15], s46 offen lds
    s_add_u32 m0, s76, 106496
    s_movk_i32 s46, 512
    buffer_load_dwordx4 v20, s[12:15], s46 offen lds
    s_waitcnt vmcnt(13)
    s_barrier
    s_add_u32 m0, s64, 0
    s_movk_i32 s46, 768
    buffer_load_dwordx4 v8, s[8:11], s46 offen lds
    s_add_u32 m0, s65, 0
    s_movk_i32 s46, 768
    buffer_load_dwordx4 v9, s[8:11], s46 offen lds
    s_add_u32 m0, s66, 0
    s_movk_i32 s46, 768
    buffer_load_dwordx4 v10, s[8:11], s46 offen lds
    s_add_u32 m0, s67, 0
    s_movk_i32 s46, 768
    buffer_load_dwordx4 v11, s[8:11], s46 offen lds
    s_add_u32 m0, s68, 0
    s_movk_i32 s46, 768
    buffer_load_dwordx4 v12, s[8:11], s46 offen lds
    s_add_u32 m0, s69, 0
    s_movk_i32 s46, 768
    buffer_load_dwordx4 v13, s[12:15], s46 offen lds
    s_add_u32 m0, s70, 0
    s_movk_i32 s46, 768
    buffer_load_dwordx4 v14, s[12:15], s46 offen lds
    s_add_u32 m0, s71, 0
    s_movk_i32 s46, 768
    buffer_load_dwordx4 v15, s[12:15], s46 offen lds
    s_add_u32 m0, s72, 0
    s_movk_i32 s46, 768
    buffer_load_dwordx4 v16, s[12:15], s46 offen lds
    s_add_u32 m0, s73, 0
    s_movk_i32 s46, 768
    buffer_load_dwordx4 v17, s[12:15], s46 offen lds
    s_add_u32 m0, s74, 0
    s_movk_i32 s46, 768
    buffer_load_dwordx4 v18, s[12:15], s46 offen lds
    s_add_u32 m0, s75, 0
    s_movk_i32 s46, 768
    buffer_load_dwordx4 v19, s[12:15], s46 offen lds
    s_add_u32 m0, s76, 0
    s_movk_i32 s46, 768
    buffer_load_dwordx4 v20, s[12:15], s46 offen lds
    s_waitcnt vmcnt(13)
    s_barrier
    s_add_u32 m0, s64, 53248
    s_movk_i32 s46, 1024
    buffer_load_dwordx4 v8, s[8:11], s46 offen lds
    s_add_u32 m0, s65, 53248
    s_movk_i32 s46, 1024
    buffer_load_dwordx4 v9, s[8:11], s46 offen lds
    s_add_u32 m0, s66, 53248
    s_movk_i32 s46, 1024
    buffer_load_dwordx4 v10, s[8:11], s46 offen lds
    s_add_u32 m0, s67, 53248
    s_movk_i32 s46, 1024
    buffer_load_dwordx4 v11, s[8:11], s46 offen lds
    s_add_u32 m0, s68, 53248
    s_movk_i32 s46, 1024
    buffer_load_dwordx4 v12, s[8:11], s46 offen lds
    s_add_u32 m0, s69, 53248
    s_movk_i32 s46, 1024
    buffer_load_dwordx4 v13, s[12:15], s46 offen lds
    s_add_u32 m0, s70, 53248
    s_movk_i32 s46, 1024
    buffer_load_dwordx4 v14, s[12:15], s46 offen lds
    s_add_u32 m0, s71, 53248
    s_movk_i32 s46, 1024
    buffer_load_dwordx4 v15, s[12:15], s46 offen lds
    s_add_u32 m0, s72, 53248
    s_movk_i32 s46, 1024
    buffer_load_dwordx4 v16, s[12:15], s46 offen lds
    s_add_u32 m0, s73, 53248
    s_movk_i32 s46, 1024
    buffer_load_dwordx4 v17, s[12:15], s46 offen lds
    s_add_u32 m0, s74, 53248
    s_movk_i32 s46, 1024
    buffer_load_dwordx4 v18, s[12:15], s46 offen lds
    s_add_u32 m0, s75, 53248
    s_movk_i32 s46, 1024
    buffer_load_dwordx4 v19, s[12:15], s46 offen lds
    s_add_u32 m0, s76, 53248
    s_movk_i32 s46, 1024
    buffer_load_dwordx4 v20, s[12:15], s46 offen lds
    s_waitcnt vmcnt(13)
    s_barrier
    s_add_u32 m0, s64, 106496
    s_movk_i32 s46, 1280
    buffer_load_dwordx4 v8, s[8:11], s46 offen lds
    s_add_u32 m0, s65, 106496
    s_movk_i32 s46, 1280
    buffer_load_dwordx4 v9, s[8:11], s46 offen lds
    s_add_u32 m0, s66, 106496
    s_movk_i32 s46, 1280
    buffer_load_dwordx4 v10, s[8:11], s46 offen lds
    s_add_u32 m0, s67, 106496
    s_movk_i32 s46, 1280
    buffer_load_dwordx4 v11, s[8:11], s46 offen lds
    s_add_u32 m0, s68, 106496
    s_movk_i32 s46, 1280
    buffer_load_dwordx4 v12, s[8:11], s46 offen lds
    s_add_u32 m0, s69, 106496
    s_movk_i32 s46, 1280
    buffer_load_dwordx4 v13, s[12:15], s46 offen lds
    s_add_u32 m0, s70, 106496
    s_movk_i32 s46, 1280
    buffer_load_dwordx4 v14, s[12:15], s46 offen lds
    s_add_u32 m0, s71, 106496
    s_movk_i32 s46, 1280
    buffer_load_dwordx4 v15, s[12:15], s46 offen lds
    s_add_u32 m0, s72, 106496
    s_movk_i32 s46, 1280
    buffer_load_dwordx4 v16, s[12:15], s46 offen lds
    s_add_u32 m0, s73, 106496
    s_movk_i32 s46, 1280
    buffer_load_dwordx4 v17, s[12:15], s46 offen lds
    s_add_u32 m0, s74, 106496
    s_movk_i32 s46, 1280
    buffer_load_dwordx4 v18, s[12:15], s46 offen lds
    s_add_u32 m0, s75, 106496
    s_movk_i32 s46, 1280
    buffer_load_dwordx4 v19, s[12:15], s46 offen lds
    s_add_u32 m0, s76, 106496
    s_movk_i32 s46, 1280
    buffer_load_dwordx4 v20, s[12:15], s46 offen lds
    s_waitcnt vmcnt(13)
    s_barrier
    s_add_u32 m0, s64, 0
    s_movk_i32 s46, 1536
    buffer_load_dwordx4 v8, s[8:11], s46 offen lds
    s_add_u32 m0, s65, 0
    s_movk_i32 s46, 1536
    buffer_load_dwordx4 v9, s[8:11], s46 offen lds
    s_add_u32 m0, s66, 0
    s_movk_i32 s46, 1536
    buffer_load_dwordx4 v10, s[8:11], s46 offen lds
    s_add_u32 m0, s67, 0
    s_movk_i32 s46, 1536
    buffer_load_dwordx4 v11, s[8:11], s46 offen lds
    s_add_u32 m0, s68, 0
    s_movk_i32 s46, 1536
    buffer_load_dwordx4 v12, s[8:11], s46 offen lds
    s_add_u32 m0, s69, 0
    s_movk_i32 s46, 1536
    buffer_load_dwordx4 v13, s[12:15], s46 offen lds
    s_add_u32 m0, s70, 0
    s_movk_i32 s46, 1536
    buffer_load_dwordx4 v14, s[12:15], s46 offen lds
    s_add_u32 m0, s71, 0
    s_movk_i32 s46, 1536
    buffer_load_dwordx4 v15, s[12:15], s46 offen lds
    s_add_u32 m0, s72, 0
    s_movk_i32 s46, 1536
    buffer_load_dwordx4 v16, s[12:15], s46 offen lds
    s_add_u32 m0, s73, 0
    s_movk_i32 s46, 1536
    buffer_load_dwordx4 v17, s[12:15], s46 offen lds
    s_add_u32 m0, s74, 0
    s_movk_i32 s46, 1536
    buffer_load_dwordx4 v18, s[12:15], s46 offen lds
    s_add_u32 m0, s75, 0
    s_movk_i32 s46, 1536
    buffer_load_dwordx4 v19, s[12:15], s46 offen lds
    s_add_u32 m0, s76, 0
    s_movk_i32 s46, 1536
    buffer_load_dwordx4 v20, s[12:15], s46 offen lds
    s_waitcnt vmcnt(13)
    s_barrier
    s_add_u32 m0, s64, 53248
    s_movk_i32 s46, 1792
    buffer_load_dwordx4 v8, s[8:11], s46 offen lds
    s_add_u32 m0, s65, 53248
    s_movk_i32 s46, 1792
    buffer_load_dwordx4 v9, s[8:11], s46 offen lds
    s_add_u32 m0, s66, 53248
    s_movk_i32 s46, 1792
    buffer_load_dwordx4 v10, s[8:11], s46 offen lds
    s_add_u32 m0, s67, 53248
    s_movk_i32 s46, 1792
    buffer_load_dwordx4 v11, s[8:11], s46 offen lds
    s_add_u32 m0, s68, 53248
    s_movk_i32 s46, 1792
    buffer_load_dwordx4 v12, s[8:11], s46 offen lds
    s_add_u32 m0, s69, 53248
    s_movk_i32 s46, 1792
    buffer_load_dwordx4 v13, s[12:15], s46 offen lds
    s_add_u32 m0, s70, 53248
    s_movk_i32 s46, 1792
    buffer_load_dwordx4 v14, s[12:15], s46 offen lds
    s_add_u32 m0, s71, 53248
    s_movk_i32 s46, 1792
    buffer_load_dwordx4 v15, s[12:15], s46 offen lds
    s_add_u32 m0, s72, 53248
    s_movk_i32 s46, 1792
    buffer_load_dwordx4 v16, s[12:15], s46 offen lds
    s_add_u32 m0, s73, 53248
    s_movk_i32 s46, 1792
    buffer_load_dwordx4 v17, s[12:15], s46 offen lds
    s_add_u32 m0, s74, 53248
    s_movk_i32 s46, 1792
    buffer_load_dwordx4 v18, s[12:15], s46 offen lds
    s_add_u32 m0, s75, 53248
    s_movk_i32 s46, 1792
    buffer_load_dwordx4 v19, s[12:15], s46 offen lds
    s_add_u32 m0, s76, 53248
    s_movk_i32 s46, 1792
    buffer_load_dwordx4 v20, s[12:15], s46 offen lds
    s_waitcnt vmcnt(13)
    s_barrier
    s_add_u32 m0, s64, 106496
    s_movk_i32 s46, 2048
    buffer_load_dwordx4 v8, s[8:11], s46 offen lds
    s_add_u32 m0, s65, 106496
    s_movk_i32 s46, 2048
    buffer_load_dwordx4 v9, s[8:11], s46 offen lds
    s_add_u32 m0, s66, 106496
    s_movk_i32 s46, 2048
    buffer_load_dwordx4 v10, s[8:11], s46 offen lds
    s_add_u32 m0, s67, 106496
    s_movk_i32 s46, 2048
    buffer_load_dwordx4 v11, s[8:11], s46 offen lds
    s_add_u32 m0, s68, 106496
    s_movk_i32 s46, 2048
    buffer_load_dwordx4 v12, s[8:11], s46 offen lds
    s_add_u32 m0, s69, 106496
    s_movk_i32 s46, 2048
    buffer_load_dwordx4 v13, s[12:15], s46 offen lds
    s_add_u32 m0, s70, 106496
    s_movk_i32 s46, 2048
    buffer_load_dwordx4 v14, s[12:15], s46 offen lds
    s_add_u32 m0, s71, 106496
    s_movk_i32 s46, 2048
    buffer_load_dwordx4 v15, s[12:15], s46 offen lds
    s_add_u32 m0, s72, 106496
    s_movk_i32 s46, 2048
    buffer_load_dwordx4 v16, s[12:15], s46 offen lds
    s_add_u32 m0, s73, 106496
    s_movk_i32 s46, 2048
    buffer_load_dwordx4 v17, s[12:15], s46 offen lds
    s_add_u32 m0, s74, 106496
    s_movk_i32 s46, 2048
    buffer_load_dwordx4 v18, s[12:15], s46 offen lds
    s_add_u32 m0, s75, 106496
    s_movk_i32 s46, 2048
    buffer_load_dwordx4 v19, s[12:15], s46 offen lds
    s_add_u32 m0, s76, 106496
    s_movk_i32 s46, 2048
    buffer_load_dwordx4 v20, s[12:15], s46 offen lds
    s_waitcnt vmcnt(13)
    s_barrier
    s_add_u32 m0, s64, 0
    s_movk_i32 s46, 2304
    buffer_load_dwordx4 v8, s[8:11], s46 offen lds
    s_add_u32 m0, s65, 0
    s_movk_i32 s46, 2304
    buffer_load_dwordx4 v9, s[8:11], s46 offen lds
    s_add_u32 m0, s66, 0
    s_movk_i32 s46, 2304
    buffer_load_dwordx4 v10, s[8:11], s46 offen lds
    s_add_u32 m0, s67, 0
    s_movk_i32 s46, 2304
    buffer_load_dwordx4 v11, s[8:11], s46 offen lds
    s_add_u32 m0, s68, 0
    s_movk_i32 s46, 2304
    buffer_load_dwordx4 v12, s[8:11], s46 offen lds
    s_add_u32 m0, s69, 0
    s_movk_i32 s46, 2304
    buffer_load_dwordx4 v13, s[12:15], s46 offen lds
    s_add_u32 m0, s70, 0
    s_movk_i32 s46, 2304
    buffer_load_dwordx4 v14, s[12:15], s46 offen lds
    s_add_u32 m0, s71, 0
    s_movk_i32 s46, 2304
    buffer_load_dwordx4 v15, s[12:15], s46 offen lds
    s_add_u32 m0, s72, 0
    s_movk_i32 s46, 2304
    buffer_load_dwordx4 v16, s[12:15], s46 offen lds
    s_add_u32 m0, s73, 0
    s_movk_i32 s46, 2304
    buffer_load_dwordx4 v17, s[12:15], s46 offen lds
    s_add_u32 m0, s74, 0
    s_movk_i32 s46, 2304
    buffer_load_dwordx4 v18, s[12:15], s46 offen lds
    s_add_u32 m0, s75, 0
    s_movk_i32 s46, 2304
    buffer_load_dwordx4 v19, s[12:15], s46 offen lds
    s_add_u32 m0, s76, 0
    s_movk_i32 s46, 2304
    buffer_load_dwordx4 v20, s[12:15], s46 offen lds
    s_waitcnt vmcnt(13)
    s_barrier
    s_add_u32 m0, s64, 53248
    s_movk_i32 s46, 2560
    buffer_load_dwordx4 v8, s[8:11], s46 offen lds
    s_add_u32 m0, s65, 53248
    s_movk_i32 s46, 2560
    buffer_load_dwordx4 v9, s[8:11], s46 offen lds
    s_add_u32 m0, s66, 53248
    s_movk_i32 s46, 2560
    buffer_load_dwordx4 v10, s[8:11], s46 offen lds
    s_add_u32 m0, s67, 53248
    s_movk_i32 s46, 2560
    buffer_load_dwordx4 v11, s[8:11], s46 offen lds
    s_add_u32 m0, s68, 53248
    s_movk_i32 s46, 2560
    buffer_load_dwordx4 v12, s[8:11], s46 offen lds
    s_add_u32 m0, s69, 53248
    s_movk_i32 s46, 2560
    buffer_load_dwordx4 v13, s[12:15], s46 offen lds
    s_add_u32 m0, s70, 53248
    s_movk_i32 s46, 2560
    buffer_load_dwordx4 v14, s[12:15], s46 offen lds
    s_add_u32 m0, s71, 53248
    s_movk_i32 s46, 2560
    buffer_load_dwordx4 v15, s[12:15], s46 offen lds
    s_add_u32 m0, s72, 53248
    s_movk_i32 s46, 2560
    buffer_load_dwordx4 v16, s[12:15], s46 offen lds
    s_add_u32 m0, s73, 53248
    s_movk_i32 s46, 2560
    buffer_load_dwordx4 v17, s[12:15], s46 offen lds
    s_add_u32 m0, s74, 53248
    s_movk_i32 s46, 2560
    buffer_load_dwordx4 v18, s[12:15], s46 offen lds
    s_add_u32 m0, s75, 53248
    s_movk_i32 s46, 2560
    buffer_load_dwordx4 v19, s[12:15], s46 offen lds
    s_add_u32 m0, s76, 53248
    s_movk_i32 s46, 2560
    buffer_load_dwordx4 v20, s[12:15], s46 offen lds
    s_waitcnt vmcnt(13)
    s_barrier
    s_add_u32 m0, s64, 106496
    s_movk_i32 s46, 2816
    buffer_load_dwordx4 v8, s[8:11], s46 offen lds
    s_add_u32 m0, s65, 106496
    s_movk_i32 s46, 2816
    buffer_load_dwordx4 v9, s[8:11], s46 offen lds
    s_add_u32 m0, s66, 106496
    s_movk_i32 s46, 2816
    buffer_load_dwordx4 v10, s[8:11], s46 offen lds
    s_add_u32 m0, s67, 106496
    s_movk_i32 s46, 2816
    buffer_load_dwordx4 v11, s[8:11], s46 offen lds
    s_add_u32 m0, s68, 106496
    s_movk_i32 s46, 2816
    buffer_load_dwordx4 v12, s[8:11], s46 offen lds
    s_add_u32 m0, s69, 106496
    s_movk_i32 s46, 2816
    buffer_load_dwordx4 v13, s[12:15], s46 offen lds
    s_add_u32 m0, s70, 106496
    s_movk_i32 s46, 2816
    buffer_load_dwordx4 v14, s[12:15], s46 offen lds
    s_add_u32 m0, s71, 106496
    s_movk_i32 s46, 2816
    buffer_load_dwordx4 v15, s[12:15], s46 offen lds
    s_add_u32 m0, s72, 106496
    s_movk_i32 s46, 2816
    buffer_load_dwordx4 v16, s[12:15], s46 offen lds
    s_add_u32 m0, s73, 106496
    s_movk_i32 s46, 2816
    buffer_load_dwordx4 v17, s[12:15], s46 offen lds
    s_add_u32 m0, s74, 106496
    s_movk_i32 s46, 2816
    buffer_load_dwordx4 v18, s[12:15], s46 offen lds
    s_add_u32 m0, s75, 106496
    s_movk_i32 s46, 2816
    buffer_load_dwordx4 v19, s[12:15], s46 offen lds
    s_add_u32 m0, s76, 106496
    s_movk_i32 s46, 2816
    buffer_load_dwordx4 v20, s[12:15], s46 offen lds
    s_waitcnt vmcnt(13)
    s_barrier
    s_add_u32 m0, s64, 0
    s_movk_i32 s46, 3072
    buffer_load_dwordx4 v8, s[8:11], s46 offen lds
    s_add_u32 m0, s65, 0
    s_movk_i32 s46, 3072
    buffer_load_dwordx4 v9, s[8:11], s46 offen lds
    s_add_u32 m0, s66, 0
    s_movk_i32 s46, 3072
    buffer_load_dwordx4 v10, s[8:11], s46 offen lds
    s_add_u32 m0, s67, 0
    s_movk_i32 s46, 3072
    buffer_load_dwordx4 v11, s[8:11], s46 offen lds
    s_add_u32 m0, s68, 0
    s_movk_i32 s46, 3072
    buffer_load_dwordx4 v12, s[8:11], s46 offen lds
    s_add_u32 m0, s69, 0
    s_movk_i32 s46, 3072
    buffer_load_dwordx4 v13, s[12:15], s46 offen lds
    s_add_u32 m0, s70, 0
    s_movk_i32 s46, 3072
    buffer_load_dwordx4 v14, s[12:15], s46 offen lds
    s_add_u32 m0, s71, 0
    s_movk_i32 s46, 3072
    buffer_load_dwordx4 v15, s[12:15], s46 offen lds
    s_add_u32 m0, s72, 0
    s_movk_i32 s46, 3072
    buffer_load_dwordx4 v16, s[12:15], s46 offen lds
    s_add_u32 m0, s73, 0
    s_movk_i32 s46, 3072
    buffer_load_dwordx4 v17, s[12:15], s46 offen lds
    s_add_u32 m0, s74, 0
    s_movk_i32 s46, 3072
    buffer_load_dwordx4 v18, s[12:15], s46 offen lds
    s_add_u32 m0, s75, 0
    s_movk_i32 s46, 3072
    buffer_load_dwordx4 v19, s[12:15], s46 offen lds
    s_add_u32 m0, s76, 0
    s_movk_i32 s46, 3072
    buffer_load_dwordx4 v20, s[12:15], s46 offen lds
    s_waitcnt vmcnt(13)
    s_barrier
    s_add_u32 m0, s64, 53248
    s_movk_i32 s46, 3328
    buffer_load_dwordx4 v8, s[8:11], s46 offen lds
    s_add_u32 m0, s65, 53248
    s_movk_i32 s46, 3328
    buffer_load_dwordx4 v9, s[8:11], s46 offen lds
    s_add_u32 m0, s66, 53248
    s_movk_i32 s46, 3328
    buffer_load_dwordx4 v10, s[8:11], s46 offen lds
    s_add_u32 m0, s67, 53248
    s_movk_i32 s46, 3328
    buffer_load_dwordx4 v11, s[8:11], s46 offen lds
    s_add_u32 m0, s68, 53248
    s_movk_i32 s46, 3328
    buffer_load_dwordx4 v12, s[8:11], s46 offen lds
    s_add_u32 m0, s69, 53248
    s_movk_i32 s46, 3328
    buffer_load_dwordx4 v13, s[12:15], s46 offen lds
    s_add_u32 m0, s70, 53248
    s_movk_i32 s46, 3328
    buffer_load_dwordx4 v14, s[12:15], s46 offen lds
    s_add_u32 m0, s71, 53248
    s_movk_i32 s46, 3328
    buffer_load_dwordx4 v15, s[12:15], s46 offen lds
    s_add_u32 m0, s72, 53248
    s_movk_i32 s46, 3328
    buffer_load_dwordx4 v16, s[12:15], s46 offen lds
    s_add_u32 m0, s73, 53248
    s_movk_i32 s46, 3328
    buffer_load_dwordx4 v17, s[12:15], s46 offen lds
    s_add_u32 m0, s74, 53248
    s_movk_i32 s46, 3328
    buffer_load_dwordx4 v18, s[12:15], s46 offen lds
    s_add_u32 m0, s75, 53248
    s_movk_i32 s46, 3328
    buffer_load_dwordx4 v19, s[12:15], s46 offen lds
    s_add_u32 m0, s76, 53248
    s_movk_i32 s46, 3328
    buffer_load_dwordx4 v20, s[12:15], s46 offen lds
    s_waitcnt vmcnt(13)
    s_barrier
    s_add_u32 m0, s64, 106496
    s_movk_i32 s46, 3584
    buffer_load_dwordx4 v8, s[8:11], s46 offen lds
    s_add_u32 m0, s65, 106496
    s_movk_i32 s46, 3584
    buffer_load_dwordx4 v9, s[8:11], s46 offen lds
    s_add_u32 m0, s66, 106496
    s_movk_i32 s46, 3584
    buffer_load_dwordx4 v10, s[8:11], s46 offen lds
    s_add_u32 m0, s67, 106496
    s_movk_i32 s46, 3584
    buffer_load_dwordx4 v11, s[8:11], s46 offen lds
    s_add_u32 m0, s68, 106496
    s_movk_i32 s46, 3584
    buffer_load_dwordx4 v12, s[8:11], s46 offen lds
    s_add_u32 m0, s69, 106496
    s_movk_i32 s46, 3584
    buffer_load_dwordx4 v13, s[12:15], s46 offen lds
    s_add_u32 m0, s70, 106496
    s_movk_i32 s46, 3584
    buffer_load_dwordx4 v14, s[12:15], s46 offen lds
    s_add_u32 m0, s71, 106496
    s_movk_i32 s46, 3584
    buffer_load_dwordx4 v15, s[12:15], s46 offen lds
    s_add_u32 m0, s72, 106496
    s_movk_i32 s46, 3584
    buffer_load_dwordx4 v16, s[12:15], s46 offen lds
    s_add_u32 m0, s73, 106496
    s_movk_i32 s46, 3584
    buffer_load_dwordx4 v17, s[12:15], s46 offen lds
    s_add_u32 m0, s74, 106496
    s_movk_i32 s46, 3584
    buffer_load_dwordx4 v18, s[12:15], s46 offen lds
    s_add_u32 m0, s75, 106496
    s_movk_i32 s46, 3584
    buffer_load_dwordx4 v19, s[12:15], s46 offen lds
    s_add_u32 m0, s76, 106496
    s_movk_i32 s46, 3584
    buffer_load_dwordx4 v20, s[12:15], s46 offen lds
    s_waitcnt vmcnt(13)
    s_barrier
    s_add_u32 m0, s64, 0
    s_movk_i32 s46, 3840
    buffer_load_dwordx4 v8, s[8:11], s46 offen lds
    s_add_u32 m0, s65, 0
    s_movk_i32 s46, 3840
    buffer_load_dwordx4 v9, s[8:11], s46 offen lds
    s_add_u32 m0, s66, 0
    s_movk_i32 s46, 3840
    buffer_load_dwordx4 v10, s[8:11], s46 offen lds
    s_add_u32 m0, s67, 0
    s_movk_i32 s46, 3840
    buffer_load_dwordx4 v11, s[8:11], s46 offen lds
    s_add_u32 m0, s68, 0
    s_movk_i32 s46, 3840
    buffer_load_dwordx4 v12, s[8:11], s46 offen lds
    s_add_u32 m0, s69, 0
    s_movk_i32 s46, 3840
    buffer_load_dwordx4 v13, s[12:15], s46 offen lds
    s_add_u32 m0, s70, 0
    s_movk_i32 s46, 3840
    buffer_load_dwordx4 v14, s[12:15], s46 offen lds
    s_add_u32 m0, s71, 0
    s_movk_i32 s46, 3840
    buffer_load_dwordx4 v15, s[12:15], s46 offen lds
    s_add_u32 m0, s72, 0
    s_movk_i32 s46, 3840
    buffer_load_dwordx4 v16, s[12:15], s46 offen lds
    s_add_u32 m0, s73, 0
    s_movk_i32 s46, 3840
    buffer_load_dwordx4 v17, s[12:15], s46 offen lds
    s_add_u32 m0, s74, 0
    s_movk_i32 s46, 3840
    buffer_load_dwordx4 v18, s[12:15], s46 offen lds
    s_add_u32 m0, s75, 0
    s_movk_i32 s46, 3840
    buffer_load_dwordx4 v19, s[12:15], s46 offen lds
    s_add_u32 m0, s76, 0
    s_movk_i32 s46, 3840
    buffer_load_dwordx4 v20, s[12:15], s46 offen lds
    s_waitcnt vmcnt(13)
    s_barrier
    s_waitcnt vmcnt(0)
    s_barrier
    s_endpgm
gemmb_kernel_comp:
    s_mov_b32 s42, s40
    s_mov_b32 s43, 0
    v_lshrrev_b32 v4, 1, v2
    v_xor_b32 v4, v4, v3
    v_and_b32 v5, 12, v2
    v_lshlrev_b32 v5, 1, v5
    v_and_b32 v6, 3, v2
    v_or_b32 v5, v5, v6
    v_xor_b32 v6, 0, v4
    v_lshlrev_b32 v6, 4, v6
    v_lshl_add_u32 v6, v5, 7, v6
    v_add_u32 v8, 0, v6
    v_add_u32 v12, 53248, v6
    v_add_u32 v16, 106496, v6
    v_xor_b32 v6, 4, v4
    v_lshlrev_b32 v6, 4, v6
    v_lshl_add_u32 v6, v5, 7, v6
    v_add_u32 v9, 0, v6
    v_add_u32 v13, 53248, v6
    v_add_u32 v17, 106496, v6
    v_xor_b32 v6, 0, v4
    v_lshlrev_b32 v6, 4, v6
    v_lshl_add_u32 v6, v2, 7, v6
    v_add_u32 v10, 0, v6
    v_add_u32 v14, 53248, v6
    v_add_u32 v18, 106496, v6
    v_xor_b32 v6, 4, v4
    v_lshlrev_b32 v6, 4, v6
    v_lshl_add_u32 v6, v2, 7, v6
    v_add_u32 v11, 0, v6
    v_add_u32 v15, 53248, v6
    v_add_u32 v19, 106496, v6
    s_lshl_b32 s46, s42, 12
    s_add_u32 s46, s46, 20480
    v_xor_b32 v6, 0, v4
    v_lshlrev_b32 v6, 4, v6
    v_lshl_add_u32 v6, v2, 7, v6
    v_add_u32 v6, s46, v6
    v_add_u32 v20, 0, v6
    v_add_u32 v22, 53248, v6
    v_add_u32 v24, 106496, v6
    v_xor_b32 v6, 4, v4
    v_lshlrev_b32 v6, 4, v6
    v_lshl_add_u32 v6, v2, 7, v6
    v_add_u32 v6, s46, v6
    v_add_u32 v21, 0, v6
    v_add_u32 v23, 53248, v6
    v_add_u32 v25, 106496, v6
    s_lshl_b32 s58, s7, 4
    s_lshl_b32 s59, s40, 2
    s_add_u32 s58, s58, s59
    v_add_u32 v7, s58, v3
    v_lshlrev_b32 v7, 12, v7
    v_lshl_add_u32 v7, v2, 4, v7
    s_barrier
    ds_read_b128 v[52:55], v20 offset:0
    ds_read_b128 v[56:59], v20 offset:2048
    ds_read_b128 v[32:35], v8 offset:0
    ds_read_b128 v[36:39], v8 offset:512
    ds_read_b128 v[40:43], v8 offset:4096
    ds_read_b128 v[44:47], v8 offset:4608
    ds_read_b128 v[48:51], v10 offset:8192
    buffer_load_dwordx4 v[144:147], v7, s[12:15], 0 offen offset:1024
    buffer_load_dwordx4 v[148:151], v7, s[12:15], 0 offen offset:1280
    buffer_load_dwordx4 v[152:155], v7, s[12:15], 0 offen offset:1536
    ds_read_b128 v[80:83], v21 offset:0
    ds_read_b128 v[84:87], v21 offset:2048
    ds_read_b128 v[60:63], v9 offset:0
    ds_read_b128 v[64:67], v9 offset:512
    ds_read_b128 v[68:71], v9 offset:4096
    ds_read_b128 v[72:75], v9 offset:4608
    ds_read_b128 v[76:79], v11 offset:8192
    s_waitcnt lgkmcnt(7)
    v_mfma_f32_16x16x32_bf16 a[0:3], v[32:35], v[52:55], 0
    v_mfma_f32_16x16x32_bf16 a[4:7], v[32:35], v[56:59], 0
    v_mfma_f32_16x16x32_bf16 a[8:11], v[36:39], v[52:55], 0
    v_mfma_f32_16x16x32_bf16 a[12:15], v[36:39], v[56:59], 0
    v_mfma_f32_16x16x32_bf16 a[16:19], v[40:43], v[52:55], 0
    v_mfma_f32_16x16x32_bf16 a[20:23], v[40:43], v[56:59], 0
    v_mfma_f32_16x16x32_bf16 a[24:27], v[44:47], v[52:55], 0
    v_mfma_f32_16x16x32_bf16 a[28:31], v[44:47], v[56:59], 0
    v_mfma_f32_16x16x32_bf16 a[32:35], v[48:51], v[52:55], 0
    v_mfma_f32_16x16x32_bf16 a[36:39], v[48:51], v[56:59], 0
    ds_read_b128 v[52:55], v20 offset:16384
    ds_read_b128 v[56:59], v20 offset:18432
    ds_read_b128 v[32:35], v8 offset:10240
    ds_read_b128 v[36:39], v8 offset:10752
    ds_read_b128 v[40:43], v8 offset:14336
    ds_read_b128 v[44:47], v8 offset:14848
    ds_read_b128 v[48:51], v10 offset:18432
    s_waitcnt lgkmcnt(7)
    v_mfma_f32_16x16x32_bf16 a[0:3], v[60:63], v[80:83], a[0:3]
    v_mfma_f32_16x16x32_bf16 a[4:7], v[60:63], v[84:87], a[4:7]
    v_mfma_f32_16x16x32_bf16 a[8:11], v[64:67], v[80:83], a[8:11]
    v_mfma_f32_16x16x32_bf16 a[12:15], v[64:67], v[84:87], a[12:15]
    v_mfma_f32_16x16x32_bf16 a[16:19], v[68:71], v[80:83], a[16:19]
    v_mfma_f32_16x16x32_bf16 a[20:23], v[68:71], v[84:87], a[20:23]
    v_mfma_f32_16x16x32_bf16 a[24:27], v[72:75], v[80:83], a[24:27]
    v_mfma_f32_16x16x32_bf16 a[28:31], v[72:75], v[84:87], a[28:31]
    v_mfma_f32_16x16x32_bf16 a[32:35], v[76:79], v[80:83], a[32:35]
    v_mfma_f32_16x16x32_bf16 a[36:39], v[76:79], v[84:87], a[36:39]
    ds_read_b128 v[80:83], v21 offset:16384
    ds_read_b128 v[84:87], v21 offset:18432
    ds_read_b128 v[60:63], v9 offset:10240
    ds_read_b128 v[64:67], v9 offset:10752
    ds_read_b128 v[68:71], v9 offset:14336
    ds_read_b128 v[72:75], v9 offset:14848
    ds_read_b128 v[76:79], v11 offset:18432
    s_waitcnt lgkmcnt(7)
    v_mfma_f32_16x16x32_bf16 a[0:3], v[32:35], v[52:55], a[0:3]
    v_mfma_f32_16x16x32_bf16 a[4:7], v[32:35], v[56:59], a[4:7]
    v_mfma_f32_16x16x32_bf16 a[8:11], v[36:39], v[52:55], a[8:11]
    v_mfma_f32_16x16x32_bf16 a[12:15], v[36:39], v[56:59], a[12:15]
    v_mfma_f32_16x16x32_bf16 a[16:19], v[40:43], v[52:55], a[16:19]
    v_mfma_f32_16x16x32_bf16 a[20:23], v[40:43], v[56:59], a[20:23]
    v_mfma_f32_16x16x32_bf16 a[24:27], v[44:47], v[52:55], a[24:27]
    v_mfma_f32_16x16x32_bf16 a[28:31], v[44:47], v[56:59], a[28:31]
    v_mfma_f32_16x16x32_bf16 a[32:35], v[48:51], v[52:55], a[32:35]
    v_mfma_f32_16x16x32_bf16 a[36:39], v[48:51], v[56:59], a[36:39]
    s_waitcnt lgkmcnt(0)
    s_barrier
    ds_read_b128 v[52:55], v22 offset:0
    ds_read_b128 v[56:59], v22 offset:2048
    ds_read_b128 v[32:35], v12 offset:0
    ds_read_b128 v[36:39], v12 offset:512
    ds_read_b128 v[40:43], v12 offset:4096
    ds_read_b128 v[44:47], v12 offset:4608
    ds_read_b128 v[48:51], v14 offset:8192
    v_mfma_f32_16x16x32_bf16 a[0:3], v[60:63], v[80:83], a[0:3]
    v_mfma_f32_16x16x32_bf16 a[4:7], v[60:63], v[84:87], a[4:7]
    v_mfma_f32_16x16x32_bf16 a[8:11], v[64:67], v[80:83], a[8:11]
    v_mfma_f32_16x16x32_bf16 a[12:15], v[64:67], v[84:87], a[12:15]
    v_mfma_f32_16x16x32_bf16 a[16:19], v[68:71], v[80:83], a[16:19]
    v_mfma_f32_16x16x32_bf16 a[20:23], v[68:71], v[84:87], a[20:23]
    v_mfma_f32_16x16x32_bf16 a[24:27], v[72:75], v[80:83], a[24:27]
    v_mfma_f32_16x16x32_bf16 a[28:31], v[72:75], v[84:87], a[28:31]
    v_mfma_f32_16x16x32_bf16 a[32:35], v[76:79], v[80:83], a[32:35]
    v_mfma_f32_16x16x32_bf16 a[36:39], v[76:79], v[84:87], a[36:39]
    buffer_load_dwordx4 v[156:159], v7, s[12:15], 0 offen offset:1792
    buffer_load_dwordx4 v[128:131], v7, s[12:15], 0 offen offset:2048
    buffer_load_dwordx4 v[132:135], v7, s[12:15], 0 offen offset:2304
    ds_read_b128 v[80:83], v23 offset:0
    ds_read_b128 v[84:87], v23 offset:2048
    ds_read_b128 v[60:63], v13 offset:0
    ds_read_b128 v[64:67], v13 offset:512
    ds_read_b128 v[68:71], v13 offset:4096
    ds_read_b128 v[72:75], v13 offset:4608
    ds_read_b128 v[76:79], v15 offset:8192
    s_waitcnt lgkmcnt(7)
    v_mfma_f32_16x16x32_bf16 a[0:3], v[32:35], v[52:55], a[0:3]
    v_mfma_f32_16x16x32_bf16 a[4:7], v[32:35], v[56:59], a[4:7]
    v_mfma_f32_16x16x32_bf16 a[8:11], v[36:39], v[52:55], a[8:11]
    v_mfma_f32_16x16x32_bf16 a[12:15], v[36:39], v[56:59], a[12:15]
    v_mfma_f32_16x16x32_bf16 a[16:19], v[40:43], v[52:55], a[16:19]
    v_mfma_f32_16x16x32_bf16 a[20:23], v[40:43], v[56:59], a[20:23]
    v_mfma_f32_16x16x32_bf16 a[24:27], v[44:47], v[52:55], a[24:27]
    v_mfma_f32_16x16x32_bf16 a[28:31], v[44:47], v[56:59], a[28:31]
    v_mfma_f32_16x16x32_bf16 a[32:35], v[48:51], v[52:55], a[32:35]
    v_mfma_f32_16x16x32_bf16 a[36:39], v[48:51], v[56:59], a[36:39]
    ds_read_b128 v[52:55], v22 offset:16384
    ds_read_b128 v[56:59], v22 offset:18432
    ds_read_b128 v[32:35], v12 offset:10240
    ds_read_b128 v[36:39], v12 offset:10752
    ds_read_b128 v[40:43], v12 offset:14336
    ds_read_b128 v[44:47], v12 offset:14848
    ds_read_b128 v[48:51], v14 offset:18432
    s_waitcnt lgkmcnt(7)
    v_mfma_f32_16x16x32_bf16 a[0:3], v[60:63], v[80:83], a[0:3]
    v_mfma_f32_16x16x32_bf16 a[4:7], v[60:63], v[84:87], a[4:7]
    v_mfma_f32_16x16x32_bf16 a[8:11], v[64:67], v[80:83], a[8:11]
    v_mfma_f32_16x16x32_bf16 a[12:15], v[64:67], v[84:87], a[12:15]
    v_mfma_f32_16x16x32_bf16 a[16:19], v[68:71], v[80:83], a[16:19]
    v_mfma_f32_16x16x32_bf16 a[20:23], v[68:71], v[84:87], a[20:23]
    v_mfma_f32_16x16x32_bf16 a[24:27], v[72:75], v[80:83], a[24:27]
    v_mfma_f32_16x16x32_bf16 a[28:31], v[72:75], v[84:87], a[28:31]
    v_mfma_f32_16x16x32_bf16 a[32:35], v[76:79], v[80:83], a[32:35]
    v_mfma_f32_16x16x32_bf16 a[36:39], v[76:79], v[84:87], a[36:39]
    ds_read_b128 v[80:83], v23 offset:16384
    ds_read_b128 v[84:87], v23 offset:18432
    ds_read_b128 v[60:63], v13 offset:10240
    ds_read_b128 v[64:67], v13 offset:10752
    ds_read_b128 v[68:71], v13 offset:14336
    ds_read_b128 v[72:75], v13 offset:14848
    ds_read_b128 v[76:79], v15 offset:18432
    s_waitcnt lgkmcnt(7)
    v_mfma_f32_16x16x32_bf16 a[0:3], v[32:35], v[52:55], a[0:3]
    v_mfma_f32_16x16x32_bf16 a[4:7], v[32:35], v[56:59], a[4:7]
    v_mfma_f32_16x16x32_bf16 a[8:11], v[36:39], v[52:55], a[8:11]
    v_mfma_f32_16x16x32_bf16 a[12:15], v[36:39], v[56:59], a[12:15]
    v_mfma_f32_16x16x32_bf16 a[16:19], v[40:43], v[52:55], a[16:19]
    v_mfma_f32_16x16x32_bf16 a[20:23], v[40:43], v[56:59], a[20:23]
    v_mfma_f32_16x16x32_bf16 a[24:27], v[44:47], v[52:55], a[24:27]
    v_mfma_f32_16x16x32_bf16 a[28:31], v[44:47], v[56:59], a[28:31]
    v_mfma_f32_16x16x32_bf16 a[32:35], v[48:51], v[52:55], a[32:35]
    v_mfma_f32_16x16x32_bf16 a[36:39], v[48:51], v[56:59], a[36:39]
    s_waitcnt lgkmcnt(0)
    s_barrier
    ds_read_b128 v[52:55], v24 offset:0
    ds_read_b128 v[56:59], v24 offset:2048
    ds_read_b128 v[32:35], v16 offset:0
    ds_read_b128 v[36:39], v16 offset:512
    ds_read_b128 v[40:43], v16 offset:4096
    ds_read_b128 v[44:47], v16 offset:4608
    ds_read_b128 v[48:51], v18 offset:8192
    v_mfma_f32_16x16x32_bf16 a[0:3], v[60:63], v[80:83], a[0:3]
    v_mfma_f32_16x16x32_bf16 a[4:7], v[60:63], v[84:87], a[4:7]
    v_mfma_f32_16x16x32_bf16 a[8:11], v[64:67], v[80:83], a[8:11]
    v_mfma_f32_16x16x32_bf16 a[12:15], v[64:67], v[84:87], a[12:15]
    v_mfma_f32_16x16x32_bf16 a[16:19], v[68:71], v[80:83], a[16:19]
    v_mfma_f32_16x16x32_bf16 a[20:23], v[68:71], v[84:87], a[20:23]
    v_mfma_f32_16x16x32_bf16 a[24:27], v[72:75], v[80:83], a[24:27]
    v_mfma_f32_16x16x32_bf16 a[28:31], v[72:75], v[84:87], a[28:31]
    v_mfma_f32_16x16x32_bf16 a[32:35], v[76:79], v[80:83], a[32:35]
    v_mfma_f32_16x16x32_bf16 a[36:39], v[76:79], v[84:87], a[36:39]
    buffer_load_dwordx4 v[136:139], v7, s[12:15], 0 offen offset:2560
    buffer_load_dwordx4 v[140:143], v7, s[12:15], 0 offen offset:2816
    buffer_load_dwordx4 v[144:147], v7, s[12:15], 0 offen offset:3072
    ds_read_b128 v[80:83], v25 offset:0
    ds_read_b128 v[84:87], v25 offset:2048
    ds_read_b128 v[60:63], v17 offset:0
    ds_read_b128 v[64:67], v17 offset:512
    ds_read_b128 v[68:71], v17 offset:4096
    ds_read_b128 v[72:75], v17 offset:4608
    ds_read_b128 v[76:79], v19 offset:8192
    s_waitcnt lgkmcnt(7)
    v_mfma_f32_16x16x32_bf16 a[0:3], v[32:35], v[52:55], a[0:3]
    v_mfma_f32_16x16x32_bf16 a[4:7], v[32:35], v[56:59], a[4:7]
    v_mfma_f32_16x16x32_bf16 a[8:11], v[36:39], v[52:55], a[8:11]
    v_mfma_f32_16x16x32_bf16 a[12:15], v[36:39], v[56:59], a[12:15]
    v_mfma_f32_16x16x32_bf16 a[16:19], v[40:43], v[52:55], a[16:19]
    v_mfma_f32_16x16x32_bf16 a[20:23], v[40:43], v[56:59], a[20:23]
    v_mfma_f32_16x16x32_bf16 a[24:27], v[44:47], v[52:55], a[24:27]
    v_mfma_f32_16x16x32_bf16 a[28:31], v[44:47], v[56:59], a[28:31]
    v_mfma_f32_16x16x32_bf16 a[32:35], v[48:51], v[52:55], a[32:35]
    v_mfma_f32_16x16x32_bf16 a[36:39], v[48:51], v[56:59], a[36:39]
    ds_read_b128 v[52:55], v24 offset:16384
    ds_read_b128 v[56:59], v24 offset:18432
    ds_read_b128 v[32:35], v16 offset:10240
    ds_read_b128 v[36:39], v16 offset:10752
    ds_read_b128 v[40:43], v16 offset:14336
    ds_read_b128 v[44:47], v16 offset:14848
    ds_read_b128 v[48:51], v18 offset:18432
    s_waitcnt lgkmcnt(7)
    v_mfma_f32_16x16x32_bf16 a[0:3], v[60:63], v[80:83], a[0:3]
    v_mfma_f32_16x16x32_bf16 a[4:7], v[60:63], v[84:87], a[4:7]
    v_mfma_f32_16x16x32_bf16 a[8:11], v[64:67], v[80:83], a[8:11]
    v_mfma_f32_16x16x32_bf16 a[12:15], v[64:67], v[84:87], a[12:15]
    v_mfma_f32_16x16x32_bf16 a[16:19], v[68:71], v[80:83], a[16:19]
    v_mfma_f32_16x16x32_bf16 a[20:23], v[68:71], v[84:87], a[20:23]
    v_mfma_f32_16x16x32_bf16 a[24:27], v[72:75], v[80:83], a[24:27]
    v_mfma_f32_16x16x32_bf16 a[28:31], v[72:75], v[84:87], a[28:31]
    v_mfma_f32_16x16x32_bf16 a[32:35], v[76:79], v[80:83], a[32:35]
    v_mfma_f32_16x16x32_bf16 a[36:39], v[76:79], v[84:87], a[36:39]
    ds_read_b128 v[80:83], v25 offset:16384
    ds_read_b128 v[84:87], v25 offset:18432
    ds_read_b128 v[60:63], v17 offset:10240
    ds_read_b128 v[64:67], v17 offset:10752
    ds_read_b128 v[68:71], v17 offset:14336
    ds_read_b128 v[72:75], v17 offset:14848
    ds_read_b128 v[76:79], v19 offset:18432
    s_waitcnt lgkmcnt(7)
    v_mfma_f32_16x16x32_bf16 a[0:3], v[32:35], v[52:55], a[0:3]
    v_mfma_f32_16x16x32_bf16 a[4:7], v[32:35], v[56:59], a[4:7]
    v_mfma_f32_16x16x32_bf16 a[8:11], v[36:39], v[52:55], a[8:11]
    v_mfma_f32_16x16x32_bf16 a[12:15], v[36:39], v[56:59], a[12:15]
    v_mfma_f32_16x16x32_bf16 a[16:19], v[40:43], v[52:55], a[16:19]
    v_mfma_f32_16x16x32_bf16 a[20:23], v[40:43], v[56:59], a[20:23]
    v_mfma_f32_16x16x32_bf16 a[24:27], v[44:47], v[52:55], a[24:27]
    v_mfma_f32_16x16x32_bf16 a[28:31], v[44:47], v[56:59], a[28:31]
    v_mfma_f32_16x16x32_bf16 a[32:35], v[48:51], v[52:55], a[32:35]
    v_mfma_f32_16x16x32_bf16 a[36:39], v[48:51], v[56:59], a[36:39]
    s_waitcnt lgkmcnt(0)
    s_barrier
    ds_read_b128 v[52:55], v20 offset:0
    ds_read_b128 v[56:59], v20 offset:2048
    ds_read_b128 v[32:35], v8 offset:0
    ds_read_b128 v[36:39], v8 offset:512
    ds_read_b128 v[40:43], v8 offset:4096
    ds_read_b128 v[44:47], v8 offset:4608
    ds_read_b128 v[48:51], v10 offset:8192
    v_mfma_f32_16x16x32_bf16 a[0:3], v[60:63], v[80:83], a[0:3]
    v_mfma_f32_16x16x32_bf16 a[4:7], v[60:63], v[84:87], a[4:7]
    v_mfma_f32_16x16x32_bf16 a[8:11], v[64:67], v[80:83], a[8:11]
    v_mfma_f32_16x16x32_bf16 a[12:15], v[64:67], v[84:87], a[12:15]
    v_mfma_f32_16x16x32_bf16 a[16:19], v[68:71], v[80:83], a[16:19]
    v_mfma_f32_16x16x32_bf16 a[20:23], v[68:71], v[84:87], a[20:23]
    v_mfma_f32_16x16x32_bf16 a[24:27], v[72:75], v[80:83], a[24:27]
    v_mfma_f32_16x16x32_bf16 a[28:31], v[72:75], v[84:87], a[28:31]
    v_mfma_f32_16x16x32_bf16 a[32:35], v[76:79], v[80:83], a[32:35]
    v_mfma_f32_16x16x32_bf16 a[36:39], v[76:79], v[84:87], a[36:39]
    buffer_load_dwordx4 v[148:151], v7, s[12:15], 0 offen offset:3328
    buffer_load_dwordx4 v[152:155], v7, s[12:15], 0 offen offset:3584
    buffer_load_dwordx4 v[156:159], v7, s[12:15], 0 offen offset:3840
    ds_read_b128 v[80:83], v21 offset:0
    ds_read_b128 v[84:87], v21 offset:2048
    ds_read_b128 v[60:63], v9 offset:0
    ds_read_b128 v[64:67], v9 offset:512
    ds_read_b128 v[68:71], v9 offset:4096
    ds_read_b128 v[72:75], v9 offset:4608
    ds_read_b128 v[76:79], v11 offset:8192
    s_waitcnt lgkmcnt(7)
    v_mfma_f32_16x16x32_bf16 a[0:3], v[32:35], v[52:55], a[0:3]
    v_mfma_f32_16x16x32_bf16 a[4:7], v[32:35], v[56:59], a[4:7]
    v_mfma_f32_16x16x32_bf16 a[8:11], v[36:39], v[52:55], a[8:11]
    v_mfma_f32_16x16x32_bf16 a[12:15], v[36:39], v[56:59], a[12:15]
    v_mfma_f32_16x16x32_bf16 a[16:19], v[40:43], v[52:55], a[16:19]
    v_mfma_f32_16x16x32_bf16 a[20:23], v[40:43], v[56:59], a[20:23]
    v_mfma_f32_16x16x32_bf16 a[24:27], v[44:47], v[52:55], a[24:27]
    v_mfma_f32_16x16x32_bf16 a[28:31], v[44:47], v[56:59], a[28:31]
    v_mfma_f32_16x16x32_bf16 a[32:35], v[48:51], v[52:55], a[32:35]
    v_mfma_f32_16x16x32_bf16 a[36:39], v[48:51], v[56:59], a[36:39]
    ds_read_b128 v[52:55], v20 offset:16384
    ds_read_b128 v[56:59], v20 offset:18432
    ds_read_b128 v[32:35], v8 offset:10240
    ds_read_b128 v[36:39], v8 offset:10752
    ds_read_b128 v[40:43], v8 offset:14336
    ds_read_b128 v[44:47], v8 offset:14848
    ds_read_b128 v[48:51], v10 offset:18432
    s_waitcnt lgkmcnt(7)
    v_mfma_f32_16x16x32_bf16 a[0:3], v[60:63], v[80:83], a[0:3]
    v_mfma_f32_16x16x32_bf16 a[4:7], v[60:63], v[84:87], a[4:7]
    v_mfma_f32_16x16x32_bf16 a[8:11], v[64:67], v[80:83], a[8:11]
    v_mfma_f32_16x16x32_bf16 a[12:15], v[64:67], v[84:87], a[12:15]
    v_mfma_f32_16x16x32_bf16 a[16:19], v[68:71], v[80:83], a[16:19]
    v_mfma_f32_16x16x32_bf16 a[20:23], v[68:71], v[84:87], a[20:23]
    v_mfma_f32_16x16x32_bf16 a[24:27], v[72:75], v[80:83], a[24:27]
    v_mfma_f32_16x16x32_bf16 a[28:31], v[72:75], v[84:87], a[28:31]
    v_mfma_f32_16x16x32_bf16 a[32:35], v[76:79], v[80:83], a[32:35]
    v_mfma_f32_16x16x32_bf16 a[36:39], v[76:79], v[84:87], a[36:39]
    ds_read_b128 v[80:83], v21 offset:16384
    ds_read_b128 v[84:87], v21 offset:18432
    ds_read_b128 v[60:63], v9 offset:10240
    ds_read_b128 v[64:67], v9 offset:10752
    ds_read_b128 v[68:71], v9 offset:14336
    ds_read_b128 v[72:75], v9 offset:14848
    ds_read_b128 v[76:79], v11 offset:18432
    s_waitcnt lgkmcnt(7)
    v_mfma_f32_16x16x32_bf16 a[0:3], v[32:35], v[52:55], a[0:3]
    v_mfma_f32_16x16x32_bf16 a[4:7], v[32:35], v[56:59], a[4:7]
    v_mfma_f32_16x16x32_bf16 a[8:11], v[36:39], v[52:55], a[8:11]
    v_mfma_f32_16x16x32_bf16 a[12:15], v[36:39], v[56:59], a[12:15]
    v_mfma_f32_16x16x32_bf16 a[16:19], v[40:43], v[52:55], a[16:19]
    v_mfma_f32_16x16x32_bf16 a[20:23], v[40:43], v[56:59], a[20:23]
    v_mfma_f32_16x16x32_bf16 a[24:27], v[44:47], v[52:55], a[24:27]
    v_mfma_f32_16x16x32_bf16 a[28:31], v[44:47], v[56:59], a[28:31]
    v_mfma_f32_16x16x32_bf16 a[32:35], v[48:51], v[52:55], a[32:35]
    v_mfma_f32_16x16x32_bf16 a[36:39], v[48:51], v[56:59], a[36:39]
    s_waitcnt lgkmcnt(0)
    s_barrier
    ds_read_b128 v[52:55], v22 offset:0
    ds_read_b128 v[56:59], v22 offset:2048
    ds_read_b128 v[32:35], v12 offset:0
    ds_read_b128 v[36:39], v12 offset:512
    ds_read_b128 v[40:43], v12 offset:4096
    ds_read_b128 v[44:47], v12 offset:4608
    ds_read_b128 v[48:51], v14 offset:8192
    v_mfma_f32_16x16x32_bf16 a[0:3], v[60:63], v[80:83], a[0:3]
    v_mfma_f32_16x16x32_bf16 a[4:7], v[60:63], v[84:87], a[4:7]
    v_mfma_f32_16x16x32_bf16 a[8:11], v[64:67], v[80:83], a[8:11]
    v_mfma_f32_16x16x32_bf16 a[12:15], v[64:67], v[84:87], a[12:15]
    v_mfma_f32_16x16x32_bf16 a[16:19], v[68:71], v[80:83], a[16:19]
    v_mfma_f32_16x16x32_bf16 a[20:23], v[68:71], v[84:87], a[20:23]
    v_mfma_f32_16x16x32_bf16 a[24:27], v[72:75], v[80:83], a[24:27]
    v_mfma_f32_16x16x32_bf16 a[28:31], v[72:75], v[84:87], a[28:31]
    v_mfma_f32_16x16x32_bf16 a[32:35], v[76:79], v[80:83], a[32:35]
    v_mfma_f32_16x16x32_bf16 a[36:39], v[76:79], v[84:87], a[36:39]
    ds_read_b128 v[80:83], v23 offset:0
    ds_read_b128 v[84:87], v23 offset:2048
    ds_read_b128 v[60:63], v13 offset:0
    ds_read_b128 v[64:67], v13 offset:512
    ds_read_b128 v[68:71], v13 offset:4096
    ds_read_b128 v[72:75], v13 offset:4608
    ds_read_b128 v[76:79], v15 offset:8192
    s_waitcnt lgkmcnt(7)
    v_mfma_f32_16x16x32_bf16 a[0:3], v[32:35], v[52:55], a[0:3]
    v_mfma_f32_16x16x32_bf16 a[4:7], v[32:35], v[56:59], a[4:7]
    v_mfma_f32_16x16x32_bf16 a[8:11], v[36:39], v[52:55], a[8:11]
    v_mfma_f32_16x16x32_bf16 a[12:15], v[36:39], v[56:59], a[12:15]
    v_mfma_f32_16x16x32_bf16 a[16:19], v[40:43], v[52:55], a[16:19]
    v_mfma_f32_16x16x32_bf16 a[20:23], v[40:43], v[56:59], a[20:23]
    v_mfma_f32_16x16x32_bf16 a[24:27], v[44:47], v[52:55], a[24:27]
    v_mfma_f32_16x16x32_bf16 a[28:31], v[44:47], v[56:59], a[28:31]
    v_mfma_f32_16x16x32_bf16 a[32:35], v[48:51], v[52:55], a[32:35]
    v_mfma_f32_16x16x32_bf16 a[36:39], v[48:51], v[56:59], a[36:39]
    ds_read_b128 v[52:55], v22 offset:16384
    ds_read_b128 v[56:59], v22 offset:18432
    ds_read_b128 v[32:35], v12 offset:10240
    ds_read_b128 v[36:39], v12 offset:10752
    ds_read_b128 v[40:43], v12 offset:14336
    ds_read_b128 v[44:47], v12 offset:14848
    ds_read_b128 v[48:51], v14 offset:18432
    s_waitcnt lgkmcnt(7)
    v_mfma_f32_16x16x32_bf16 a[0:3], v[60:63], v[80:83], a[0:3]
    v_mfma_f32_16x16x32_bf16 a[4:7], v[60:63], v[84:87], a[4:7]
    v_mfma_f32_16x16x32_bf16 a[8:11], v[64:67], v[80:83], a[8:11]
    v_mfma_f32_16x16x32_bf16 a[12:15], v[64:67], v[84:87], a[12:15]
    v_mfma_f32_16x16x32_bf16 a[16:19], v[68:71], v[80:83], a[16:19]
    v_mfma_f32_16x16x32_bf16 a[20:23], v[68:71], v[84:87], a[20:23]
    v_mfma_f32_16x16x32_bf16 a[24:27], v[72:75], v[80:83], a[24:27]
    v_mfma_f32_16x16x32_bf16 a[28:31], v[72:75], v[84:87], a[28:31]
    v_mfma_f32_16x16x32_bf16 a[32:35], v[76:79], v[80:83], a[32:35]
    v_mfma_f32_16x16x32_bf16 a[36:39], v[76:79], v[84:87], a[36:39]
    ds_read_b128 v[80:83], v23 offset:16384
    ds_read_b128 v[84:87], v23 offset:18432
    ds_read_b128 v[60:63], v13 offset:10240
    ds_read_b128 v[64:67], v13 offset:10752
    ds_read_b128 v[68:71], v13 offset:14336
    ds_read_b128 v[72:75], v13 offset:14848
    ds_read_b128 v[76:79], v15 offset:18432
    s_waitcnt lgkmcnt(7)
    v_mfma_f32_16x16x32_bf16 a[0:3], v[32:35], v[52:55], a[0:3]
    v_mfma_f32_16x16x32_bf16 a[4:7], v[32:35], v[56:59], a[4:7]
    v_mfma_f32_16x16x32_bf16 a[8:11], v[36:39], v[52:55], a[8:11]
    v_mfma_f32_16x16x32_bf16 a[12:15], v[36:39], v[56:59], a[12:15]
    v_mfma_f32_16x16x32_bf16 a[16:19], v[40:43], v[52:55], a[16:19]
    v_mfma_f32_16x16x32_bf16 a[20:23], v[40:43], v[56:59], a[20:23]
    v_mfma_f32_16x16x32_bf16 a[24:27], v[44:47], v[52:55], a[24:27]
    v_mfma_f32_16x16x32_bf16 a[28:31], v[44:47], v[56:59], a[28:31]
    v_mfma_f32_16x16x32_bf16 a[32:35], v[48:51], v[52:55], a[32:35]
    v_mfma_f32_16x16x32_bf16 a[36:39], v[48:51], v[56:59], a[36:39]
    s_waitcnt lgkmcnt(0)
    s_barrier
    ds_read_b128 v[52:55], v24 offset:0
    ds_read_b128 v[56:59], v24 offset:2048
    ds_read_b128 v[32:35], v16 offset:0
    ds_read_b128 v[36:39], v16 offset:512
    ds_read_b128 v[40:43], v16 offset:4096
    ds_read_b128 v[44:47], v16 offset:4608
    ds_read_b128 v[48:51], v18 offset:8192
    v_mfma_f32_16x16x32_bf16 a[0:3], v[60:63], v[80:83], a[0:3]
    v_mfma_f32_16x16x32_bf16 a[4:7], v[60:63], v[84:87], a[4:7]
    v_mfma_f32_16x16x32_bf16 a[8:11], v[64:67], v[80:83], a[8:11]
    v_mfma_f32_16x16x32_bf16 a[12:15], v[64:67], v[84:87], a[12:15]
    v_mfma_f32_16x16x32_bf16 a[16:19], v[68:71], v[80:83], a[16:19]
    v_mfma_f32_16x16x32_bf16 a[20:23], v[68:71], v[84:87], a[20:23]
    v_mfma_f32_16x16x32_bf16 a[24:27], v[72:75], v[80:83], a[24:27]
    v_mfma_f32_16x16x32_bf16 a[28:31], v[72:75], v[84:87], a[28:31]
    v_mfma_f32_16x16x32_bf16 a[32:35], v[76:79], v[80:83], a[32:35]
    v_mfma_f32_16x16x32_bf16 a[36:39], v[76:79], v[84:87], a[36:39]
    ds_read_b128 v[80:83], v25 offset:0
    ds_read_b128 v[84:87], v25 offset:2048
    ds_read_b128 v[60:63], v17 offset:0
    ds_read_b128 v[64:67], v17 offset:512
    ds_read_b128 v[68:71], v17 offset:4096
    ds_read_b128 v[72:75], v17 offset:4608
    ds_read_b128 v[76:79], v19 offset:8192
    s_waitcnt lgkmcnt(7)
    v_mfma_f32_16x16x32_bf16 a[0:3], v[32:35], v[52:55], a[0:3]
    v_mfma_f32_16x16x32_bf16 a[4:7], v[32:35], v[56:59], a[4:7]
    v_mfma_f32_16x16x32_bf16 a[8:11], v[36:39], v[52:55], a[8:11]
    v_mfma_f32_16x16x32_bf16 a[12:15], v[36:39], v[56:59], a[12:15]
    v_mfma_f32_16x16x32_bf16 a[16:19], v[40:43], v[52:55], a[16:19]
    v_mfma_f32_16x16x32_bf16 a[20:23], v[40:43], v[56:59], a[20:23]
    v_mfma_f32_16x16x32_bf16 a[24:27], v[44:47], v[52:55], a[24:27]
    v_mfma_f32_16x16x32_bf16 a[28:31], v[44:47], v[56:59], a[28:31]
    v_mfma_f32_16x16x32_bf16 a[32:35], v[48:51], v[52:55], a[32:35]
    v_mfma_f32_16x16x32_bf16 a[36:39], v[48:51], v[56:59], a[36:39]
    ds_read_b128 v[52:55], v24 offset:16384
    ds_read_b128 v[56:59], v24 offset:18432
    ds_read_b128 v[32:35], v16 offset:10240
    ds_read_b128 v[36:39], v16 offset:10752
    ds_read_b128 v[40:43], v16 offset:14336
    ds_read_b128 v[44:47], v16 offset:14848
    ds_read_b128 v[48:51], v18 offset:18432
    s_waitcnt lgkmcnt(7)
    v_mfma_f32_16x16x32_bf16 a[0:3], v[60:63], v[80:83], a[0:3]
    v_mfma_f32_16x16x32_bf16 a[4:7], v[60:63], v[84:87], a[4:7]
    v_mfma_f32_16x16x32_bf16 a[8:11], v[64:67], v[80:83], a[8:11]
    v_mfma_f32_16x16x32_bf16 a[12:15], v[64:67], v[84:87], a[12:15]
    v_mfma_f32_16x16x32_bf16 a[16:19], v[68:71], v[80:83], a[16:19]
    v_mfma_f32_16x16x32_bf16 a[20:23], v[68:71], v[84:87], a[20:23]
    v_mfma_f32_16x16x32_bf16 a[24:27], v[72:75], v[80:83], a[24:27]
    v_mfma_f32_16x16x32_bf16 a[28:31], v[72:75], v[84:87], a[28:31]
    v_mfma_f32_16x16x32_bf16 a[32:35], v[76:79], v[80:83], a[32:35]
    v_mfma_f32_16x16x32_bf16 a[36:39], v[76:79], v[84:87], a[36:39]
    ds_read_b128 v[80:83], v25 offset:16384
    ds_read_b128 v[84:87], v25 offset:18432
    ds_read_b128 v[60:63], v17 offset:10240
    ds_read_b128 v[64:67], v17 offset:10752
    ds_read_b128 v[68:71], v17 offset:14336
    ds_read_b128 v[72:75], v17 offset:14848
    ds_read_b128 v[76:79], v19 offset:18432
    s_waitcnt lgkmcnt(7)
    v_mfma_f32_16x16x32_bf16 a[0:3], v[32:35], v[52:55], a[0:3]
    v_mfma_f32_16x16x32_bf16 a[4:7], v[32:35], v[56:59], a[4:7]
    v_mfma_f32_16x16x32_bf16 a[8:11], v[36:39], v[52:55], a[8:11]
    v_mfma_f32_16x16x32_bf16 a[12:15], v[36:39], v[56:59], a[12:15]
    v_mfma_f32_16x16x32_bf16 a[16:19], v[40:43], v[52:55], a[16:19]
    v_mfma_f32_16x16x32_bf16 a[20:23], v[40:43], v[56:59], a[20:23]
    v_mfma_f32_16x16x32_bf16 a[24:27], v[44:47], v[52:55], a[24:27]
    v_mfma_f32_16x16x32_bf16 a[28:31], v[44:47], v[56:59], a[28:31]
    v_mfma_f32_16x16x32_bf16 a[32:35], v[48:51], v[52:55], a[32:35]
    v_mfma_f32_16x16x32_bf16 a[36:39], v[48:51], v[56:59], a[36:39]
    s_waitcnt lgkmcnt(0)
    s_barrier
    ds_read_b128 v[52:55], v20 offset:0
    ds_read_b128 v[56:59], v20 offset:2048
    ds_read_b128 v[32:35], v8 offset:0
    ds_read_b128 v[36:39], v8 offset:512
    ds_read_b128 v[40:43], v8 offset:4096
    ds_read_b128 v[44:47], v8 offset:4608
    ds_read_b128 v[48:51], v10 offset:8192
    v_mfma_f32_16x16x32_bf16 a[0:3], v[60:63], v[80:83], a[0:3]
    v_mfma_f32_16x16x32_bf16 a[4:7], v[60:63], v[84:87], a[4:7]
    v_mfma_f32_16x16x32_bf16 a[8:11], v[64:67], v[80:83], a[8:11]
    v_mfma_f32_16x16x32_bf16 a[12:15], v[64:67], v[84:87], a[12:15]
    v_mfma_f32_16x16x32_bf16 a[16:19], v[68:71], v[80:83], a[16:19]
    v_mfma_f32_16x16x32_bf16 a[20:23], v[68:71], v[84:87], a[20:23]
    v_mfma_f32_16x16x32_bf16 a[24:27], v[72:75], v[80:83], a[24:27]
    v_mfma_f32_16x16x32_bf16 a[28:31], v[72:75], v[84:87], a[28:31]
    v_mfma_f32_16x16x32_bf16 a[32:35], v[76:79], v[80:83], a[32:35]
    v_mfma_f32_16x16x32_bf16 a[36:39], v[76:79], v[84:87], a[36:39]
    ds_read_b128 v[80:83], v21 offset:0
    ds_read_b128 v[84:87], v21 offset:2048
    ds_read_b128 v[60:63], v9 offset:0
    ds_read_b128 v[64:67], v9 offset:512
    ds_read_b128 v[68:71], v9 offset:4096
    ds_read_b128 v[72:75], v9 offset:4608
    ds_read_b128 v[76:79], v11 offset:8192
    s_waitcnt lgkmcnt(7)
    v_mfma_f32_16x16x32_bf16 a[0:3], v[32:35], v[52:55], a[0:3]
    v_mfma_f32_16x16x32_bf16 a[4:7], v[32:35], v[56:59], a[4:7]
    v_mfma_f32_16x16x32_bf16 a[8:11], v[36:39], v[52:55], a[8:11]
    v_mfma_f32_16x16x32_bf16 a[12:15], v[36:39], v[56:59], a[12:15]
    v_mfma_f32_16x16x32_bf16 a[16:19], v[40:43], v[52:55], a[16:19]
    v_mfma_f32_16x16x32_bf16 a[20:23], v[40:43], v[56:59], a[20:23]
    v_mfma_f32_16x16x32_bf16 a[24:27], v[44:47], v[52:55], a[24:27]
    v_mfma_f32_16x16x32_bf16 a[28:31], v[44:47], v[56:59], a[28:31]
    v_mfma_f32_16x16x32_bf16 a[32:35], v[48:51], v[52:55], a[32:35]
    v_mfma_f32_16x16x32_bf16 a[36:39], v[48:51], v[56:59], a[36:39]
    ds_read_b128 v[52:55], v20 offset:16384
    ds_read_b128 v[56:59], v20 offset:18432
    ds_read_b128 v[32:35], v8 offset:10240
    ds_read_b128 v[36:39], v8 offset:10752
    ds_read_b128 v[40:43], v8 offset:14336
    ds_read_b128 v[44:47], v8 offset:14848
    ds_read_b128 v[48:51], v10 offset:18432
    s_waitcnt lgkmcnt(7)
    v_mfma_f32_16x16x32_bf16 a[0:3], v[60:63], v[80:83], a[0:3]
    v_mfma_f32_16x16x32_bf16 a[4:7], v[60:63], v[84:87], a[4:7]
    v_mfma_f32_16x16x32_bf16 a[8:11], v[64:67], v[80:83], a[8:11]
    v_mfma_f32_16x16x32_bf16 a[12:15], v[64:67], v[84:87], a[12:15]
    v_mfma_f32_16x16x32_bf16 a[16:19], v[68:71], v[80:83], a[16:19]
    v_mfma_f32_16x16x32_bf16 a[20:23], v[68:71], v[84:87], a[20:23]
    v_mfma_f32_16x16x32_bf16 a[24:27], v[72:75], v[80:83], a[24:27]
    v_mfma_f32_16x16x32_bf16 a[28:31], v[72:75], v[84:87], a[28:31]
    v_mfma_f32_16x16x32_bf16 a[32:35], v[76:79], v[80:83], a[32:35]
    v_mfma_f32_16x16x32_bf16 a[36:39], v[76:79], v[84:87], a[36:39]
    ds_read_b128 v[80:83], v21 offset:16384
    ds_read_b128 v[84:87], v21 offset:18432
    ds_read_b128 v[60:63], v9 offset:10240
    ds_read_b128 v[64:67], v9 offset:10752
    ds_read_b128 v[68:71], v9 offset:14336
    ds_read_b128 v[72:75], v9 offset:14848
    ds_read_b128 v[76:79], v11 offset:18432
    s_waitcnt lgkmcnt(7)
    v_mfma_f32_16x16x32_bf16 a[0:3], v[32:35], v[52:55], a[0:3]
    v_mfma_f32_16x16x32_bf16 a[4:7], v[32:35], v[56:59], a[4:7]
    v_mfma_f32_16x16x32_bf16 a[8:11], v[36:39], v[52:55], a[8:11]
    v_mfma_f32_16x16x32_bf16 a[12:15], v[36:39], v[56:59], a[12:15]
    v_mfma_f32_16x16x32_bf16 a[16:19], v[40:43], v[52:55], a[16:19]
    v_mfma_f32_16x16x32_bf16 a[20:23], v[40:43], v[56:59], a[20:23]
    v_mfma_f32_16x16x32_bf16 a[24:27], v[44:47], v[52:55], a[24:27]
    v_mfma_f32_16x16x32_bf16 a[28:31], v[44:47], v[56:59], a[28:31]
    v_mfma_f32_16x16x32_bf16 a[32:35], v[48:51], v[52:55], a[32:35]
    v_mfma_f32_16x16x32_bf16 a[36:39], v[48:51], v[56:59], a[36:39]
    s_waitcnt lgkmcnt(0)
    s_barrier
    ds_read_b128 v[52:55], v22 offset:0
    ds_read_b128 v[56:59], v22 offset:2048
    ds_read_b128 v[32:35], v12 offset:0
    ds_read_b128 v[36:39], v12 offset:512
    ds_read_b128 v[40:43], v12 offset:4096
    ds_read_b128 v[44:47], v12 offset:4608
    ds_read_b128 v[48:51], v14 offset:8192
    v_mfma_f32_16x16x32_bf16 a[0:3], v[60:63], v[80:83], a[0:3]
    v_mfma_f32_16x16x32_bf16 a[4:7], v[60:63], v[84:87], a[4:7]
    v_mfma_f32_16x16x32_bf16 a[8:11], v[64:67], v[80:83], a[8:11]
    v_mfma_f32_16x16x32_bf16 a[12:15], v[64:67], v[84:87], a[12:15]
    v_mfma_f32_16x16x32_bf16 a[16:19], v[68:71], v[80:83], a[16:19]
    v_mfma_f32_16x16x32_bf16 a[20:23], v[68:71], v[84:87], a[20:23]
    v_mfma_f32_16x16x32_bf16 a[24:27], v[72:75], v[80:83], a[24:27]
    v_mfma_f32_16x16x32_bf16 a[28:31], v[72:75], v[84:87], a[28:31]
    v_mfma_f32_16x16x32_bf16 a[32:35], v[76:79], v[80:83], a[32:35]
    v_mfma_f32_16x16x32_bf16 a[36:39], v[76:79], v[84:87], a[36:39]
    ds_read_b128 v[80:83], v23 offset:0
    ds_read_b128 v[84:87], v23 offset:2048
    ds_read_b128 v[60:63], v13 offset:0
    ds_read_b128 v[64:67], v13 offset:512
    ds_read_b128 v[68:71], v13 offset:4096
    ds_read_b128 v[72:75], v13 offset:4608
    ds_read_b128 v[76:79], v15 offset:8192
    s_waitcnt lgkmcnt(7)
    v_mfma_f32_16x16x32_bf16 a[0:3], v[32:35], v[52:55], a[0:3]
    v_mfma_f32_16x16x32_bf16 a[4:7], v[32:35], v[56:59], a[4:7]
    v_mfma_f32_16x16x32_bf16 a[8:11], v[36:39], v[52:55], a[8:11]
    v_mfma_f32_16x16x32_bf16 a[12:15], v[36:39], v[56:59], a[12:15]
    v_mfma_f32_16x16x32_bf16 a[16:19], v[40:43], v[52:55], a[16:19]
    v_mfma_f32_16x16x32_bf16 a[20:23], v[40:43], v[56:59], a[20:23]
    v_mfma_f32_16x16x32_bf16 a[24:27], v[44:47], v[52:55], a[24:27]
    v_mfma_f32_16x16x32_bf16 a[28:31], v[44:47], v[56:59], a[28:31]
    v_mfma_f32_16x16x32_bf16 a[32:35], v[48:51], v[52:55], a[32:35]
    v_mfma_f32_16x16x32_bf16 a[36:39], v[48:51], v[56:59], a[36:39]
    ds_read_b128 v[52:55], v22 offset:16384
    ds_read_b128 v[56:59], v22 offset:18432
    ds_read_b128 v[32:35], v12 offset:10240
    ds_read_b128 v[36:39], v12 offset:10752
    ds_read_b128 v[40:43], v12 offset:14336
    ds_read_b128 v[44:47], v12 offset:14848
    ds_read_b128 v[48:51], v14 offset:18432
    s_waitcnt lgkmcnt(7)
    v_mfma_f32_16x16x32_bf16 a[0:3], v[60:63], v[80:83], a[0:3]
    v_mfma_f32_16x16x32_bf16 a[4:7], v[60:63], v[84:87], a[4:7]
    v_mfma_f32_16x16x32_bf16 a[8:11], v[64:67], v[80:83], a[8:11]
    v_mfma_f32_16x16x32_bf16 a[12:15], v[64:67], v[84:87], a[12:15]
    v_mfma_f32_16x16x32_bf16 a[16:19], v[68:71], v[80:83], a[16:19]
    v_mfma_f32_16x16x32_bf16 a[20:23], v[68:71], v[84:87], a[20:23]
    v_mfma_f32_16x16x32_bf16 a[24:27], v[72:75], v[80:83], a[24:27]
    v_mfma_f32_16x16x32_bf16 a[28:31], v[72:75], v[84:87], a[28:31]
    v_mfma_f32_16x16x32_bf16 a[32:35], v[76:79], v[80:83], a[32:35]
    v_mfma_f32_16x16x32_bf16 a[36:39], v[76:79], v[84:87], a[36:39]
    ds_read_b128 v[80:83], v23 offset:16384
    ds_read_b128 v[84:87], v23 offset:18432
    ds_read_b128 v[60:63], v13 offset:10240
    ds_read_b128 v[64:67], v13 offset:10752
    ds_read_b128 v[68:71], v13 offset:14336
    ds_read_b128 v[72:75], v13 offset:14848
    ds_read_b128 v[76:79], v15 offset:18432
    s_waitcnt lgkmcnt(7)
    v_mfma_f32_16x16x32_bf16 a[0:3], v[32:35], v[52:55], a[0:3]
    v_mfma_f32_16x16x32_bf16 a[4:7], v[32:35], v[56:59], a[4:7]
    v_mfma_f32_16x16x32_bf16 a[8:11], v[36:39], v[52:55], a[8:11]
    v_mfma_f32_16x16x32_bf16 a[12:15], v[36:39], v[56:59], a[12:15]
    v_mfma_f32_16x16x32_bf16 a[16:19], v[40:43], v[52:55], a[16:19]
    v_mfma_f32_16x16x32_bf16 a[20:23], v[40:43], v[56:59], a[20:23]
    v_mfma_f32_16x16x32_bf16 a[24:27], v[44:47], v[52:55], a[24:27]
    v_mfma_f32_16x16x32_bf16 a[28:31], v[44:47], v[56:59], a[28:31]
    v_mfma_f32_16x16x32_bf16 a[32:35], v[48:51], v[52:55], a[32:35]
    v_mfma_f32_16x16x32_bf16 a[36:39], v[48:51], v[56:59], a[36:39]
    s_waitcnt lgkmcnt(0)
    s_barrier
    ds_read_b128 v[52:55], v24 offset:0
    ds_read_b128 v[56:59], v24 offset:2048
    ds_read_b128 v[32:35], v16 offset:0
    ds_read_b128 v[36:39], v16 offset:512
    ds_read_b128 v[40:43], v16 offset:4096
    ds_read_b128 v[44:47], v16 offset:4608
    ds_read_b128 v[48:51], v18 offset:8192
    v_mfma_f32_16x16x32_bf16 a[0:3], v[60:63], v[80:83], a[0:3]
    v_mfma_f32_16x16x32_bf16 a[4:7], v[60:63], v[84:87], a[4:7]
    v_mfma_f32_16x16x32_bf16 a[8:11], v[64:67], v[80:83], a[8:11]
    v_mfma_f32_16x16x32_bf16 a[12:15], v[64:67], v[84:87], a[12:15]
    v_mfma_f32_16x16x32_bf16 a[16:19], v[68:71], v[80:83], a[16:19]
    v_mfma_f32_16x16x32_bf16 a[20:23], v[68:71], v[84:87], a[20:23]
    v_mfma_f32_16x16x32_bf16 a[24:27], v[72:75], v[80:83], a[24:27]
    v_mfma_f32_16x16x32_bf16 a[28:31], v[72:75], v[84:87], a[28:31]
    v_mfma_f32_16x16x32_bf16 a[32:35], v[76:79], v[80:83], a[32:35]
    v_mfma_f32_16x16x32_bf16 a[36:39], v[76:79], v[84:87], a[36:39]
    ds_read_b128 v[80:83], v25 offset:0
    ds_read_b128 v[84:87], v25 offset:2048
    ds_read_b128 v[60:63], v17 offset:0
    ds_read_b128 v[64:67], v17 offset:512
    ds_read_b128 v[68:71], v17 offset:4096
    ds_read_b128 v[72:75], v17 offset:4608
    ds_read_b128 v[76:79], v19 offset:8192
    s_waitcnt lgkmcnt(7)
    v_mfma_f32_16x16x32_bf16 a[0:3], v[32:35], v[52:55], a[0:3]
    v_mfma_f32_16x16x32_bf16 a[4:7], v[32:35], v[56:59], a[4:7]
    v_mfma_f32_16x16x32_bf16 a[8:11], v[36:39], v[52:55], a[8:11]
    v_mfma_f32_16x16x32_bf16 a[12:15], v[36:39], v[56:59], a[12:15]
    v_mfma_f32_16x16x32_bf16 a[16:19], v[40:43], v[52:55], a[16:19]
    v_mfma_f32_16x16x32_bf16 a[20:23], v[40:43], v[56:59], a[20:23]
    v_mfma_f32_16x16x32_bf16 a[24:27], v[44:47], v[52:55], a[24:27]
    v_mfma_f32_16x16x32_bf16 a[28:31], v[44:47], v[56:59], a[28:31]
    v_mfma_f32_16x16x32_bf16 a[32:35], v[48:51], v[52:55], a[32:35]
    v_mfma_f32_16x16x32_bf16 a[36:39], v[48:51], v[56:59], a[36:39]
    ds_read_b128 v[52:55], v24 offset:16384
    ds_read_b128 v[56:59], v24 offset:18432
    ds_read_b128 v[32:35], v16 offset:10240
    ds_read_b128 v[36:39], v16 offset:10752
    ds_read_b128 v[40:43], v16 offset:14336
    ds_read_b128 v[44:47], v16 offset:14848
    ds_read_b128 v[48:51], v18 offset:18432
    s_waitcnt lgkmcnt(7)
    v_mfma_f32_16x16x32_bf16 a[0:3], v[60:63], v[80:83], a[0:3]
    v_mfma_f32_16x16x32_bf16 a[4:7], v[60:63], v[84:87], a[4:7]
    v_mfma_f32_16x16x32_bf16 a[8:11], v[64:67], v[80:83], a[8:11]
    v_mfma_f32_16x16x32_bf16 a[12:15], v[64:67], v[84:87], a[12:15]
    v_mfma_f32_16x16x32_bf16 a[16:19], v[68:71], v[80:83], a[16:19]
    v_mfma_f32_16x16x32_bf16 a[20:23], v[68:71], v[84:87], a[20:23]
    v_mfma_f32_16x16x32_bf16 a[24:27], v[72:75], v[80:83], a[24:27]
    v_mfma_f32_16x16x32_bf16 a[28:31], v[72:75], v[84:87], a[28:31]
    v_mfma_f32_16x16x32_bf16 a[32:35], v[76:79], v[80:83], a[32:35]
    v_mfma_f32_16x16x32_bf16 a[36:39], v[76:79], v[84:87], a[36:39]
    ds_read_b128 v[80:83], v25 offset:16384
    ds_read_b128 v[84:87], v25 offset:18432
    ds_read_b128 v[60:63], v17 offset:10240
    ds_read_b128 v[64:67], v17 offset:10752
    ds_read_b128 v[68:71], v17 offset:14336
    ds_read_b128 v[72:75], v17 offset:14848
    ds_read_b128 v[76:79], v19 offset:18432
    s_waitcnt lgkmcnt(7)
    v_mfma_f32_16x16x32_bf16 a[0:3], v[32:35], v[52:55], a[0:3]
    v_mfma_f32_16x16x32_bf16 a[4:7], v[32:35], v[56:59], a[4:7]
    v_mfma_f32_16x16x32_bf16 a[8:11], v[36:39], v[52:55], a[8:11]
    v_mfma_f32_16x16x32_bf16 a[12:15], v[36:39], v[56:59], a[12:15]
    v_mfma_f32_16x16x32_bf16 a[16:19], v[40:43], v[52:55], a[16:19]
    v_mfma_f32_16x16x32_bf16 a[20:23], v[40:43], v[56:59], a[20:23]
    v_mfma_f32_16x16x32_bf16 a[24:27], v[44:47], v[52:55], a[24:27]
    v_mfma_f32_16x16x32_bf16 a[28:31], v[44:47], v[56:59], a[28:31]
    v_mfma_f32_16x16x32_bf16 a[32:35], v[48:51], v[52:55], a[32:35]
    v_mfma_f32_16x16x32_bf16 a[36:39], v[48:51], v[56:59], a[36:39]
    s_waitcnt lgkmcnt(0)
    s_barrier
    ds_read_b128 v[52:55], v20 offset:0
    ds_read_b128 v[56:59], v20 offset:2048
    ds_read_b128 v[32:35], v8 offset:0
    ds_read_b128 v[36:39], v8 offset:512
    ds_read_b128 v[40:43], v8 offset:4096
    ds_read_b128 v[44:47], v8 offset:4608
    ds_read_b128 v[48:51], v10 offset:8192
    v_mfma_f32_16x16x32_bf16 a[0:3], v[60:63], v[80:83], a[0:3]
    v_mfma_f32_16x16x32_bf16 a[4:7], v[60:63], v[84:87], a[4:7]
    v_mfma_f32_16x16x32_bf16 a[8:11], v[64:67], v[80:83], a[8:11]
    v_mfma_f32_16x16x32_bf16 a[12:15], v[64:67], v[84:87], a[12:15]
    v_mfma_f32_16x16x32_bf16 a[16:19], v[68:71], v[80:83], a[16:19]
    v_mfma_f32_16x16x32_bf16 a[20:23], v[68:71], v[84:87], a[20:23]
    v_mfma_f32_16x16x32_bf16 a[24:27], v[72:75], v[80:83], a[24:27]
    v_mfma_f32_16x16x32_bf16 a[28:31], v[72:75], v[84:87], a[28:31]
    v_mfma_f32_16x16x32_bf16 a[32:35], v[76:79], v[80:83], a[32:35]
    v_mfma_f32_16x16x32_bf16 a[36:39], v[76:79], v[84:87], a[36:39]
    ds_read_b128 v[80:83], v21 offset:0
    ds_read_b128 v[84:87], v21 offset:2048
    ds_read_b128 v[60:63], v9 offset:0
    ds_read_b128 v[64:67], v9 offset:512
    ds_read_b128 v[68:71], v9 offset:4096
    ds_read_b128 v[72:75], v9 offset:4608
    ds_read_b128 v[76:79], v11 offset:8192
    s_waitcnt lgkmcnt(7)
    v_mfma_f32_16x16x32_bf16 a[0:3], v[32:35], v[52:55], a[0:3]
    v_mfma_f32_16x16x32_bf16 a[4:7], v[32:35], v[56:59], a[4:7]
    v_mfma_f32_16x16x32_bf16 a[8:11], v[36:39], v[52:55], a[8:11]
    v_mfma_f32_16x16x32_bf16 a[12:15], v[36:39], v[56:59], a[12:15]
    v_mfma_f32_16x16x32_bf16 a[16:19], v[40:43], v[52:55], a[16:19]
    v_mfma_f32_16x16x32_bf16 a[20:23], v[40:43], v[56:59], a[20:23]
    v_mfma_f32_16x16x32_bf16 a[24:27], v[44:47], v[52:55], a[24:27]
    v_mfma_f32_16x16x32_bf16 a[28:31], v[44:47], v[56:59], a[28:31]
    v_mfma_f32_16x16x32_bf16 a[32:35], v[48:51], v[52:55], a[32:35]
    v_mfma_f32_16x16x32_bf16 a[36:39], v[48:51], v[56:59], a[36:39]
    ds_read_b128 v[52:55], v20 offset:16384
    ds_read_b128 v[56:59], v20 offset:18432
    ds_read_b128 v[32:35], v8 offset:10240
    ds_read_b128 v[36:39], v8 offset:10752
    ds_read_b128 v[40:43], v8 offset:14336
    ds_read_b128 v[44:47], v8 offset:14848
    ds_read_b128 v[48:51], v10 offset:18432
    s_waitcnt lgkmcnt(7)
    v_mfma_f32_16x16x32_bf16 a[0:3], v[60:63], v[80:83], a[0:3]
    v_mfma_f32_16x16x32_bf16 a[4:7], v[60:63], v[84:87], a[4:7]
    v_mfma_f32_16x16x32_bf16 a[8:11], v[64:67], v[80:83], a[8:11]
    v_mfma_f32_16x16x32_bf16 a[12:15], v[64:67], v[84:87], a[12:15]
    v_mfma_f32_16x16x32_bf16 a[16:19], v[68:71], v[80:83], a[16:19]
    v_mfma_f32_16x16x32_bf16 a[20:23], v[68:71], v[84:87], a[20:23]
    v_mfma_f32_16x16x32_bf16 a[24:27], v[72:75], v[80:83], a[24:27]
    v_mfma_f32_16x16x32_bf16 a[28:31], v[72:75], v[84:87], a[28:31]
    v_mfma_f32_16x16x32_bf16 a[32:35], v[76:79], v[80:83], a[32:35]
    v_mfma_f32_16x16x32_bf16 a[36:39], v[76:79], v[84:87], a[36:39]
    ds_read_b128 v[80:83], v21 offset:16384
    ds_read_b128 v[84:87], v21 offset:18432
    ds_read_b128 v[60:63], v9 offset:10240
    ds_read_b128 v[64:67], v9 offset:10752
    ds_read_b128 v[68:71], v9 offset:14336
    ds_read_b128 v[72:75], v9 offset:14848
    ds_read_b128 v[76:79], v11 offset:18432
    s_waitcnt lgkmcnt(7)
    v_mfma_f32_16x16x32_bf16 a[0:3], v[32:35], v[52:55], a[0:3]
    v_mfma_f32_16x16x32_bf16 a[4:7], v[32:35], v[56:59], a[4:7]
    v_mfma_f32_16x16x32_bf16 a[8:11], v[36:39], v[52:55], a[8:11]
    v_mfma_f32_16x16x32_bf16 a[12:15], v[36:39], v[56:59], a[12:15]
    v_mfma_f32_16x16x32_bf16 a[16:19], v[40:43], v[52:55], a[16:19]
    v_mfma_f32_16x16x32_bf16 a[20:23], v[40:43], v[56:59], a[20:23]
    v_mfma_f32_16x16x32_bf16 a[24:27], v[44:47], v[52:55], a[24:27]
    v_mfma_f32_16x16x32_bf16 a[28:31], v[44:47], v[56:59], a[28:31]
    v_mfma_f32_16x16x32_bf16 a[32:35], v[48:51], v[52:55], a[32:35]
    v_mfma_f32_16x16x32_bf16 a[36:39], v[48:51], v[56:59], a[36:39]
    s_waitcnt lgkmcnt(0)
    s_barrier
    ds_read_b128 v[52:55], v22 offset:0
    ds_read_b128 v[56:59], v22 offset:2048
    ds_read_b128 v[32:35], v12 offset:0
    ds_read_b128 v[36:39], v12 offset:512
    ds_read_b128 v[40:43], v12 offset:4096
    ds_read_b128 v[44:47], v12 offset:4608
    ds_read_b128 v[48:51], v14 offset:8192
    v_mfma_f32_16x16x32_bf16 a[0:3], v[60:63], v[80:83], a[0:3]
    v_mfma_f32_16x16x32_bf16 a[4:7], v[60:63], v[84:87], a[4:7]
    v_mfma_f32_16x16x32_bf16 a[8:11], v[64:67], v[80:83], a[8:11]
    v_mfma_f32_16x16x32_bf16 a[12:15], v[64:67], v[84:87], a[12:15]
    v_mfma_f32_16x16x32_bf16 a[16:19], v[68:71], v[80:83], a[16:19]
    v_mfma_f32_16x16x32_bf16 a[20:23], v[68:71], v[84:87], a[20:23]
    v_mfma_f32_16x16x32_bf16 a[24:27], v[72:75], v[80:83], a[24:27]
    v_mfma_f32_16x16x32_bf16 a[28:31], v[72:75], v[84:87], a[28:31]
    v_mfma_f32_16x16x32_bf16 a[32:35], v[76:79], v[80:83], a[32:35]
    v_mfma_f32_16x16x32_bf16 a[36:39], v[76:79], v[84:87], a[36:39]
    ds_read_b128 v[80:83], v23 offset:0
    ds_read_b128 v[84:87], v23 offset:2048
    ds_read_b128 v[60:63], v13 offset:0
    ds_read_b128 v[64:67], v13 offset:512
    ds_read_b128 v[68:71], v13 offset:4096
    ds_read_b128 v[72:75], v13 offset:4608
    ds_read_b128 v[76:79], v15 offset:8192
    s_waitcnt lgkmcnt(7)
    v_mfma_f32_16x16x32_bf16 a[0:3], v[32:35], v[52:55], a[0:3]
    v_mfma_f32_16x16x32_bf16 a[4:7], v[32:35], v[56:59], a[4:7]
    v_mfma_f32_16x16x32_bf16 a[8:11], v[36:39], v[52:55], a[8:11]
    v_mfma_f32_16x16x32_bf16 a[12:15], v[36:39], v[56:59], a[12:15]
    v_mfma_f32_16x16x32_bf16 a[16:19], v[40:43], v[52:55], a[16:19]
    v_mfma_f32_16x16x32_bf16 a[20:23], v[40:43], v[56:59], a[20:23]
    v_mfma_f32_16x16x32_bf16 a[24:27], v[44:47], v[52:55], a[24:27]
    v_mfma_f32_16x16x32_bf16 a[28:31], v[44:47], v[56:59], a[28:31]
    v_mfma_f32_16x16x32_bf16 a[32:35], v[48:51], v[52:55], a[32:35]
    v_mfma_f32_16x16x32_bf16 a[36:39], v[48:51], v[56:59], a[36:39]
    ds_read_b128 v[52:55], v22 offset:16384
    ds_read_b128 v[56:59], v22 offset:18432
    ds_read_b128 v[32:35], v12 offset:10240
    ds_read_b128 v[36:39], v12 offset:10752
    ds_read_b128 v[40:43], v12 offset:14336
    ds_read_b128 v[44:47], v12 offset:14848
    ds_read_b128 v[48:51], v14 offset:18432
    s_waitcnt lgkmcnt(7)
    v_mfma_f32_16x16x32_bf16 a[0:3], v[60:63], v[80:83], a[0:3]
    v_mfma_f32_16x16x32_bf16 a[4:7], v[60:63], v[84:87], a[4:7]
    v_mfma_f32_16x16x32_bf16 a[8:11], v[64:67], v[80:83], a[8:11]
    v_mfma_f32_16x16x32_bf16 a[12:15], v[64:67], v[84:87], a[12:15]
    v_mfma_f32_16x16x32_bf16 a[16:19], v[68:71], v[80:83], a[16:19]
    v_mfma_f32_16x16x32_bf16 a[20:23], v[68:71], v[84:87], a[20:23]
    v_mfma_f32_16x16x32_bf16 a[24:27], v[72:75], v[80:83], a[24:27]
    v_mfma_f32_16x16x32_bf16 a[28:31], v[72:75], v[84:87], a[28:31]
    v_mfma_f32_16x16x32_bf16 a[32:35], v[76:79], v[80:83], a[32:35]
    v_mfma_f32_16x16x32_bf16 a[36:39], v[76:79], v[84:87], a[36:39]
    ds_read_b128 v[80:83], v23 offset:16384
    ds_read_b128 v[84:87], v23 offset:18432
    ds_read_b128 v[60:63], v13 offset:10240
    ds_read_b128 v[64:67], v13 offset:10752
    ds_read_b128 v[68:71], v13 offset:14336
    ds_read_b128 v[72:75], v13 offset:14848
    ds_read_b128 v[76:79], v15 offset:18432
    s_waitcnt lgkmcnt(7)
    v_mfma_f32_16x16x32_bf16 a[0:3], v[32:35], v[52:55], a[0:3]
    v_mfma_f32_16x16x32_bf16 a[4:7], v[32:35], v[56:59], a[4:7]
    v_mfma_f32_16x16x32_bf16 a[8:11], v[36:39], v[52:55], a[8:11]
    v_mfma_f32_16x16x32_bf16 a[12:15], v[36:39], v[56:59], a[12:15]
    v_mfma_f32_16x16x32_bf16 a[16:19], v[40:43], v[52:55], a[16:19]
    v_mfma_f32_16x16x32_bf16 a[20:23], v[40:43], v[56:59], a[20:23]
    v_mfma_f32_16x16x32_bf16 a[24:27], v[44:47], v[52:55], a[24:27]
    v_mfma_f32_16x16x32_bf16 a[28:31], v[44:47], v[56:59], a[28:31]
    v_mfma_f32_16x16x32_bf16 a[32:35], v[48:51], v[52:55], a[32:35]
    v_mfma_f32_16x16x32_bf16 a[36:39], v[48:51], v[56:59], a[36:39]
    s_waitcnt lgkmcnt(0)
    s_barrier
    ds_read_b128 v[52:55], v24 offset:0
    ds_read_b128 v[56:59], v24 offset:2048
    ds_read_b128 v[32:35], v16 offset:0
    ds_read_b128 v[36:39], v16 offset:512
    ds_read_b128 v[40:43], v16 offset:4096
    ds_read_b128 v[44:47], v16 offset:4608
    ds_read_b128 v[48:51], v18 offset:8192
    v_mfma_f32_16x16x32_bf16 a[0:3], v[60:63], v[80:83], a[0:3]
    v_mfma_f32_16x16x32_bf16 a[4:7], v[60:63], v[84:87], a[4:7]
    v_mfma_f32_16x16x32_bf16 a[8:11], v[64:67], v[80:83], a[8:11]
    v_mfma_f32_16x16x32_bf16 a[12:15], v[64:67], v[84:87], a[12:15]
    v_mfma_f32_16x16x32_bf16 a[16:19], v[68:71], v[80:83], a[16:19]
    v_mfma_f32_16x16x32_bf16 a[20:23], v[68:71], v[84:87], a[20:23]
    v_mfma_f32_16x16x32_bf16 a[24:27], v[72:75], v[80:83], a[24:27]
    v_mfma_f32_16x16x32_bf16 a[28:31], v[72:75], v[84:87], a[28:31]
    v_mfma_f32_16x16x32_bf16 a[32:35], v[76:79], v[80:83], a[32:35]
    v_mfma_f32_16x16x32_bf16 a[36:39], v[76:79], v[84:87], a[36:39]
    ds_read_b128 v[80:83], v25 offset:0
    ds_read_b128 v[84:87], v25 offset:2048
    ds_read_b128 v[60:63], v17 offset:0
    ds_read_b128 v[64:67], v17 offset:512
    ds_read_b128 v[68:71], v17 offset:4096
    ds_read_b128 v[72:75], v17 offset:4608
    ds_read_b128 v[76:79], v19 offset:8192
    s_waitcnt lgkmcnt(7)
    v_mfma_f32_16x16x32_bf16 a[0:3], v[32:35], v[52:55], a[0:3]
    v_mfma_f32_16x16x32_bf16 a[4:7], v[32:35], v[56:59], a[4:7]
    v_mfma_f32_16x16x32_bf16 a[8:11], v[36:39], v[52:55], a[8:11]
    v_mfma_f32_16x16x32_bf16 a[12:15], v[36:39], v[56:59], a[12:15]
    v_mfma_f32_16x16x32_bf16 a[16:19], v[40:43], v[52:55], a[16:19]
    v_mfma_f32_16x16x32_bf16 a[20:23], v[40:43], v[56:59], a[20:23]
    v_mfma_f32_16x16x32_bf16 a[24:27], v[44:47], v[52:55], a[24:27]
    v_mfma_f32_16x16x32_bf16 a[28:31], v[44:47], v[56:59], a[28:31]
    v_mfma_f32_16x16x32_bf16 a[32:35], v[48:51], v[52:55], a[32:35]
    v_mfma_f32_16x16x32_bf16 a[36:39], v[48:51], v[56:59], a[36:39]
    ds_read_b128 v[52:55], v24 offset:16384
    ds_read_b128 v[56:59], v24 offset:18432
    ds_read_b128 v[32:35], v16 offset:10240
    ds_read_b128 v[36:39], v16 offset:10752
    ds_read_b128 v[40:43], v16 offset:14336
    ds_read_b128 v[44:47], v16 offset:14848
    ds_read_b128 v[48:51], v18 offset:18432
    s_waitcnt lgkmcnt(7)
    v_mfma_f32_16x16x32_bf16 a[0:3], v[60:63], v[80:83], a[0:3]
    v_mfma_f32_16x16x32_bf16 a[4:7], v[60:63], v[84:87], a[4:7]
    v_mfma_f32_16x16x32_bf16 a[8:11], v[64:67], v[80:83], a[8:11]
    v_mfma_f32_16x16x32_bf16 a[12:15], v[64:67], v[84:87], a[12:15]
    v_mfma_f32_16x16x32_bf16 a[16:19], v[68:71], v[80:83], a[16:19]
    v_mfma_f32_16x16x32_bf16 a[20:23], v[68:71], v[84:87], a[20:23]
    v_mfma_f32_16x16x32_bf16 a[24:27], v[72:75], v[80:83], a[24:27]
    v_mfma_f32_16x16x32_bf16 a[28:31], v[72:75], v[84:87], a[28:31]
    v_mfma_f32_16x16x32_bf16 a[32:35], v[76:79], v[80:83], a[32:35]
    v_mfma_f32_16x16x32_bf16 a[36:39], v[76:79], v[84:87], a[36:39]
    ds_read_b128 v[80:83], v25 offset:16384
    ds_read_b128 v[84:87], v25 offset:18432
    ds_read_b128 v[60:63], v17 offset:10240
    ds_read_b128 v[64:67], v17 offset:10752
    ds_read_b128 v[68:71], v17 offset:14336
    ds_read_b128 v[72:75], v17 offset:14848
    ds_read_b128 v[76:79], v19 offset:18432
    s_waitcnt lgkmcnt(7)
    v_mfma_f32_16x16x32_bf16 a[0:3], v[32:35], v[52:55], a[0:3]
    v_mfma_f32_16x16x32_bf16 a[4:7], v[32:35], v[56:59], a[4:7]
    v_mfma_f32_16x16x32_bf16 a[8:11], v[36:39], v[52:55], a[8:11]
    v_mfma_f32_16x16x32_bf16 a[12:15], v[36:39], v[56:59], a[12:15]
    v_mfma_f32_16x16x32_bf16 a[16:19], v[40:43], v[52:55], a[16:19]
    v_mfma_f32_16x16x32_bf16 a[20:23], v[40:43], v[56:59], a[20:23]
    v_mfma_f32_16x16x32_bf16 a[24:27], v[44:47], v[52:55], a[24:27]
    v_mfma_f32_16x16x32_bf16 a[28:31], v[44:47], v[56:59], a[28:31]
    v_mfma_f32_16x16x32_bf16 a[32:35], v[48:51], v[52:55], a[32:35]
    v_mfma_f32_16x16x32_bf16 a[36:39], v[48:51], v[56:59], a[36:39]
    s_waitcnt lgkmcnt(0)
    s_barrier
    ds_read_b128 v[52:55], v20 offset:0
    ds_read_b128 v[56:59], v20 offset:2048
    ds_read_b128 v[32:35], v8 offset:0
    ds_read_b128 v[36:39], v8 offset:512
    ds_read_b128 v[40:43], v8 offset:4096
    ds_read_b128 v[44:47], v8 offset:4608
    ds_read_b128 v[48:51], v10 offset:8192
    v_mfma_f32_16x16x32_bf16 a[0:3], v[60:63], v[80:83], a[0:3]
    v_mfma_f32_16x16x32_bf16 a[4:7], v[60:63], v[84:87], a[4:7]
    v_mfma_f32_16x16x32_bf16 a[8:11], v[64:67], v[80:83], a[8:11]
    v_mfma_f32_16x16x32_bf16 a[12:15], v[64:67], v[84:87], a[12:15]
    v_mfma_f32_16x16x32_bf16 a[16:19], v[68:71], v[80:83], a[16:19]
    v_mfma_f32_16x16x32_bf16 a[20:23], v[68:71], v[84:87], a[20:23]
    v_mfma_f32_16x16x32_bf16 a[24:27], v[72:75], v[80:83], a[24:27]
    v_mfma_f32_16x16x32_bf16 a[28:31], v[72:75], v[84:87], a[28:31]
    v_mfma_f32_16x16x32_bf16 a[32:35], v[76:79], v[80:83], a[32:35]
    v_mfma_f32_16x16x32_bf16 a[36:39], v[76:79], v[84:87], a[36:39]
    ds_read_b128 v[80:83], v21 offset:0
    ds_read_b128 v[84:87], v21 offset:2048
    ds_read_b128 v[60:63], v9 offset:0
    ds_read_b128 v[64:67], v9 offset:512
    ds_read_b128 v[68:71], v9 offset:4096
    ds_read_b128 v[72:75], v9 offset:4608
    ds_read_b128 v[76:79], v11 offset:8192
    s_waitcnt lgkmcnt(7)
    v_mfma_f32_16x16x32_bf16 a[0:3], v[32:35], v[52:55], a[0:3]
    v_mfma_f32_16x16x32_bf16 a[4:7], v[32:35], v[56:59], a[4:7]
    v_mfma_f32_16x16x32_bf16 a[8:11], v[36:39], v[52:55], a[8:11]
    v_mfma_f32_16x16x32_bf16 a[12:15], v[36:39], v[56:59], a[12:15]
    v_mfma_f32_16x16x32_bf16 a[16:19], v[40:43], v[52:55], a[16:19]
    v_mfma_f32_16x16x32_bf16 a[20:23], v[40:43], v[56:59], a[20:23]
    v_mfma_f32_16x16x32_bf16 a[24:27], v[44:47], v[52:55], a[24:27]
    v_mfma_f32_16x16x32_bf16 a[28:31], v[44:47], v[56:59], a[28:31]
    v_mfma_f32_16x16x32_bf16 a[32:35], v[48:51], v[52:55], a[32:35]
    v_mfma_f32_16x16x32_bf16 a[36:39], v[48:51], v[56:59], a[36:39]
    ds_read_b128 v[52:55], v20 offset:16384
    ds_read_b128 v[56:59], v20 offset:18432
    ds_read_b128 v[32:35], v8 offset:10240
    ds_read_b128 v[36:39], v8 offset:10752
    ds_read_b128 v[40:43], v8 offset:14336
    ds_read_b128 v[44:47], v8 offset:14848
    ds_read_b128 v[48:51], v10 offset:18432
    s_waitcnt lgkmcnt(7)
    v_mfma_f32_16x16x32_bf16 a[0:3], v[60:63], v[80:83], a[0:3]
    v_mfma_f32_16x16x32_bf16 a[4:7], v[60:63], v[84:87], a[4:7]
    v_mfma_f32_16x16x32_bf16 a[8:11], v[64:67], v[80:83], a[8:11]
    v_mfma_f32_16x16x32_bf16 a[12:15], v[64:67], v[84:87], a[12:15]
    v_mfma_f32_16x16x32_bf16 a[16:19], v[68:71], v[80:83], a[16:19]
    v_mfma_f32_16x16x32_bf16 a[20:23], v[68:71], v[84:87], a[20:23]
    v_mfma_f32_16x16x32_bf16 a[24:27], v[72:75], v[80:83], a[24:27]
    v_mfma_f32_16x16x32_bf16 a[28:31], v[72:75], v[84:87], a[28:31]
    v_mfma_f32_16x16x32_bf16 a[32:35], v[76:79], v[80:83], a[32:35]
    v_mfma_f32_16x16x32_bf16 a[36:39], v[76:79], v[84:87], a[36:39]
    ds_read_b128 v[80:83], v21 offset:16384
    ds_read_b128 v[84:87], v21 offset:18432
    ds_read_b128 v[60:63], v9 offset:10240
    ds_read_b128 v[64:67], v9 offset:10752
    ds_read_b128 v[68:71], v9 offset:14336
    ds_read_b128 v[72:75], v9 offset:14848
    ds_read_b128 v[76:79], v11 offset:18432
    s_waitcnt lgkmcnt(7)
    v_mfma_f32_16x16x32_bf16 a[0:3], v[32:35], v[52:55], a[0:3]
    v_mfma_f32_16x16x32_bf16 a[4:7], v[32:35], v[56:59], a[4:7]
    v_mfma_f32_16x16x32_bf16 a[8:11], v[36:39], v[52:55], a[8:11]
    v_mfma_f32_16x16x32_bf16 a[12:15], v[36:39], v[56:59], a[12:15]
    v_mfma_f32_16x16x32_bf16 a[16:19], v[40:43], v[52:55], a[16:19]
    v_mfma_f32_16x16x32_bf16 a[20:23], v[40:43], v[56:59], a[20:23]
    v_mfma_f32_16x16x32_bf16 a[24:27], v[44:47], v[52:55], a[24:27]
    v_mfma_f32_16x16x32_bf16 a[28:31], v[44:47], v[56:59], a[28:31]
    v_mfma_f32_16x16x32_bf16 a[32:35], v[48:51], v[52:55], a[32:35]
    v_mfma_f32_16x16x32_bf16 a[36:39], v[48:51], v[56:59], a[36:39]
    s_waitcnt lgkmcnt(0)
    s_barrier
    ds_read_b128 v[52:55], v22 offset:0
    ds_read_b128 v[56:59], v22 offset:2048
    ds_read_b128 v[32:35], v12 offset:0
    ds_read_b128 v[36:39], v12 offset:512
    ds_read_b128 v[40:43], v12 offset:4096
    ds_read_b128 v[44:47], v12 offset:4608
    ds_read_b128 v[48:51], v14 offset:8192
    v_mfma_f32_16x16x32_bf16 a[0:3], v[60:63], v[80:83], a[0:3]
    v_mfma_f32_16x16x32_bf16 a[4:7], v[60:63], v[84:87], a[4:7]
    v_mfma_f32_16x16x32_bf16 a[8:11], v[64:67], v[80:83], a[8:11]
    v_mfma_f32_16x16x32_bf16 a[12:15], v[64:67], v[84:87], a[12:15]
    v_mfma_f32_16x16x32_bf16 a[16:19], v[68:71], v[80:83], a[16:19]
    v_mfma_f32_16x16x32_bf16 a[20:23], v[68:71], v[84:87], a[20:23]
    v_mfma_f32_16x16x32_bf16 a[24:27], v[72:75], v[80:83], a[24:27]
    v_mfma_f32_16x16x32_bf16 a[28:31], v[72:75], v[84:87], a[28:31]
    v_mfma_f32_16x16x32_bf16 a[32:35], v[76:79], v[80:83], a[32:35]
    v_mfma_f32_16x16x32_bf16 a[36:39], v[76:79], v[84:87], a[36:39]
    ds_read_b128 v[80:83], v23 offset:0
    ds_read_b128 v[84:87], v23 offset:2048
    ds_read_b128 v[60:63], v13 offset:0
    ds_read_b128 v[64:67], v13 offset:512
    ds_read_b128 v[68:71], v13 offset:4096
    ds_read_b128 v[72:75], v13 offset:4608
    ds_read_b128 v[76:79], v15 offset:8192
    s_waitcnt lgkmcnt(7)
    v_mfma_f32_16x16x32_bf16 a[0:3], v[32:35], v[52:55], a[0:3]
    v_mfma_f32_16x16x32_bf16 a[4:7], v[32:35], v[56:59], a[4:7]
    v_mfma_f32_16x16x32_bf16 a[8:11], v[36:39], v[52:55], a[8:11]
    v_mfma_f32_16x16x32_bf16 a[12:15], v[36:39], v[56:59], a[12:15]
    v_mfma_f32_16x16x32_bf16 a[16:19], v[40:43], v[52:55], a[16:19]
    v_mfma_f32_16x16x32_bf16 a[20:23], v[40:43], v[56:59], a[20:23]
    v_mfma_f32_16x16x32_bf16 a[24:27], v[44:47], v[52:55], a[24:27]
    v_mfma_f32_16x16x32_bf16 a[28:31], v[44:47], v[56:59], a[28:31]
    v_mfma_f32_16x16x32_bf16 a[32:35], v[48:51], v[52:55], a[32:35]
    v_mfma_f32_16x16x32_bf16 a[36:39], v[48:51], v[56:59], a[36:39]
    ds_read_b128 v[52:55], v22 offset:16384
    ds_read_b128 v[56:59], v22 offset:18432
    ds_read_b128 v[32:35], v12 offset:10240
    ds_read_b128 v[36:39], v12 offset:10752
    ds_read_b128 v[40:43], v12 offset:14336
    ds_read_b128 v[44:47], v12 offset:14848
    ds_read_b128 v[48:51], v14 offset:18432
    s_waitcnt lgkmcnt(7)
    v_mfma_f32_16x16x32_bf16 a[0:3], v[60:63], v[80:83], a[0:3]
    v_mfma_f32_16x16x32_bf16 a[4:7], v[60:63], v[84:87], a[4:7]
    v_mfma_f32_16x16x32_bf16 a[8:11], v[64:67], v[80:83], a[8:11]
    v_mfma_f32_16x16x32_bf16 a[12:15], v[64:67], v[84:87], a[12:15]
    v_mfma_f32_16x16x32_bf16 a[16:19], v[68:71], v[80:83], a[16:19]
    v_mfma_f32_16x16x32_bf16 a[20:23], v[68:71], v[84:87], a[20:23]
    v_mfma_f32_16x16x32_bf16 a[24:27], v[72:75], v[80:83], a[24:27]
    v_mfma_f32_16x16x32_bf16 a[28:31], v[72:75], v[84:87], a[28:31]
    v_mfma_f32_16x16x32_bf16 a[32:35], v[76:79], v[80:83], a[32:35]
    v_mfma_f32_16x16x32_bf16 a[36:39], v[76:79], v[84:87], a[36:39]
    ds_read_b128 v[80:83], v23 offset:16384
    ds_read_b128 v[84:87], v23 offset:18432
    ds_read_b128 v[60:63], v13 offset:10240
    ds_read_b128 v[64:67], v13 offset:10752
    ds_read_b128 v[68:71], v13 offset:14336
    ds_read_b128 v[72:75], v13 offset:14848
    ds_read_b128 v[76:79], v15 offset:18432
    s_waitcnt lgkmcnt(7)
    v_mfma_f32_16x16x32_bf16 a[0:3], v[32:35], v[52:55], a[0:3]
    v_mfma_f32_16x16x32_bf16 a[4:7], v[32:35], v[56:59], a[4:7]
    v_mfma_f32_16x16x32_bf16 a[8:11], v[36:39], v[52:55], a[8:11]
    v_mfma_f32_16x16x32_bf16 a[12:15], v[36:39], v[56:59], a[12:15]
    v_mfma_f32_16x16x32_bf16 a[16:19], v[40:43], v[52:55], a[16:19]
    v_mfma_f32_16x16x32_bf16 a[20:23], v[40:43], v[56:59], a[20:23]
    v_mfma_f32_16x16x32_bf16 a[24:27], v[44:47], v[52:55], a[24:27]
    v_mfma_f32_16x16x32_bf16 a[28:31], v[44:47], v[56:59], a[28:31]
    v_mfma_f32_16x16x32_bf16 a[32:35], v[48:51], v[52:55], a[32:35]
    v_mfma_f32_16x16x32_bf16 a[36:39], v[48:51], v[56:59], a[36:39]
    s_waitcnt lgkmcnt(0)
    s_barrier
    ds_read_b128 v[52:55], v24 offset:0
    ds_read_b128 v[56:59], v24 offset:2048
    ds_read_b128 v[32:35], v16 offset:0
    ds_read_b128 v[36:39], v16 offset:512
    ds_read_b128 v[40:43], v16 offset:4096
    ds_read_b128 v[44:47], v16 offset:4608
    ds_read_b128 v[48:51], v18 offset:8192
    v_mfma_f32_16x16x32_bf16 a[0:3], v[60:63], v[80:83], a[0:3]
    v_mfma_f32_16x16x32_bf16 a[4:7], v[60:63], v[84:87], a[4:7]
    v_mfma_f32_16x16x32_bf16 a[8:11], v[64:67], v[80:83], a[8:11]
    v_mfma_f32_16x16x32_bf16 a[12:15], v[64:67], v[84:87], a[12:15]
    v_mfma_f32_16x16x32_bf16 a[16:19], v[68:71], v[80:83], a[16:19]
    v_mfma_f32_16x16x32_bf16 a[20:23], v[68:71], v[84:87], a[20:23]
    v_mfma_f32_16x16x32_bf16 a[24:27], v[72:75], v[80:83], a[24:27]
    v_mfma_f32_16x16x32_bf16 a[28:31], v[72:75], v[84:87], a[28:31]
    v_mfma_f32_16x16x32_bf16 a[32:35], v[76:79], v[80:83], a[32:35]
    v_mfma_f32_16x16x32_bf16 a[36:39], v[76:79], v[84:87], a[36:39]
    ds_read_b128 v[80:83], v25 offset:0
    ds_read_b128 v[84:87], v25 offset:2048
    ds_read_b128 v[60:63], v17 offset:0
    ds_read_b128 v[64:67], v17 offset:512
    ds_read_b128 v[68:71], v17 offset:4096
    ds_read_b128 v[72:75], v17 offset:4608
    ds_read_b128 v[76:79], v19 offset:8192
    s_waitcnt lgkmcnt(7)
    v_mfma_f32_16x16x32_bf16 a[0:3], v[32:35], v[52:55], a[0:3]
    v_mfma_f32_16x16x32_bf16 a[4:7], v[32:35], v[56:59], a[4:7]
    v_mfma_f32_16x16x32_bf16 a[8:11], v[36:39], v[52:55], a[8:11]
    v_mfma_f32_16x16x32_bf16 a[12:15], v[36:39], v[56:59], a[12:15]
    v_mfma_f32_16x16x32_bf16 a[16:19], v[40:43], v[52:55], a[16:19]
    v_mfma_f32_16x16x32_bf16 a[20:23], v[40:43], v[56:59], a[20:23]
    v_mfma_f32_16x16x32_bf16 a[24:27], v[44:47], v[52:55], a[24:27]
    v_mfma_f32_16x16x32_bf16 a[28:31], v[44:47], v[56:59], a[28:31]
    v_mfma_f32_16x16x32_bf16 a[32:35], v[48:51], v[52:55], a[32:35]
    v_mfma_f32_16x16x32_bf16 a[36:39], v[48:51], v[56:59], a[36:39]
    ds_read_b128 v[52:55], v24 offset:16384
    ds_read_b128 v[56:59], v24 offset:18432
    ds_read_b128 v[32:35], v16 offset:10240
    ds_read_b128 v[36:39], v16 offset:10752
    ds_read_b128 v[40:43], v16 offset:14336
    ds_read_b128 v[44:47], v16 offset:14848
    ds_read_b128 v[48:51], v18 offset:18432
    s_waitcnt lgkmcnt(7)
    v_mfma_f32_16x16x32_bf16 a[0:3], v[60:63], v[80:83], a[0:3]
    v_mfma_f32_16x16x32_bf16 a[4:7], v[60:63], v[84:87], a[4:7]
    v_mfma_f32_16x16x32_bf16 a[8:11], v[64:67], v[80:83], a[8:11]
    v_mfma_f32_16x16x32_bf16 a[12:15], v[64:67], v[84:87], a[12:15]
    v_mfma_f32_16x16x32_bf16 a[16:19], v[68:71], v[80:83], a[16:19]
    v_mfma_f32_16x16x32_bf16 a[20:23], v[68:71], v[84:87], a[20:23]
    v_mfma_f32_16x16x32_bf16 a[24:27], v[72:75], v[80:83], a[24:27]
    v_mfma_f32_16x16x32_bf16 a[28:31], v[72:75], v[84:87], a[28:31]
    v_mfma_f32_16x16x32_bf16 a[32:35], v[76:79], v[80:83], a[32:35]
    v_mfma_f32_16x16x32_bf16 a[36:39], v[76:79], v[84:87], a[36:39]
    ds_read_b128 v[80:83], v25 offset:16384
    ds_read_b128 v[84:87], v25 offset:18432
    ds_read_b128 v[60:63], v17 offset:10240
    ds_read_b128 v[64:67], v17 offset:10752
    ds_read_b128 v[68:71], v17 offset:14336
    ds_read_b128 v[72:75], v17 offset:14848
    ds_read_b128 v[76:79], v19 offset:18432
    s_waitcnt lgkmcnt(7)
    v_mfma_f32_16x16x32_bf16 a[0:3], v[32:35], v[52:55], a[0:3]
    v_mfma_f32_16x16x32_bf16 a[4:7], v[32:35], v[56:59], a[4:7]
    v_mfma_f32_16x16x32_bf16 a[8:11], v[36:39], v[52:55], a[8:11]
    v_mfma_f32_16x16x32_bf16 a[12:15], v[36:39], v[56:59], a[12:15]
    v_mfma_f32_16x16x32_bf16 a[16:19], v[40:43], v[52:55], a[16:19]
    v_mfma_f32_16x16x32_bf16 a[20:23], v[40:43], v[56:59], a[20:23]
    v_mfma_f32_16x16x32_bf16 a[24:27], v[44:47], v[52:55], a[24:27]
    v_mfma_f32_16x16x32_bf16 a[28:31], v[44:47], v[56:59], a[28:31]
    v_mfma_f32_16x16x32_bf16 a[32:35], v[48:51], v[52:55], a[32:35]
    v_mfma_f32_16x16x32_bf16 a[36:39], v[48:51], v[56:59], a[36:39]
    s_waitcnt lgkmcnt(0)
    s_barrier
    ds_read_b128 v[52:55], v20 offset:0
    ds_read_b128 v[56:59], v20 offset:2048
    ds_read_b128 v[32:35], v8 offset:0
    ds_read_b128 v[36:39], v8 offset:512
    ds_read_b128 v[40:43], v8 offset:4096
    ds_read_b128 v[44:47], v8 offset:4608
    ds_read_b128 v[48:51], v10 offset:8192
    v_mfma_f32_16x16x32_bf16 a[0:3], v[60:63], v[80:83], a[0:3]
    v_mfma_f32_16x16x32_bf16 a[4:7], v[60:63], v[84:87], a[4:7]
    v_mfma_f32_16x16x32_bf16 a[8:11], v[64:67], v[80:83], a[8:11]
    v_mfma_f32_16x16x32_bf16 a[12:15], v[64:67], v[84:87], a[12:15]
    v_mfma_f32_16x16x32_bf16 a[16:19], v[68:71], v[80:83], a[16:19]
    v_mfma_f32_16x16x32_bf16 a[20:23], v[68:71], v[84:87], a[20:23]
    v_mfma_f32_16x16x32_bf16 a[24:27], v[72:75], v[80:83], a[24:27]
    v_mfma_f32_16x16x32_bf16 a[28:31], v[72:75], v[84:87], a[28:31]
    v_mfma_f32_16x16x32_bf16 a[32:35], v[76:79], v[80:83], a[32:35]
    v_mfma_f32_16x16x32_bf16 a[36:39], v[76:79], v[84:87], a[36:39]
    ds_read_b128 v[80:83], v21 offset:0
    ds_read_b128 v[84:87], v21 offset:2048
    ds_read_b128 v[60:63], v9 offset:0
    ds_read_b128 v[64:67], v9 offset:512
    ds_read_b128 v[68:71], v9 offset:4096
    ds_read_b128 v[72:75], v9 offset:4608
    ds_read_b128 v[76:79], v11 offset:8192
    s_waitcnt lgkmcnt(7)
    v_mfma_f32_16x16x32_bf16 a[0:3], v[32:35], v[52:55], a[0:3]
    v_mfma_f32_16x16x32_bf16 a[4:7], v[32:35], v[56:59], a[4:7]
    v_mfma_f32_16x16x32_bf16 a[8:11], v[36:39], v[52:55], a[8:11]
    v_mfma_f32_16x16x32_bf16 a[12:15], v[36:39], v[56:59], a[12:15]
    v_mfma_f32_16x16x32_bf16 a[16:19], v[40:43], v[52:55], a[16:19]
    v_mfma_f32_16x16x32_bf16 a[20:23], v[40:43], v[56:59], a[20:23]
    v_mfma_f32_16x16x32_bf16 a[24:27], v[44:47], v[52:55], a[24:27]
    v_mfma_f32_16x16x32_bf16 a[28:31], v[44:47], v[56:59], a[28:31]
    v_mfma_f32_16x16x32_bf16 a[32:35], v[48:51], v[52:55], a[32:35]
    v_mfma_f32_16x16x32_bf16 a[36:39], v[48:51], v[56:59], a[36:39]
    ds_read_b128 v[52:55], v20 offset:16384
    ds_read_b128 v[56:59], v20 offset:18432
    ds_read_b128 v[32:35], v8 offset:10240
    ds_read_b128 v[36:39], v8 offset:10752
    ds_read_b128 v[40:43], v8 offset:14336
    ds_read_b128 v[44:47], v8 offset:14848
    ds_read_b128 v[48:51], v10 offset:18432
    s_waitcnt lgkmcnt(7)
    v_mfma_f32_16x16x32_bf16 a[0:3], v[60:63], v[80:83], a[0:3]
    v_mfma_f32_16x16x32_bf16 a[4:7], v[60:63], v[84:87], a[4:7]
    v_mfma_f32_16x16x32_bf16 a[8:11], v[64:67], v[80:83], a[8:11]
    v_mfma_f32_16x16x32_bf16 a[12:15], v[64:67], v[84:87], a[12:15]
    v_mfma_f32_16x16x32_bf16 a[16:19], v[68:71], v[80:83], a[16:19]
    v_mfma_f32_16x16x32_bf16 a[20:23], v[68:71], v[84:87], a[20:23]
    v_mfma_f32_16x16x32_bf16 a[24:27], v[72:75], v[80:83], a[24:27]
    v_mfma_f32_16x16x32_bf16 a[28:31], v[72:75], v[84:87], a[28:31]
    v_mfma_f32_16x16x32_bf16 a[32:35], v[76:79], v[80:83], a[32:35]
    v_mfma_f32_16x16x32_bf16 a[36:39], v[76:79], v[84:87], a[36:39]
    ds_read_b128 v[80:83], v21 offset:16384
    ds_read_b128 v[84:87], v21 offset:18432
    ds_read_b128 v[60:63], v9 offset:10240
    ds_read_b128 v[64:67], v9 offset:10752
    ds_read_b128 v[68:71], v9 offset:14336
    ds_read_b128 v[72:75], v9 offset:14848
    ds_read_b128 v[76:79], v11 offset:18432
    s_waitcnt lgkmcnt(7)
    v_mfma_f32_16x16x32_bf16 a[0:3], v[32:35], v[52:55], a[0:3]
    v_mfma_f32_16x16x32_bf16 a[4:7], v[32:35], v[56:59], a[4:7]
    v_mfma_f32_16x16x32_bf16 a[8:11], v[36:39], v[52:55], a[8:11]
    v_mfma_f32_16x16x32_bf16 a[12:15], v[36:39], v[56:59], a[12:15]
    v_mfma_f32_16x16x32_bf16 a[16:19], v[40:43], v[52:55], a[16:19]
    v_mfma_f32_16x16x32_bf16 a[20:23], v[40:43], v[56:59], a[20:23]
    v_mfma_f32_16x16x32_bf16 a[24:27], v[44:47], v[52:55], a[24:27]
    v_mfma_f32_16x16x32_bf16 a[28:31], v[44:47], v[56:59], a[28:31]
    v_mfma_f32_16x16x32_bf16 a[32:35], v[48:51], v[52:55], a[32:35]
    v_mfma_f32_16x16x32_bf16 a[36:39], v[48:51], v[56:59], a[36:39]
    s_waitcnt lgkmcnt(0)
    v_mfma_f32_16x16x32_bf16 a[0:3], v[60:63], v[80:83], a[0:3]
    v_mfma_f32_16x16x32_bf16 a[4:7], v[60:63], v[84:87], a[4:7]
    v_mfma_f32_16x16x32_bf16 a[8:11], v[64:67], v[80:83], a[8:11]
    v_mfma_f32_16x16x32_bf16 a[12:15], v[64:67], v[84:87], a[12:15]
    v_mfma_f32_16x16x32_bf16 a[16:19], v[68:71], v[80:83], a[16:19]
    v_mfma_f32_16x16x32_bf16 a[20:23], v[68:71], v[84:87], a[20:23]
    v_mfma_f32_16x16x32_bf16 a[24:27], v[72:75], v[80:83], a[24:27]
    v_mfma_f32_16x16x32_bf16 a[28:31], v[72:75], v[84:87], a[28:31]
    v_mfma_f32_16x16x32_bf16 a[32:35], v[76:79], v[80:83], a[32:35]
    v_mfma_f32_16x16x32_bf16 a[36:39], v[76:79], v[84:87], a[36:39]
    s_nop 7
    s_nop 7
    v_accvgpr_read_b32 v88, a0
    v_accvgpr_read_b32 v89, a1
    v_accvgpr_read_b32 v90, a2
    v_accvgpr_read_b32 v91, a3
    v_accvgpr_read_b32 v92, a4
    v_accvgpr_read_b32 v93, a5
    v_accvgpr_read_b32 v94, a6
    v_accvgpr_read_b32 v95, a7
    v_accvgpr_read_b32 v96, a8
    v_accvgpr_read_b32 v97, a9
    v_accvgpr_read_b32 v98, a10
    v_accvgpr_read_b32 v99, a11
    v_accvgpr_read_b32 v100, a12
    v_accvgpr_read_b32 v101, a13
    v_accvgpr_read_b32 v102, a14
    v_accvgpr_read_b32 v103, a15
    v_accvgpr_read_b32 v104, a16
    v_accvgpr_read_b32 v105, a17
    v_accvgpr_read_b32 v106, a18
    v_accvgpr_read_b32 v107, a19
    v_accvgpr_read_b32 v108, a20
    v_accvgpr_read_b32 v109, a21
    v_accvgpr_read_b32 v110, a22
    v_accvgpr_read_b32 v111, a23
    v_accvgpr_read_b32 v112, a24
    v_accvgpr_read_b32 v113, a25
    v_accvgpr_read_b32 v114, a26
    v_accvgpr_read_b32 v115, a27
    v_accvgpr_read_b32 v116, a28
    v_accvgpr_read_b32 v117, a29
    v_accvgpr_read_b32 v118, a30
    v_accvgpr_read_b32 v119, a31
    v_accvgpr_read_b32 v120, a32
    v_accvgpr_read_b32 v121, a33
    v_accvgpr_read_b32 v122, a34
    v_accvgpr_read_b32 v123, a35
    v_accvgpr_read_b32 v124, a36
    v_accvgpr_read_b32 v125, a37
    v_accvgpr_read_b32 v126, a38
    v_accvgpr_read_b32 v127, a39
    s_waitcnt vmcnt(0)
    s_lshl_b32 s46, s42, 5
    v_add_u32 v4, s46, v2
    s_movk_i32 s46, 1280
    v_mul_lo_u32 v4, v4, s46
    v_lshl_add_u32 v5, v3, 3, v4
    v_lshl_add_u32 v4, v3, 4, v4
    s_mov_b32 s47, 20480
    v_cvt_pk_bf16_f32 v32, v88, v89
    v_cvt_pk_bf16_f32 v33, v90, v91
    v_cvt_pk_bf16_f32 v34, v96, v97
    v_cvt_pk_bf16_f32 v35, v98, v99
    buffer_store_dwordx4 v[32:35], v4, s[16:19], 0 offen offset:0
    v_cvt_pk_bf16_f32 v36, v104, v105
    v_cvt_pk_bf16_f32 v37, v106, v107
    v_cvt_pk_bf16_f32 v38, v112, v113
    v_cvt_pk_bf16_f32 v39, v114, v115
    buffer_store_dwordx4 v[36:39], v4, s[16:19], 0 offen offset:64
    v_cvt_pk_bf16_f32 v40, v120, v121
    v_cvt_pk_bf16_f32 v41, v122, v123
    buffer_store_dwordx2 v[40:41], v5, s[16:19], 0 offen offset:128
    v_cvt_pk_bf16_f32 v44, v92, v93
    v_cvt_pk_bf16_f32 v45, v94, v95
    v_cvt_pk_bf16_f32 v46, v100, v101
    v_cvt_pk_bf16_f32 v47, v102, v103
    buffer_store_dwordx4 v[44:47], v4, s[16:19], s47 offen offset:0
    v_cvt_pk_bf16_f32 v32, v108, v109
    v_cvt_pk_bf16_f32 v33, v110, v111
    v_cvt_pk_bf16_f32 v34, v116, v117
    v_cvt_pk_bf16_f32 v35, v118, v119
    buffer_store_dwordx4 v[32:35], v4, s[16:19], s47 offen offset:64
    v_cvt_pk_bf16_f32 v36, v124, v125
    v_cvt_pk_bf16_f32 v37, v126, v127
    buffer_store_dwordx2 v[36:37], v5, s[16:19], s47 offen offset:128
gemmb_kernel_end:
    s_endpgm
.globl ln2_kernel
.p2align 8
.type ln2_kernel,@function
ln2_kernel:
    s_cmp_ge_u32 s2, 736
    s_cbranch_scc1 ln2_kernel_end
    s_cmp_lt_u32 s2, 256
    s_cbranch_scc1 ln2_kernel_go
ln2_kernel_tr:
    s_load_dwordx2 s[4:5], s[0:1], 96
    s_load_dwordx4 s[28:31], s[0:1], 48
    s_sub_u32 s6, s2, 256
    s_waitcnt lgkmcnt(0)
    s_cmp_ge_u32 s6, 240
    s_cbranch_scc1 ln2_kernel_tr2
    s_mul_i32 s7, s6, 2731
    s_lshr_b32 s7, s7, 16
    s_mul_i32 s20, s7, 24
    s_sub_u32 s20, s6, s20
    s_mov_b32 s8, s28
    s_mov_b32 s9, s29
    s_mov_b32 s10, 1966080
    s_mov_b32 s11, 0x00020000
    s_add_u32 s12, s4, 131072
    s_addc_u32 s13, s5, 0
    s_mov_b32 s14, 1966080
    s_mov_b32 s15, 0x00020000
    s_movk_i32 s21, 3072
    s_movk_i32 s22, 1280
    s_branch ln2_kernel_trgo
ln2_kernel_tr2:
    s_sub_u32 s6, s6, 240
    s_mul_i32 s7, s6, 6554
    s_lshr_b32 s7, s7, 16
    s_mul_i32 s20, s7, 10
    s_sub_u32 s20, s6, s20
    s_mov_b32 s8, s30
    s_mov_b32 s9, s31
    s_mov_b32 s10, 1966080
    s_mov_b32 s11, 0x00020000
    s_add_u32 s12, s4, 2097152
    s_addc_u32 s13, s5, 0
    s_mov_b32 s14, 1966080
    s_mov_b32 s15, 0x00020000
    s_movk_i32 s21, 1280
    s_movk_i32 s22, 3072
ln2_kernel_trgo:
    v_lshrrev_b32 v1, 3, v0
    v_and_b32 v2, 7, v0
    s_lshl_b32 s23, s7, 6
    v_add_u32 v3, s23, v1
    v_mul_lo_u32 v3, v3, s21
    v_lshl_add_u32 v3, v2, 4, v3
    s_lshl_b32 s24, s20, 7
    v_add_u32 v3, s24, v3
    s_lshl_b32 s25, s21, 5
    buffer_load_dwordx4 v[8:11], v3, s[8:11], 0 offen
    buffer_load_dwordx4 v[12:15], v3, s[8:11], s25 offen
    s_movk_i32 s26, 1152
    v_mul_lo_u32 v4, v2, s26
    v_lshl_add_u32 v4, v1, 1, v4
    s_waitcnt vmcnt(1)
    ds_write_b16 v4, v8 offset:0
    ds_write_b16_d16_hi v4, v8 offset:144
    ds_write_b16 v4, v9 offset:288
    ds_write_b16_d16_hi v4, v9 offset:432
    ds_write_b16 v4, v10 offset:576
    ds_write_b16_d16_hi v4, v10 offset:720
    ds_write_b16 v4, v11 offset:864
    ds_write_b16_d16_hi v4, v11 offset:1008
    s_waitcnt vmcnt(0)
    ds_write_b16 v4, v12 offset:64
    ds_write_b16_d16_hi v4, v12 offset:208
    ds_write_b16 v4, v13 offset:352
    ds_write_b16_d16_hi v4, v13 offset:496
    ds_write_b16 v4, v14 offset:640
    ds_write_b16_d16_hi v4, v14 offset:784
    ds_write_b16 v4, v15 offset:928
    ds_write_b16_d16_hi v4, v15 offset:1072
    s_waitcnt lgkmcnt(0)
    s_barrier
    s_movk_i32 s26, 144
    v_mul_lo_u32 v5, v1, s26
    v_lshl_add_u32 v5, v2, 4, v5
    ds_read_b128 v[8:11], v5
    ds_read_b128 v[12:15], v5 offset:4608
    s_lshl_b32 s23, s20, 6
    v_add_u32 v6, s23, v1
    v_mul_lo_u32 v6, v6, s22
    v_lshl_add_u32 v6, v2, 4, v6
    s_lshl_b32 s24, s7, 7
    v_add_u32 v6, s24, v6
    s_lshl_b32 s25, s22, 5
    s_waitcnt lgkmcnt(1)
    buffer_store_dwordx4 v[8:11], v6, s[12:15], 0 offen
    s_waitcnt lgkmcnt(0)
    buffer_store_dwordx4 v[12:15], v6, s[12:15], s25 offen
    s_branch ln2_kernel_end
ln2_kernel_go:
    s_load_dwordx2 s[4:5], s[0:1], 96
    s_load_dwordx2 s[6:7], s[0:1], 0
    s_waitcnt lgkmcnt(0)
    s_mov_b32 s8, s6
    s_mov_b32 s9, s7
    s_mov_b32 s10, 2621440
    s_mov_b32 s11, 0x00020000
    s_mov_b32 s12, s4
    s_mov_b32 s13, s5
    s_mov_b32 s14, 7680
    s_mov_b32 s15, 0x00020000
    s_add_u32 s16, s4, 19791872
    s_addc_u32 s17, s5, 0
    s_mov_b32 s18, 2621440
    s_mov_b32 s19, 0x00020000
    s_add_u32 s20, s4, 11927552
    s_addc_u32 s21, s5, 0
    s_mov_b32 s22, 2621440
    s_mov_b32 s23, 0x00020000
    s_add_u32 s24, s4, 14548992
    s_addc_u32 s25, s5, 0
    s_mov_b32 s26, 2621440
    s_mov_b32 s27, 0x00020000
    s_add_u32 s28, s4, 17170432
    s_addc_u32 s29, s5, 0
    s_mov_b32 s30, 2621440
    s_mov_b32 s31, 0x00020000
    v_lshrrev_b32 v1, 5, v0
    s_and_b32 s33, s2, 7
    s_lshl_b32 s33, s33, 5
    s_lshr_b32 s3, s2, 3
    s_add_u32 s3, s3, s33
    s_lshl_b32 s3, s3, 3
    v_add_u32 v1, s3, v1
    v_and_b32 v2, 31, v0
    v_lshlrev_b32 v2, 3, v2
    s_movk_i32 s3, 1280
    v_mul_lo_u32 v1, v1, s3
    v_add_u32 v1, v1, v2
    buffer_load_dwordx2 v[10:11], v1, s[8:11], 0 offen offset:0
    buffer_load_dwordx2 v[12:13], v1, s[8:11], 0 offen offset:256
    buffer_load_dwordx2 v[14:15], v1, s[8:11], 0 offen offset:512
    buffer_load_dwordx2 v[16:17], v1, s[8:11], 0 offen offset:768
    buffer_load_dwordx2 v[18:19], v1, s[8:11], 0 offen offset:1024
    buffer_load_dwordx2 v[20:21], v1, s[20:23], 0 offen offset:0
    buffer_load_dwordx2 v[22:23], v1, s[20:23], 0 offen offset:256
    buffer_load_dwordx2 v[24:25], v1, s[20:23], 0 offen offset:512
    buffer_load_dwordx2 v[26:27], v1, s[20:23], 0 offen offset:768
    buffer_load_dwordx2 v[28:29], v1, s[20:23], 0 offen offset:1024
    buffer_load_dwordx2 v[30:31], v1, s[24:27], 0 offen offset:0
    buffer_load_dwordx2 v[32:33], v1, s[24:27], 0 offen offset:256
    buffer_load_dwordx2 v[34:35], v1, s[24:27], 0 offen offset:512
    buffer_load_dwordx2 v[36:37], v1, s[24:27], 0 offen offset:768
    buffer_load_dwordx2 v[38:39], v1, s[24:27], 0 offen offset:1024
    buffer_load_dwordx2 v[40:41], v2, s[12:15], 0 offen offset:2560
    buffer_load_dwordx2 v[42:43], v2, s[12:15], 0 offen offset:2816
    buffer_load_dwordx2 v[44:45], v2, s[12:15], 0 offen offset:3072
    buffer_load_dwordx2 v[46:47], v2, s[12:15], 0 offen offset:3328
    buffer_load_dwordx2 v[48:49], v2, s[12:15], 0 offen offset:3584
    s_movk_i32 s3, 5120
    buffer_load_dwordx2 v[50:51], v2, s[12:15], s3 offen offset:0
    buffer_load_dwordx2 v[52:53], v2, s[12:15], s3 offen offset:256
    buffer_load_dwordx2 v[54:55], v2, s[12:15], s3 offen offset:512
    buffer_load_dwordx2 v[56:57], v2, s[12:15], s3 offen offset:768
    buffer_load_dwordx2 v[58:59], v2, s[12:15], s3 offen offset:1024
    s_movk_i32 s32, 3840
    buffer_load_dwordx2 v[60:61], v2, s[12:15], s32 offen offset:0
    buffer_load_dwordx2 v[62:63], v2, s[12:15], s32 offen offset:256
    buffer_load_dwordx2 v[64:65], v2, s[12:15], s32 offen offset:512
    buffer_load_dwordx2 v[66:67], v2, s[12:15], s32 offen offset:768
    buffer_load_dwordx2 v[68:69], v2, s[12:15], s32 offen offset:1024
    s_waitcnt vmcnt(10)
    v_lshlrev_b32 v140, 16, v20
    v_and_b32 v141, 0xffff0000, v20
    v_lshlrev_b32 v142, 16, v30
    v_and_b32 v143, 0xffff0000, v30
    v_sub_f32 v140, v140, v142
    v_sub_f32 v141, v141, v143
    v_cvt_pk_bf16_f32 v144, v140, v141
    v_lshlrev_b32 v140, 16, v144
    v_and_b32 v141, 0xffff0000, v144
    v_lshlrev_b32 v142, 16, v40
    v_and_b32 v143, 0xffff0000, v40
    v_mul_f32 v140, v140, v142
    v_mul_f32 v141, v141, v143
    v_cvt_pk_bf16_f32 v144, v140, v141
    v_lshlrev_b32 v140, 16, v144
    v_and_b32 v141, 0xffff0000, v144
    v_lshlrev_b32 v142, 16, v10
    v_and_b32 v143, 0xffff0000, v10
    v_add_f32 v140, v140, v142
    v_add_f32 v141, v141, v143
    v_cvt_pk_bf16_f32 v20, v140, v141
    v_lshlrev_b32 v70, 16, v20
    v_and_b32 v71, 0xffff0000, v20
    v_lshlrev_b32 v140, 16, v21
    v_and_b32 v141, 0xffff0000, v21
    v_lshlrev_b32 v142, 16, v31
    v_and_b32 v143, 0xffff0000, v31
    v_sub_f32 v140, v140, v142
    v_sub_f32 v141, v141, v143
    v_cvt_pk_bf16_f32 v144, v140, v141
    v_lshlrev_b32 v140, 16, v144
    v_and_b32 v141, 0xffff0000, v144
    v_lshlrev_b32 v142, 16, v41
    v_and_b32 v143, 0xffff0000, v41
    v_mul_f32 v140, v140, v142
    v_mul_f32 v141, v141, v143
    v_cvt_pk_bf16_f32 v144, v140, v141
    v_lshlrev_b32 v140, 16, v144
    v_and_b32 v141, 0xffff0000, v144
    v_lshlrev_b32 v142, 16, v11
    v_and_b32 v143, 0xffff0000, v11
    v_add_f32 v140, v140, v142
    v_add_f32 v141, v141, v143
    v_cvt_pk_bf16_f32 v21, v140, v141
    v_lshlrev_b32 v72, 16, v21
    v_and_b32 v73, 0xffff0000, v21
    v_lshlrev_b32 v140, 16, v22
    v_and_b32 v141, 0xffff0000, v22
    v_lshlrev_b32 v142, 16, v32
    v_and_b32 v143, 0xffff0000, v32
    v_sub_f32 v140, v140, v142
    v_sub_f32 v141, v141, v143
    v_cvt_pk_bf16_f32 v144, v140, v141
    v_lshlrev_b32 v140, 16, v144
    v_and_b32 v141, 0xffff0000, v144
    v_lshlrev_b32 v142, 16, v42
    v_and_b32 v143, 0xffff0000, v42
    v_mul_f32 v140, v140, v142
    v_mul_f32 v141, v141, v143
    v_cvt_pk_bf16_f32 v144, v140, v141
    v_lshlrev_b32 v140, 16, v144
    v_and_b32 v141, 0xffff0000, v144
    v_lshlrev_b32 v142, 16, v12
    v_and_b32 v143, 0xffff0000, v12
    v_add_f32 v140, v140, v142
    v_add_f32 v141, v141, v143
    v_cvt_pk_bf16_f32 v22, v140, v141
    v_lshlrev_b32 v74, 16, v22
    v_and_b32 v75, 0xffff0000, v22
    v_lshlrev_b32 v140, 16, v23
    v_and_b32 v141, 0xffff0000, v23
    v_lshlrev_b32 v142, 16, v33
    v_and_b32 v143, 0xffff0000, v33
    v_sub_f32 v140, v140, v142
    v_sub_f32 v141, v141, v143
    v_cvt_pk_bf16_f32 v144, v140, v141
    v_lshlrev_b32 v140, 16, v144
    v_and_b32 v141, 0xffff0000, v144
    v_lshlrev_b32 v142, 16, v43
    v_and_b32 v143, 0xffff0000, v43
    v_mul_f32 v140, v140, v142
    v_mul_f32 v141, v141, v143
    v_cvt_pk_bf16_f32 v144, v140, v141
    v_lshlrev_b32 v140, 16, v144
    v_and_b32 v141, 0xffff0000, v144
    v_lshlrev_b32 v142, 16, v13
    v_and_b32 v143, 0xffff0000, v13
    v_add_f32 v140, v140, v142
    v_add_f32 v141, v141, v143
    v_cvt_pk_bf16_f32 v23, v140, v141
    v_lshlrev_b32 v76, 16, v23
    v_and_b32 v77, 0xffff0000, v23
    v_lshlrev_b32 v140, 16, v24
    v_and_b32 v141, 0xffff0000, v24
    v_lshlrev_b32 v142, 16, v34
    v_and_b32 v143, 0xffff0000, v34
    v_sub_f32 v140, v140, v142
    v_sub_f32 v141, v141, v143
    v_cvt_pk_bf16_f32 v144, v140, v141
    v_lshlrev_b32 v140, 16, v144
    v_and_b32 v141, 0xffff0000, v144
    v_lshlrev_b32 v142, 16, v44
    v_and_b32 v143, 0xffff0000, v44
    v_mul_f32 v140, v140, v142
    v_mul_f32 v141, v141, v143
    v_cvt_pk_bf16_f32 v144, v140, v141
    v_lshlrev_b32 v140, 16, v144
    v_and_b32 v141, 0xffff0000, v144
    v_lshlrev_b32 v142, 16, v14
    v_and_b32 v143, 0xffff0000, v14
    v_add_f32 v140, v140, v142
    v_add_f32 v141, v141, v143
    v_cvt_pk_bf16_f32 v24, v140, v141
    v_lshlrev_b32 v78, 16, v24
    v_and_b32 v79, 0xffff0000, v24
    v_lshlrev_b32 v140, 16, v25
    v_and_b32 v141, 0xffff0000, v25
    v_lshlrev_b32 v142, 16, v35
    v_and_b32 v143, 0xffff0000, v35
    v_sub_f32 v140, v140, v142
    v_sub_f32 v141, v141, v143
    v_cvt_pk_bf16_f32 v144, v140, v141
    v_lshlrev_b32 v140, 16, v144
    v_and_b32 v141, 0xffff0000, v144
    v_lshlrev_b32 v142, 16, v45
    v_and_b32 v143, 0xffff0000, v45
    v_mul_f32 v140, v140, v142
    v_mul_f32 v141, v141, v143
    v_cvt_pk_bf16_f32 v144, v140, v141
    v_lshlrev_b32 v140, 16, v144
    v_and_b32 v141, 0xffff0000, v144
    v_lshlrev_b32 v142, 16, v15
    v_and_b32 v143, 0xffff0000, v15
    v_add_f32 v140, v140, v142
    v_add_f32 v141, v141, v143
    v_cvt_pk_bf16_f32 v25, v140, v141
    v_lshlrev_b32 v80, 16, v25
    v_and_b32 v81, 0xffff0000, v25
    v_lshlrev_b32 v140, 16, v26
    v_and_b32 v141, 0xffff0000, v26
    v_lshlrev_b32 v142, 16, v36
    v_and_b32 v143, 0xffff0000, v36
    v_sub_f32 v140, v140, v142
    v_sub_f32 v141, v141, v143
    v_cvt_pk_bf16_f32 v144, v140, v141
    v_lshlrev_b32 v140, 16, v144
    v_and_b32 v141, 0xffff0000, v144
    v_lshlrev_b32 v142, 16, v46
    v_and_b32 v143, 0xffff0000, v46
    v_mul_f32 v140, v140, v142
    v_mul_f32 v141, v141, v143
    v_cvt_pk_bf16_f32 v144, v140, v141
    v_lshlrev_b32 v140, 16, v144
    v_and_b32 v141, 0xffff0000, v144
    v_lshlrev_b32 v142, 16, v16
    v_and_b32 v143, 0xffff0000, v16
    v_add_f32 v140, v140, v142
    v_add_f32 v141, v141, v143
    v_cvt_pk_bf16_f32 v26, v140, v141
    v_lshlrev_b32 v82, 16, v26
    v_and_b32 v83, 0xffff0000, v26
    v_lshlrev_b32 v140, 16, v27
    v_and_b32 v141, 0xffff0000, v27
    v_lshlrev_b32 v142, 16, v37
    v_and_b32 v143, 0xffff0000, v37
    v_sub_f32 v140, v140, v142
    v_sub_f32 v141, v141, v143
    v_cvt_pk_bf16_f32 v144, v140, v141
    v_lshlrev_b32 v140, 16, v144
    v_and_b32 v141, 0xffff0000, v144
    v_lshlrev_b32 v142, 16, v47
    v_and_b32 v143, 0xffff0000, v47
    v_mul_f32 v140, v140, v142
    v_mul_f32 v141, v141, v143
    v_cvt_pk_bf16_f32 v144, v140, v141
    v_lshlrev_b32 v140, 16, v144
    v_and_b32 v141, 0xffff0000, v144
    v_lshlrev_b32 v142, 16, v17
    v_and_b32 v143, 0xffff0000, v17
    v_add_f32 v140, v140, v142
    v_add_f32 v141, v141, v143
    v_cvt_pk_bf16_f32 v27, v140, v141
    v_lshlrev_b32 v84, 16, v27
    v_and_b32 v85, 0xffff0000, v27
    v_lshlrev_b32 v140, 16, v28
    v_and_b32 v141, 0xffff0000, v28
    v_lshlrev_b32 v142, 16, v38
    v_and_b32 v143, 0xffff0000, v38
    v_sub_f32 v140, v140, v142
    v_sub_f32 v141, v141, v143
    v_cvt_pk_bf16_f32 v144, v140, v141
    v_lshlrev_b32 v140, 16, v144
    v_and_b32 v141, 0xffff0000, v144
    v_lshlrev_b32 v142, 16, v48
    v_and_b32 v143, 0xffff0000, v48
    v_mul_f32 v140, v140, v142
    v_mul_f32 v141, v141, v143
    v_cvt_pk_bf16_f32 v144, v140, v141
    v_lshlrev_b32 v140, 16, v144
    v_and_b32 v141, 0xffff0000, v144
    v_lshlrev_b32 v142, 16, v18
    v_and_b32 v143, 0xffff0000, v18
    v_add_f32 v140, v140, v142
    v_add_f32 v141, v141, v143
    v_cvt_pk_bf16_f32 v28, v140, v141
    v_lshlrev_b32 v86, 16, v28
    v_and_b32 v87, 0xffff0000, v28
    v_lshlrev_b32 v140, 16, v29
    v_and_b32 v141, 0xffff0000, v29
    v_lshlrev_b32 v142, 16, v39
    v_and_b32 v143, 0xffff0000, v39
    v_sub_f32 v140, v140, v142
    v_sub_f32 v141, v141, v143
    v_cvt_pk_bf16_f32 v144, v140, v141
    v_lshlrev_b32 v140, 16, v144
    v_and_b32 v141, 0xffff0000, v144
    v_lshlrev_b32 v142, 16, v49
    v_and_b32 v143, 0xffff0000, v49
    v_mul_f32 v140, v140, v142
    v_mul_f32 v141, v141, v143
    v_cvt_pk_bf16_f32 v144, v140, v141
    v_lshlrev_b32 v140, 16, v144
    v_and_b32 v141, 0xffff0000, v144
    v_lshlrev_b32 v142, 16, v19
    v_and_b32 v143, 0xffff0000, v19
    v_add_f32 v140, v140, v142
    v_add_f32 v141, v141, v143
    v_cvt_pk_bf16_f32 v29, v140, v141
    v_lshlrev_b32 v88, 16, v29
    v_and_b32 v89, 0xffff0000, v29
    buffer_store_dwordx2 v[20:21], v1, s[28:31], 0 offen offset:0
    buffer_store_dwordx2 v[22:23], v1, s[28:31], 0 offen offset:256
    buffer_store_dwordx2 v[24:25], v1, s[28:31], 0 offen offset:512
    buffer_store_dwordx2 v[26:27], v1, s[28:31], 0 offen offset:768
    buffer_store_dwordx2 v[28:29], v1, s[28:31], 0 offen offset:1024
    s_waitcnt vmcnt(5)
    v_lshlrev_b32 v140, 16, v50
    v_and_b32 v141, 0xffff0000, v50
    v_add_f32 v140, 1.0, v140
    v_add_f32 v141, 1.0, v141
    v_cvt_pk_bf16_f32 v142, v140, v141
    v_lshlrev_b32 v90, 16, v142
    v_and_b32 v91, 0xffff0000, v142
    v_lshlrev_b32 v110, 16, v60
    v_and_b32 v111, 0xffff0000, v60
    v_lshlrev_b32 v140, 16, v51
    v_and_b32 v141, 0xffff0000, v51
    v_add_f32 v140, 1.0, v140
    v_add_f32 v141, 1.0, v141
    v_cvt_pk_bf16_f32 v142, v140, v141
    v_lshlrev_b32 v92, 16, v142
    v_and_b32 v93, 0xffff0000, v142
    v_lshlrev_b32 v112, 16, v61
    v_and_b32 v113, 0xffff0000, v61
    v_lshlrev_b32 v140, 16, v52
    v_and_b32 v141, 0xffff0000, v52
    v_add_f32 v140, 1.0, v140
    v_add_f32 v141, 1.0, v141
    v_cvt_pk_bf16_f32 v142, v140, v141
    v_lshlrev_b32 v94, 16, v142
    v_and_b32 v95, 0xffff0000, v142
    v_lshlrev_b32 v114, 16, v62
    v_and_b32 v115, 0xffff0000, v62
    v_lshlrev_b32 v140, 16, v53
    v_and_b32 v141, 0xffff0000, v53
    v_add_f32 v140, 1.0, v140
    v_add_f32 v141, 1.0, v141
    v_cvt_pk_bf16_f32 v142, v140, v141
    v_lshlrev_b32 v96, 16, v142
    v_and_b32 v97, 0xffff0000, v142
    v_lshlrev_b32 v116, 16, v63
    v_and_b32 v117, 0xffff0000, v63
    v_lshlrev_b32 v140, 16, v54
    v_and_b32 v141, 0xffff0000, v54
    v_add_f32 v140, 1.0, v140
    v_add_f32 v141, 1.0, v141
    v_cvt_pk_bf16_f32 v142, v140, v141
    v_lshlrev_b32 v98, 16, v142
    v_and_b32 v99, 0xffff0000, v142
    v_lshlrev_b32 v118, 16, v64
    v_and_b32 v119, 0xffff0000, v64
    v_lshlrev_b32 v140, 16, v55
    v_and_b32 v141, 0xffff0000, v55
    v_add_f32 v140, 1.0, v140
    v_add_f32 v141, 1.0, v141
    v_cvt_pk_bf16_f32 v142, v140, v141
    v_lshlrev_b32 v100, 16, v142
    v_and_b32 v101, 0xffff0000, v142
    v_lshlrev_b32 v120, 16, v65
    v_and_b32 v121, 0xffff0000, v65
    v_lshlrev_b32 v140, 16, v56
    v_and_b32 v141, 0xffff0000, v56
    v_add_f32 v140, 1.0, v140
    v_add_f32 v141, 1.0, v141
    v_cvt_pk_bf16_f32 v142, v140, v141
    v_lshlrev_b32 v102, 16, v142
    v_and_b32 v103, 0xffff0000, v142
    v_lshlrev_b32 v122, 16, v66
    v_and_b32 v123, 0xffff0000, v66
    v_lshlrev_b32 v140, 16, v57
    v_and_b32 v141, 0xffff0000, v57
    v_add_f32 v140, 1.0, v140
    v_add_f32 v141, 1.0, v141
    v_cvt_pk_bf16_f32 v142, v140, v141
    v_lshlrev_b32 v104, 16, v142
    v_and_b32 v105, 0xffff0000, v142
    v_lshlrev_b32 v124, 16, v67
    v_and_b32 v125, 0xffff0000, v67
    v_lshlrev_b32 v140, 16, v58
    v_and_b32 v141, 0xffff0000, v58
    v_add_f32 v140, 1.0, v140
    v_add_f32 v141, 1.0, v141
    v_cvt_pk_bf16_f32 v142, v140, v141
    v_lshlrev_b32 v106, 16, v142
    v_and_b32 v107, 0xffff0000, v142
    v_lshlrev_b32 v126, 16, v68
    v_and_b32 v127, 0xffff0000, v68
    v_lshlrev_b32 v140, 16, v59
    v_and_b32 v141, 0xffff0000, v59
    v_add_f32 v140, 1.0, v140
    v_add_f32 v141, 1.0, v141
    v_cvt_pk_bf16_f32 v142, v140, v141
    v_lshlrev_b32 v108, 16, v142
    v_and_b32 v109, 0xffff0000, v142
    v_lshlrev_b32 v128, 16, v69
    v_and_b32 v129, 0xffff0000, v69
    v_add_f32 v140, v70, v71
    v_add_f32 v141, v72, v73
    v_add_f32 v140, v140, v74
    v_add_f32 v141, v141, v75
    v_add_f32 v140, v140, v76
    v_add_f32 v141, v141, v77
    v_add_f32 v140, v140, v78
    v_add_f32 v141, v141, v79
    v_add_f32 v140, v140, v80
    v_add_f32 v141, v141, v81
    v_add_f32 v140, v140, v82
    v_add_f32 v141, v141, v83
    v_add_f32 v140, v140, v84
    v_add_f32 v141, v141, v85
    v_add_f32 v140, v140, v86
    v_add_f32 v141, v141, v87
    v_add_f32 v140, v140, v88
    v_add_f32 v141, v141, v89
    v_add_f32 v140, v140, v141
    s_nop 1
    v_add_f32_dpp v141, v140, v140 quad_perm:[1,0,3,2] row_mask:0xf bank_mask:0xf
    s_nop 1
    v_add_f32_dpp v140, v141, v141 quad_perm:[2,3,0,1] row_mask:0xf bank_mask:0xf
    s_nop 1
    v_add_f32_dpp v141, v140, v140 row_half_mirror row_mask:0xf bank_mask:0xf
    s_nop 1
    v_add_f32_dpp v140, v141, v141 row_mirror row_mask:0xf bank_mask:0xf
    ds_swizzle_b32 v141, v140 offset:0x401F
    s_waitcnt lgkmcnt(0)
    v_add_f32 v140, v140, v141
    v_mul_f32 v142, 0x3acccccd, v140
    v_sub_f32 v141, v70, v142
    v_mul_f32 v140, v141, v141
    v_sub_f32 v141, v71, v142
    v_mul_f32 v143, v141, v141
    v_sub_f32 v141, v72, v142
    v_fmac_f32 v140, v141, v141
    v_sub_f32 v141, v73, v142
    v_fmac_f32 v143, v141, v141
    v_sub_f32 v141, v74, v142
    v_fmac_f32 v140, v141, v141
    v_sub_f32 v141, v75, v142
    v_fmac_f32 v143, v141, v141
    v_sub_f32 v141, v76, v142
    v_fmac_f32 v140, v141, v141
    v_sub_f32 v141, v77, v142
    v_fmac_f32 v143, v141, v141
    v_sub_f32 v141, v78, v142
    v_fmac_f32 v140, v141, v141
    v_sub_f32 v141, v79, v142
    v_fmac_f32 v143, v141, v141
    v_sub_f32 v141, v80, v142
    v_fmac_f32 v140, v141, v141
    v_sub_f32 v141, v81, v142
    v_fmac_f32 v143, v141, v141
    v_sub_f32 v141, v82, v142
    v_fmac_f32 v140, v141, v141
    v_sub_f32 v141, v83, v142
    v_fmac_f32 v143, v141, v141
    v_sub_f32 v141, v84, v142
    v_fmac_f32 v140, v141, v141
    v_sub_f32 v141, v85, v142
    v_fmac_f32 v143, v141, v141
    v_sub_f32 v141, v86, v142
    v_fmac_f32 v140, v141, v141
    v_sub_f32 v141, v87, v142
    v_fmac_f32 v143, v141, v141
    v_sub_f32 v141, v88, v142
    v_fmac_f32 v140, v141, v141
    v_sub_f32 v141, v89, v142
    v_fmac_f32 v143, v141, v141
    v_add_f32 v140, v140, v143
    s_nop 1
    v_add_f32_dpp v141, v140, v140 quad_perm:[1,0,3,2] row_mask:0xf bank_mask:0xf
    s_nop 1
    v_add_f32_dpp v140, v141, v141 quad_perm:[2,3,0,1] row_mask:0xf bank_mask:0xf
    s_nop 1
    v_add_f32_dpp v141, v140, v140 row_half_mirror row_mask:0xf bank_mask:0xf
    s_nop 1
    v_add_f32_dpp v140, v141, v141 row_mirror row_mask:0xf bank_mask:0xf
    ds_swizzle_b32 v141, v140 offset:0x401F
    s_waitcnt lgkmcnt(0)
    v_add_f32 v140, v140, v141
    v_mul_f32 v140, 0x3acccccd, v140
    v_cvt_pk_bf16_f32 v141, v142, v140
    v_lshlrev_b32 v142, 16, v141
    v_and_b32 v140, 0xffff0000, v141
    v_add_f32 v140, 0x3727c5ac, v140
    v_cvt_pk_bf16_f32 v141, v140, v140
    v_lshlrev_b32 v140, 16, v141
    v_sqrt_f32 v140, v140
    s_nop 0
    v_cvt_pk_bf16_f32 v141, v140, v140
    v_lshlrev_b32 v140, 16, v141
    v_rcp_f32 v143, v140
    s_nop 0
    v_sub_f32 v144, v70, v142
    v_sub_f32 v145, v71, v142
    v_cvt_pk_bf16_f32 v141, v144, v145
    v_lshlrev_b32 v144, 16, v141
    v_and_b32 v145, 0xffff0000, v141
    v_mul_f32 v144, v144, v143
    v_mul_f32 v145, v145, v143
    v_cvt_pk_bf16_f32 v141, v144, v145
    v_lshlrev_b32 v144, 16, v141
    v_and_b32 v145, 0xffff0000, v141
    v_mul_f32 v144, v144, v90
    v_mul_f32 v145, v145, v91
    v_cvt_pk_bf16_f32 v141, v144, v145
    v_lshlrev_b32 v144, 16, v141
    v_and_b32 v145, 0xffff0000, v141
    v_add_f32 v144, v144, v110
    v_add_f32 v145, v145, v111
    v_cvt_pk_bf16_f32 v130, v144, v145
    v_sub_f32 v144, v72, v142
    v_sub_f32 v145, v73, v142
    v_cvt_pk_bf16_f32 v141, v144, v145
    v_lshlrev_b32 v144, 16, v141
    v_and_b32 v145, 0xffff0000, v141
    v_mul_f32 v144, v144, v143
    v_mul_f32 v145, v145, v143
    v_cvt_pk_bf16_f32 v141, v144, v145
    v_lshlrev_b32 v144, 16, v141
    v_and_b32 v145, 0xffff0000, v141
    v_mul_f32 v144, v144, v92
    v_mul_f32 v145, v145, v93
    v_cvt_pk_bf16_f32 v141, v144, v145
    v_lshlrev_b32 v144, 16, v141
    v_and_b32 v145, 0xffff0000, v141
    v_add_f32 v144, v144, v112
    v_add_f32 v145, v145, v113
    v_cvt_pk_bf16_f32 v131, v144, v145
    v_sub_f32 v144, v74, v142
    v_sub_f32 v145, v75, v142
    v_cvt_pk_bf16_f32 v141, v144, v145
    v_lshlrev_b32 v144, 16, v141
    v_and_b32 v145, 0xffff0000, v141
    v_mul_f32 v144, v144, v143
    v_mul_f32 v145, v145, v143
    v_cvt_pk_bf16_f32 v141, v144, v145
    v_lshlrev_b32 v144, 16, v141
    v_and_b32 v145, 0xffff0000, v141
    v_mul_f32 v144, v144, v94
    v_mul_f32 v145, v145, v95
    v_cvt_pk_bf16_f32 v141, v144, v145
    v_lshlrev_b32 v144, 16, v141
    v_and_b32 v145, 0xffff0000, v141
    v_add_f32 v144, v144, v114
    v_add_f32 v145, v145, v115
    v_cvt_pk_bf16_f32 v132, v144, v145
    v_sub_f32 v144, v76, v142
    v_sub_f32 v145, v77, v142
    v_cvt_pk_bf16_f32 v141, v144, v145
    v_lshlrev_b32 v144, 16, v141
    v_and_b32 v145, 0xffff0000, v141
    v_mul_f32 v144, v144, v143
    v_mul_f32 v145, v145, v143
    v_cvt_pk_bf16_f32 v141, v144, v145
    v_lshlrev_b32 v144, 16, v141
    v_and_b32 v145, 0xffff0000, v141
    v_mul_f32 v144, v144, v96
    v_mul_f32 v145, v145, v97
    v_cvt_pk_bf16_f32 v141, v144, v145
    v_lshlrev_b32 v144, 16, v141
    v_and_b32 v145, 0xffff0000, v141
    v_add_f32 v144, v144, v116
    v_add_f32 v145, v145, v117
    v_cvt_pk_bf16_f32 v133, v144, v145
    v_sub_f32 v144, v78, v142
    v_sub_f32 v145, v79, v142
    v_cvt_pk_bf16_f32 v141, v144, v145
    v_lshlrev_b32 v144, 16, v141
    v_and_b32 v145, 0xffff0000, v141
    v_mul_f32 v144, v144, v143
    v_mul_f32 v145, v145, v143
    v_cvt_pk_bf16_f32 v141, v144, v145
    v_lshlrev_b32 v144, 16, v141
    v_and_b32 v145, 0xffff0000, v141
    v_mul_f32 v144, v144, v98
    v_mul_f32 v145, v145, v99
    v_cvt_pk_bf16_f32 v141, v144, v145
    v_lshlrev_b32 v144, 16, v141
    v_and_b32 v145, 0xffff0000, v141
    v_add_f32 v144, v144, v118
    v_add_f32 v145, v145, v119
    v_cvt_pk_bf16_f32 v134, v144, v145
    v_sub_f32 v144, v80, v142
    v_sub_f32 v145, v81, v142
    v_cvt_pk_bf16_f32 v141, v144, v145
    v_lshlrev_b32 v144, 16, v141
    v_and_b32 v145, 0xffff0000, v141
    v_mul_f32 v144, v144, v143
    v_mul_f32 v145, v145, v143
    v_cvt_pk_bf16_f32 v141, v144, v145
    v_lshlrev_b32 v144, 16, v141
    v_and_b32 v145, 0xffff0000, v141
    v_mul_f32 v144, v144, v100
    v_mul_f32 v145, v145, v101
    v_cvt_pk_bf16_f32 v141, v144, v145
    v_lshlrev_b32 v144, 16, v141
    v_and_b32 v145, 0xffff0000, v141
    v_add_f32 v144, v144, v120
    v_add_f32 v145, v145, v121
    v_cvt_pk_bf16_f32 v135, v144, v145
    v_sub_f32 v144, v82, v142
    v_sub_f32 v145, v83, v142
    v_cvt_pk_bf16_f32 v141, v144, v145
    v_lshlrev_b32 v144, 16, v141
    v_and_b32 v145, 0xffff0000, v141
    v_mul_f32 v144, v144, v143
    v_mul_f32 v145, v145, v143
    v_cvt_pk_bf16_f32 v141, v144, v145
    v_lshlrev_b32 v144, 16, v141
    v_and_b32 v145, 0xffff0000, v141
    v_mul_f32 v144, v144, v102
    v_mul_f32 v145, v145, v103
    v_cvt_pk_bf16_f32 v141, v144, v145
    v_lshlrev_b32 v144, 16, v141
    v_and_b32 v145, 0xffff0000, v141
    v_add_f32 v144, v144, v122
    v_add_f32 v145, v145, v123
    v_cvt_pk_bf16_f32 v136, v144, v145
    v_sub_f32 v144, v84, v142
    v_sub_f32 v145, v85, v142
    v_cvt_pk_bf16_f32 v141, v144, v145
    v_lshlrev_b32 v144, 16, v141
    v_and_b32 v145, 0xffff0000, v141
    v_mul_f32 v144, v144, v143
    v_mul_f32 v145, v145, v143
    v_cvt_pk_bf16_f32 v141, v144, v145
    v_lshlrev_b32 v144, 16, v141
    v_and_b32 v145, 0xffff0000, v141
    v_mul_f32 v144, v144, v104
    v_mul_f32 v145, v145, v105
    v_cvt_pk_bf16_f32 v141, v144, v145
    v_lshlrev_b32 v144, 16, v141
    v_and_b32 v145, 0xffff0000, v141
    v_add_f32 v144, v144, v124
    v_add_f32 v145, v145, v125
    v_cvt_pk_bf16_f32 v137, v144, v145
    v_sub_f32 v144, v86, v142
    v_sub_f32 v145, v87, v142
    v_cvt_pk_bf16_f32 v141, v144, v145
    v_lshlrev_b32 v144, 16, v141
    v_and_b32 v145, 0xffff0000, v141
    v_mul_f32 v144, v144, v143
    v_mul_f32 v145, v145, v143
    v_cvt_pk_bf16_f32 v141, v144, v145
    v_lshlrev_b32 v144, 16, v141
    v_and_b32 v145, 0xffff0000, v141
    v_mul_f32 v144, v144, v106
    v_mul_f32 v145, v145, v107
    v_cvt_pk_bf16_f32 v141, v144, v145
    v_lshlrev_b32 v144, 16, v141
    v_and_b32 v145, 0xffff0000, v141
    v_add_f32 v144, v144, v126
    v_add_f32 v145, v145, v127
    v_cvt_pk_bf16_f32 v138, v144, v145
    v_sub_f32 v144, v88, v142
    v_sub_f32 v145, v89, v142
    v_cvt_pk_bf16_f32 v141, v144, v145
    v_lshlrev_b32 v144, 16, v141
    v_and_b32 v145, 0xffff0000, v141
    v_mul_f32 v144, v144, v143
    v_mul_f32 v145, v145, v143
    v_cvt_pk_bf16_f32 v141, v144, v145
    v_lshlrev_b32 v144, 16, v141
    v_and_b32 v145, 0xffff0000, v141
    v_mul_f32 v144, v144, v108
    v_mul_f32 v145, v145, v109
    v_cvt_pk_bf16_f32 v141, v144, v145
    v_lshlrev_b32 v144, 16, v141
    v_and_b32 v145, 0xffff0000, v141
    v_add_f32 v144, v144, v128
    v_add_f32 v145, v145, v129
    v_cvt_pk_bf16_f32 v139, v144, v145
    buffer_store_dwordx2 v[130:131], v1, s[16:19], 0 offen offset:0
    buffer_store_dwordx2 v[132:133], v1, s[16:19], 0 offen offset:256
    buffer_store_dwordx2 v[134:135], v1, s[16:19], 0 offen offset:512
    buffer_store_dwordx2 v[136:137], v1, s[16:19], 0 offen offset:768
    buffer_store_dwordx2 v[138:139], v1, s[16:19], 0 offen offset:1024
ln2_kernel_end:
    s_endpgm
.globl gemmc_kernel
.p2align 8
.type gemmc_kernel,@function
gemmc_kernel:
    s_cmp_ge_u32 s2, 256
    s_cbranch_scc1 gemmc_kernel_end
    v_lshrrev_b32 v1, 6, v0
    s_nop 0
    v_readfirstlane_b32 s40, v1
    v_and_b32 v1, 63, v0
    v_and_b32 v2, 15, v1
    v_lshrrev_b32 v3, 4, v1
    s_load_dwordx2 s[48:49], s[0:1], 96
    s_waitcnt lgkmcnt(0)
    s_and_b32 s3, s2, 7
    s_lshr_b32 s4, s2, 3
    s_lshr_b32 s5, s4, 1
    s_lshl_b32 s6, s3, 1
    s_and_b32 s7, s4, 1
    s_add_u32 s6, s6, s7
    s_add_u32 s8, s48, 131072
    s_addc_u32 s9, s49, 0
    s_mov_b32 s10, 122880
    s_mov_b32 s11, 0x00020000
    s_mul_i32 s20, s5, 122880
    s_add_u32 s8, s8, s20
    s_addc_u32 s9, s9, 0
    s_add_u32 s12, s48, 19791872
    s_addc_u32 s13, s49, 0
    s_mov_b32 s14, 163840
    s_mov_b32 s15, 0x00020000
    s_mul_i32 s20, s6, 163840
    s_add_u32 s12, s12, s20
    s_addc_u32 s13, s13, 0
    s_add_u32 s16, s48, 22413312
    s_addc_u32 s17, s49, 0
    s_mov_b32 s18, 393216
    s_mov_b32 s19, 0x00020000
    s_mul_i32 s20, s6, 393216
    s_mul_i32 s21, s5, 192
    s_add_u32 s20, s20, s21
    s_add_u32 s16, s16, s20
    s_addc_u32 s17, s17, 0
    s_cmp_lt_u32 s40, 4
    s_cbranch_scc1 gemmc_kernel_comp
    s_sub_u32 s40, s40, 4
    v_lshrrev_b32 v4, 3, v1
    v_and_b32 v5, 7, v1
    v_and_b32 v6, 1, v3
    v_xor_b32 v6, v6, v5
    v_xor_b32 v7, v3, v5
    s_movk_i32 s46, 1280
    v_mul_lo_u32 v28, v4, s46
    s_movk_i32 s46, 1280
    v_mul_lo_u32 v29, v4, s46
    s_mul_i32 s44, s40, 2
    s_mul_i32 s45, s40, 10240
    s_mul_i32 s64, s40, 1024
    v_xor_b32 v30, s44, v6
    v_lshl_add_u32 v30, v30, 4, v28
    v_add_u32 v8, s45, v30
    s_add_u32 m0, s64, 0
    s_movk_i32 s46, 0
    buffer_load_dwordx4 v8, s[8:11], s46 offen lds
    s_mul_i32 s44, s40, 2
    s_mul_i32 s45, s40, 10240
    s_add_u32 s45, s45, 40960
    s_mul_i32 s65, s40, 1024
    s_add_u32 s65, s65, 4096
    v_xor_b32 v30, s44, v6
    v_lshl_add_u32 v30, v30, 4, v28
    v_add_u32 v9, s45, v30
    s_add_u32 m0, s65, 0
    s_movk_i32 s46, 0
    buffer_load_dwordx4 v9, s[8:11], s46 offen lds
    s_mul_i32 s44, s40, 2
    s_mul_i32 s45, s40, 10240
    s_add_u32 s45, s45, 81920
    s_mul_i32 s66, s40, 1024
    s_add_u32 s66, s66, 8192
    v_xor_b32 v30, s44, v6
    v_lshl_add_u32 v30, v30, 4, v28
    v_add_u32 v10, s45, v30
    s_add_u32 m0, s66, 0
    s_movk_i32 s46, 0
    buffer_load_dwordx4 v10, s[8:11], s46 offen lds
    s_mov_b32 s44, 0
    s_cmp_eq_u32 s40, 1
    s_cselect_b32 s44, 4, s44
    s_cmp_eq_u32 s40, 2
    s_cselect_b32 s44, 0, s44
    s_cmp_eq_u32 s40, 3
    s_cselect_b32 s44, 4, s44
    s_mul_i32 s45, s40, 10240
    s_mul_i32 s67, s40, 1024
    s_add_u32 s67, s67, 12288
    v_xor_b32 v30, s44, v7
    v_lshl_add_u32 v30, v30, 4, v29
    v_add_u32 v11, s45, v30
    s_add_u32 m0, s67, 0
    s_movk_i32 s46, 0
    buffer_load_dwordx4 v11, s[12:15], s46 offen lds
    s_mov_b32 s44, 0
    s_cmp_eq_u32 s40, 1
    s_cselect_b32 s44, 4, s44
    s_cmp_eq_u32 s40, 2
    s_cselect_b32 s44, 0, s44
    s_cmp_eq_u32 s40, 3
    s_cselect_b32 s44, 4, s44
    s_mul_i32 s45, s40, 10240
    s_add_u32 s45, s45, 40960
    s_mul_i32 s68, s40, 1024
    s_add_u32 s68, s68, 16384
    v_xor_b32 v30, s44, v7
    v_lshl_add_u32 v30, v30, 4, v29
    v_add_u32 v12, s45, v30
    s_add_u32 m0, s68, 0
    s_movk_i32 s46, 0
    buffer_load_dwordx4 v12, s[12:15], s46 offen lds
    s_mov_b32 s44, 0
    s_cmp_eq_u32 s40, 1
    s_cselect_b32 s44, 4, s44
    s_cmp_eq_u32 s40, 2
    s_cselect_b32 s44, 0, s44
    s_cmp_eq_u32 s40, 3
    s_cselect_b32 s44, 4, s44
    s_mul_i32 s45, s40, 10240
    s_add_u32 s45, s45, 81920
    s_mul_i32 s69, s40, 1024
    s_add_u32 s69, s69, 20480
    v_xor_b32 v30, s44, v7
    v_lshl_add_u32 v30, v30, 4, v29
    v_add_u32 v13, s45, v30
    s_add_u32 m0, s69, 0
    s_movk_i32 s46, 0
    buffer_load_dwordx4 v13, s[12:15], s46 offen lds
    s_mov_b32 s44, 0
    s_cmp_eq_u32 s40, 1
    s_cselect_b32 s44, 4, s44
    s_cmp_eq_u32 s40, 2
    s_cselect_b32 s44, 0, s44
    s_cmp_eq_u32 s40, 3
    s_cselect_b32 s44, 4, s44
    s_mul_i32 s45, s40, 10240
    s_add_u32 s45, s45, 122880
    s_mul_i32 s70, s40, 1024
    s_add_u32 s70, s70, 24576
    v_xor_b32 v30, s44, v7
    v_lshl_add_u32 v30, v30, 4, v29
    v_add_u32 v14, s45, v30
    s_add_u32 m0, s70, 0
    s_movk_i32 s46, 0
    buffer_load_dwordx4 v14, s[12:15], s46 offen lds
    s_add_u32 m0, s64, 28672
    s_movk_i32 s46, 128
    buffer_load_dwordx4 v8, s[8:11], s46 offen lds
    s_add_u32 m0, s65, 28672
    s_movk_i32 s46, 128
    buffer_load_dwordx4 v9, s[8:11], s46 offen lds
    s_add_u32 m0, s66, 28672
    s_movk_i32 s46, 128
    buffer_load_dwordx4 v10, s[8:11], s46 offen lds
    s_add_u32 m0, s67, 28672
    s_movk_i32 s46, 128
    buffer_load_dwordx4 v11, s[12:15], s46 offen lds
    s_add_u32 m0, s68, 28672
    s_movk_i32 s46, 128
    buffer_load_dwordx4 v12, s[12:15], s46 offen lds
    s_add_u32 m0, s69, 28672
    s_movk_i32 s46, 128
    buffer_load_dwordx4 v13, s[12:15], s46 offen lds
    s_add_u32 m0, s70, 28672
    s_movk_i32 s46, 128
    buffer_load_dwordx4 v14, s[12:15], s46 offen lds
    s_waitcnt vmcnt(7)
    s_barrier
    s_add_u32 m0, s64, 57344
    s_movk_i32 s46, 256
    buffer_load_dwordx4 v8, s[8:11], s46 offen lds
    s_add_u32 m0, s65, 57344
    s_movk_i32 s46, 256
    buffer_load_dwordx4 v9, s[8:11], s46 offen lds
    s_add_u32 m0, s66, 57344
    s_movk_i32 s46, 256
    buffer_load_dwordx4 v10, s[8:11], s46 offen lds
    s_add_u32 m0, s67, 57344
    s_movk_i32 s46, 256
    buffer_load_dwordx4 v11, s[12:15], s46 offen lds
    s_add_u32 m0, s68, 57344
    s_movk_i32 s46, 256
    buffer_load_dwordx4 v12, s[12:15], s46 offen lds
    s_add_u32 m0, s69, 57344
    s_movk_i32 s46, 256
    buffer_load_dwordx4 v13, s[12:15], s46 offen lds
    s_add_u32 m0, s70, 57344
    s_movk_i32 s46, 256
    buffer_load_dwordx4 v14, s[12:15], s46 offen lds
    s_add_u32 m0, s64, 86016
    s_movk_i32 s46, 384
    buffer_load_dwordx4 v8, s[8:11], s46 offen lds
    s_add_u32 m0, s65, 86016
    s_movk_i32 s46, 384
    buffer_load_dwordx4 v9, s[8:11], s46 offen lds
    s_add_u32 m0, s66, 86016
    s_movk_i32 s46, 384
    buffer_load_dwordx4 v10, s[8:11], s46 offen lds
    s_add_u32 m0, s67, 86016
    s_movk_i32 s46, 384
    buffer_load_dwordx4 v11, s[12:15], s46 offen lds
    s_add_u32 m0, s68, 86016
    s_movk_i32 s46, 384
    buffer_load_dwordx4 v12, s[12:15], s46 offen lds
    s_add_u32 m0, s69, 86016
    s_movk_i32 s46, 384
    buffer_load_dwordx4 v13, s[12:15], s46 offen lds
    s_add_u32 m0, s70, 86016
    s_movk_i32 s46, 384
    buffer_load_dwordx4 v14, s[12:15], s46 offen lds
    s_waitcnt vmcnt(14)
    s_barrier
    s_add_u32 m0, s64, 114688
    s_movk_i32 s46, 512
    buffer_load_dwordx4 v8, s[8:11], s46 offen lds
    s_add_u32 m0, s65, 114688
    s_movk_i32 s46, 512
    buffer_load_dwordx4 v9, s[8:11], s46 offen lds
    s_add_u32 m0, s66, 114688
    s_movk_i32 s46, 512
    buffer_load_dwordx4 v10, s[8:11], s46 offen lds
    s_add_u32 m0, s67, 114688
    s_movk_i32 s46, 512
    buffer_load_dwordx4 v11, s[12:15], s46 offen lds
    s_add_u32 m0, s68, 114688
    s_movk_i32 s46, 512
    buffer_load_dwordx4 v12, s[12:15], s46 offen lds
    s_add_u32 m0, s69, 114688
    s_movk_i32 s46, 512
    buffer_load_dwordx4 v13, s[12:15], s46 offen lds
    s_add_u32 m0, s70, 114688
    s_movk_i32 s46, 512
    buffer_load_dwordx4 v14, s[12:15], s46 offen lds
    s_add_u32 m0, s64, 0
    s_movk_i32 s46, 640
    buffer_load_dwordx4 v8, s[8:11], s46 offen lds
    s_add_u32 m0, s65, 0
    s_movk_i32 s46, 640
    buffer_load_dwordx4 v9, s[8:11], s46 offen lds
    s_add_u32 m0, s66, 0
    s_movk_i32 s46, 640
    buffer_load_dwordx4 v10, s[8:11], s46 offen lds
    s_add_u32 m0, s67, 0
    s_movk_i32 s46, 640
    buffer_load_dwordx4 v11, s[12:15], s46 offen lds
    s_add_u32 m0, s68, 0
    s_movk_i32 s46, 640
    buffer_load_dwordx4 v12, s[12:15], s46 offen lds
    s_add_u32 m0, s69, 0
    s_movk_i32 s46, 640
    buffer_load_dwordx4 v13, s[12:15], s46 offen lds
    s_add_u32 m0, s70, 0
    s_movk_i32 s46, 640
    buffer_load_dwordx4 v14, s[12:15], s46 offen lds
    s_waitcnt vmcnt(21)
    s_barrier
    s_add_u32 m0, s64, 28672
    s_movk_i32 s46, 768
    buffer_load_dwordx4 v8, s[8:11], s46 offen lds
    s_add_u32 m0, s65, 28672
    s_movk_i32 s46, 768
    buffer_load_dwordx4 v9, s[8:11], s46 offen lds
    s_add_u32 m0, s66, 28672
    s_movk_i32 s46, 768
    buffer_load_dwordx4 v10, s[8:11], s46 offen lds
    s_add_u32 m0, s67, 28672
    s_movk_i32 s46, 768
    buffer_load_dwordx4 v11, s[12:15], s46 offen lds
    s_add_u32 m0, s68, 28672
    s_movk_i32 s46, 768
    buffer_load_dwordx4 v12, s[12:15], s46 offen lds
    s_add_u32 m0, s69, 28672
    s_movk_i32 s46, 768
    buffer_load_dwordx4 v13, s[12:15], s46 offen lds
    s_add_u32 m0, s70, 28672
    s_movk_i32 s46, 768
    buffer_load_dwordx4 v14, s[12:15], s46 offen lds
    s_waitcnt vmcnt(21)
    s_barrier
    s_add_u32 m0, s64, 57344
    s_movk_i32 s46, 896
    buffer_load_dwordx4 v8, s[8:11], s46 offen lds
    s_add_u32 m0, s65, 57344
    s_movk_i32 s46, 896
    buffer_load_dwordx4 v9, s[8:11], s46 offen lds
    s_add_u32 m0, s66, 57344
    s_movk_i32 s46, 896
    buffer_load_dwordx4 v10, s[8:11], s46 offen lds
    s_add_u32 m0, s67, 57344
    s_movk_i32 s46, 896
    buffer_load_dwordx4 v11, s[12:15], s46 offen lds
    s_add_u32 m0, s68, 57344
    s_movk_i32 s46, 896
    buffer_load_dwordx4 v12, s[12:15], s46 offen lds
    s_add_u32 m0, s69, 57344
    s_movk_i32 s46, 896
    buffer_load_dwordx4 v13, s[12:15], s46 offen lds
    s_add_u32 m0, s70, 57344
    s_movk_i32 s46, 896
    buffer_load_dwordx4 v14, s[12:15], s46 offen lds
    s_waitcnt vmcnt(21)
    s_barrier
    s_add_u32 m0, s64, 86016
    s_movk_i32 s46, 1024
    buffer_load_dwordx4 v8, s[8:11], s46 offen lds
    s_add_u32 m0, s65, 86016
    s_movk_i32 s46, 1024
    buffer_load_dwordx4 v9, s[8:11], s46 offen lds
    s_add_u32 m0, s66, 86016
    s_movk_i32 s46, 1024
    buffer_load_dwordx4 v10, s[8:11], s46 offen lds
    s_add_u32 m0, s67, 86016
    s_movk_i32 s46, 1024
    buffer_load_dwordx4 v11, s[12:15], s46 offen lds
    s_add_u32 m0, s68, 86016
    s_movk_i32 s46, 1024
    buffer_load_dwordx4 v12, s[12:15], s46 offen lds
    s_add_u32 m0, s69, 86016
    s_movk_i32 s46, 1024
    buffer_load_dwordx4 v13, s[12:15], s46 offen lds
    s_add_u32 m0, s70, 86016
    s_movk_i32 s46, 1024
    buffer_load_dwordx4 v14, s[12:15], s46 offen lds
    s_waitcnt vmcnt(21)
    s_barrier
    s_add_u32 m0, s64, 114688
    s_movk_i32 s46, 1152
    buffer_load_dwordx4 v8, s[8:11], s46 offen lds
    s_add_u32 m0, s65, 114688
    s_movk_i32 s46, 1152
    buffer_load_dwordx4 v9, s[8:11], s46 offen lds
    s_add_u32 m0, s66, 114688
    s_movk_i32 s46, 1152
    buffer_load_dwordx4 v10, s[8:11], s46 offen lds
    s_add_u32 m0, s67, 114688
    s_movk_i32 s46, 1152
    buffer_load_dwordx4 v11, s[12:15], s46 offen lds
    s_add_u32 m0, s68, 114688
    s_movk_i32 s46, 1152
    buffer_load_dwordx4 v12, s[12:15], s46 offen lds
    s_add_u32 m0, s69, 114688
    s_movk_i32 s46, 1152
    buffer_load_dwordx4 v13, s[12:15], s46 offen lds
    s_add_u32 m0, s70, 114688
    s_movk_i32 s46, 1152
    buffer_load_dwordx4 v14, s[12:15], s46 offen lds
    s_waitcnt vmcnt(21)
    s_barrier
    s_waitcnt vmcnt(14)
    s_barrier
    s_waitcnt vmcnt(7)
    s_barrier
    s_waitcnt vmcnt(0)
    s_barrier
    s_endpgm
gemmc_kernel_comp:
    s_mov_b32 s42, s40
    s_mov_b32 s43, 0
    v_lshrrev_b32 v4, 1, v2
    v_xor_b32 v4, v4, v3
    v_and_b32 v5, 12, v2
    v_lshlrev_b32 v5, 1, v5
    v_and_b32 v6, 3, v2
    v_or_b32 v5, v5, v6
    v_xor_b32 v6, 0, v4
    v_lshlrev_b32 v6, 4, v6
    v_lshl_add_u32 v6, v5, 7, v6
    v_add_u32 v8, 0, v6
    v_add_u32 v10, 28672, v6
    v_add_u32 v12, 57344, v6
    v_add_u32 v14, 86016, v6
    v_add_u32 v16, 114688, v6
    v_xor_b32 v6, 4, v4
    v_lshlrev_b32 v6, 4, v6
    v_lshl_add_u32 v6, v5, 7, v6
    v_add_u32 v9, 0, v6
    v_add_u32 v11, 28672, v6
    v_add_u32 v13, 57344, v6
    v_add_u32 v15, 86016, v6
    v_add_u32 v17, 114688, v6
    s_lshl_b32 s46, s42, 12
    s_add_u32 s46, s46, 12288
    v_xor_b32 v6, 0, v4
    v_lshlrev_b32 v6, 4, v6
    v_lshl_add_u32 v6, v2, 7, v6
    v_add_u32 v6, s46, v6
    v_add_u32 v18, 0, v6
    v_add_u32 v20, 28672, v6
    v_add_u32 v22, 57344, v6
    v_add_u32 v24, 86016, v6
    v_add_u32 v26, 114688, v6
    v_xor_b32 v6, 4, v4
    v_lshlrev_b32 v6, 4, v6
    v_lshl_add_u32 v6, v2, 7, v6
    v_add_u32 v6, s46, v6
    v_add_u32 v19, 0, v6
    v_add_u32 v21, 28672, v6
    v_add_u32 v23, 57344, v6
    v_add_u32 v25, 86016, v6
    v_add_u32 v27, 114688, v6
    s_barrier
    ds_read_b128 v[56:59], v18 offset:0
    ds_read_b128 v[60:63], v18 offset:2048
    ds_read_b128 v[32:35], v8 offset:0
    ds_read_b128 v[36:39], v8 offset:512
    ds_read_b128 v[40:43], v8 offset:4096
    ds_read_b128 v[44:47], v8 offset:4608
    ds_read_b128 v[48:51], v8 offset:8192
    ds_read_b128 v[52:55], v8 offset:8704
    ds_read_b128 v[88:91], v19 offset:0
    ds_read_b128 v[92:95], v19 offset:2048
    ds_read_b128 v[64:67], v9 offset:0
    ds_read_b128 v[68:71], v9 offset:512
    ds_read_b128 v[72:75], v9 offset:4096
    ds_read_b128 v[76:79], v9 offset:4608
    ds_read_b128 v[80:83], v9 offset:8192
    ds_read_b128 v[84:87], v9 offset:8704
    s_waitcnt lgkmcnt(8)
    v_mfma_f32_16x16x32_bf16 a[0:3], v[32:35], v[56:59], 0
    v_mfma_f32_16x16x32_bf16 a[4:7], v[32:35], v[60:63], 0
    v_mfma_f32_16x16x32_bf16 a[8:11], v[36:39], v[56:59], 0
    v_mfma_f32_16x16x32_bf16 a[12:15], v[36:39], v[60:63], 0
    v_mfma_f32_16x16x32_bf16 a[16:19], v[40:43], v[56:59], 0
    v_mfma_f32_16x16x32_bf16 a[20:23], v[40:43], v[60:63], 0
    v_mfma_f32_16x16x32_bf16 a[24:27], v[44:47], v[56:59], 0
    v_mfma_f32_16x16x32_bf16 a[28:31], v[44:47], v[60:63], 0
    v_mfma_f32_16x16x32_bf16 a[32:35], v[48:51], v[56:59], 0
    v_mfma_f32_16x16x32_bf16 a[36:39], v[48:51], v[60:63], 0
    v_mfma_f32_16x16x32_bf16 a[40:43], v[52:55], v[56:59], 0
    v_mfma_f32_16x16x32_bf16 a[44:47], v[52:55], v[60:63], 0
    s_waitcnt lgkmcnt(0)
    s_barrier
    ds_read_b128 v[56:59], v20 offset:0
    ds_read_b128 v[60:63], v20 offset:2048
    ds_read_b128 v[32:35], v10 offset:0
    ds_read_b128 v[36:39], v10 offset:512
    ds_read_b128 v[40:43], v10 offset:4096
    ds_read_b128 v[44:47], v10 offset:4608
    ds_read_b128 v[48:51], v10 offset:8192
    ds_read_b128 v[52:55], v10 offset:8704
    v_mfma_f32_16x16x32_bf16 a[0:3], v[64:67], v[88:91], a[0:3]
    v_mfma_f32_16x16x32_bf16 a[4:7], v[64:67], v[92:95], a[4:7]
    v_mfma_f32_16x16x32_bf16 a[8:11], v[68:71], v[88:91], a[8:11]
    v_mfma_f32_16x16x32_bf16 a[12:15], v[68:71], v[92:95], a[12:15]
    v_mfma_f32_16x16x32_bf16 a[16:19], v[72:75], v[88:91], a[16:19]
    v_mfma_f32_16x16x32_bf16 a[20:23], v[72:75], v[92:95], a[20:23]
    v_mfma_f32_16x16x32_bf16 a[24:27], v[76:79], v[88:91], a[24:27]
    v_mfma_f32_16x16x32_bf16 a[28:31], v[76:79], v[92:95], a[28:31]
    v_mfma_f32_16x16x32_bf16 a[32:35], v[80:83], v[88:91], a[32:35]
    v_mfma_f32_16x16x32_bf16 a[36:39], v[80:83], v[92:95], a[36:39]
    v_mfma_f32_16x16x32_bf16 a[40:43], v[84:87], v[88:91], a[40:43]
    v_mfma_f32_16x16x32_bf16 a[44:47], v[84:87], v[92:95], a[44:47]
    ds_read_b128 v[88:91], v21 offset:0
    ds_read_b128 v[92:95], v21 offset:2048
    ds_read_b128 v[64:67], v11 offset:0
    ds_read_b128 v[68:71], v11 offset:512
    ds_read_b128 v[72:75], v11 offset:4096
    ds_read_b128 v[76:79], v11 offset:4608
    ds_read_b128 v[80:83], v11 offset:8192
    ds_read_b128 v[84:87], v11 offset:8704
    s_waitcnt lgkmcnt(8)
    v_mfma_f32_16x16x32_bf16 a[0:3], v[32:35], v[56:59], a[0:3]
    v_mfma_f32_16x16x32_bf16 a[4:7], v[32:35], v[60:63], a[4:7]
    v_mfma_f32_16x16x32_bf16 a[8:11], v[36:39], v[56:59], a[8:11]
    v_mfma_f32_16x16x32_bf16 a[12:15], v[36:39], v[60:63], a[12:15]
    v_mfma_f32_16x16x32_bf16 a[16:19], v[40:43], v[56:59], a[16:19]
    v_mfma_f32_16x16x32_bf16 a[20:23], v[40:43], v[60:63], a[20:23]
    v_mfma_f32_16x16x32_bf16 a[24:27], v[44:47], v[56:59], a[24:27]
    v_mfma_f32_16x16x32_bf16 a[28:31], v[44:47], v[60:63], a[28:31]
    v_mfma_f32_16x16x32_bf16 a[32:35], v[48:51], v[56:59], a[32:35]
    v_mfma_f32_16x16x32_bf16 a[36:39], v[48:51], v[60:63], a[36:39]
    v_mfma_f32_16x16x32_bf16 a[40:43], v[52:55], v[56:59], a[40:43]
    v_mfma_f32_16x16x32_bf16 a[44:47], v[52:55], v[60:63], a[44:47]
    s_waitcnt lgkmcnt(0)
    s_barrier
    ds_read_b128 v[56:59], v22 offset:0
    ds_read_b128 v[60:63], v22 offset:2048
    ds_read_b128 v[32:35], v12 offset:0
    ds_read_b128 v[36:39], v12 offset:512
    ds_read_b128 v[40:43], v12 offset:4096
    ds_read_b128 v[44:47], v12 offset:4608
    ds_read_b128 v[48:51], v12 offset:8192
    ds_read_b128 v[52:55], v12 offset:8704
    v_mfma_f32_16x16x32_bf16 a[0:3], v[64:67], v[88:91], a[0:3]
    v_mfma_f32_16x16x32_bf16 a[4:7], v[64:67], v[92:95], a[4:7]
    v_mfma_f32_16x16x32_bf16 a[8:11], v[68:71], v[88:91], a[8:11]
    v_mfma_f32_16x16x32_bf16 a[12:15], v[68:71], v[92:95], a[12:15]
    v_mfma_f32_16x16x32_bf16 a[16:19], v[72:75], v[88:91], a[16:19]
    v_mfma_f32_16x16x32_bf16 a[20:23], v[72:75], v[92:95], a[20:23]
    v_mfma_f32_16x16x32_bf16 a[24:27], v[76:79], v[88:91], a[24:27]
    v_mfma_f32_16x16x32_bf16 a[28:31], v[76:79], v[92:95], a[28:31]
    v_mfma_f32_16x16x32_bf16 a[32:35], v[80:83], v[88:91], a[32:35]
    v_mfma_f32_16x16x32_bf16 a[36:39], v[80:83], v[92:95], a[36:39]
    v_mfma_f32_16x16x32_bf16 a[40:43], v[84:87], v[88:91], a[40:43]
    v_mfma_f32_16x16x32_bf16 a[44:47], v[84:87], v[92:95], a[44:47]
    ds_read_b128 v[88:91], v23 offset:0
    ds_read_b128 v[92:95], v23 offset:2048
    ds_read_b128 v[64:67], v13 offset:0
    ds_read_b128 v[68:71], v13 offset:512
    ds_read_b128 v[72:75], v13 offset:4096
    ds_read_b128 v[76:79], v13 offset:4608
    ds_read_b128 v[80:83], v13 offset:8192
    ds_read_b128 v[84:87], v13 offset:8704
    s_waitcnt lgkmcnt(8)
    v_mfma_f32_16x16x32_bf16 a[0:3], v[32:35], v[56:59], a[0:3]
    v_mfma_f32_16x16x32_bf16 a[4:7], v[32:35], v[60:63], a[4:7]
    v_mfma_f32_16x16x32_bf16 a[8:11], v[36:39], v[56:59], a[8:11]
    v_mfma_f32_16x16x32_bf16 a[12:15], v[36:39], v[60:63], a[12:15]
    v_mfma_f32_16x16x32_bf16 a[16:19], v[40:43], v[56:59], a[16:19]
    v_mfma_f32_16x16x32_bf16 a[20:23], v[40:43], v[60:63], a[20:23]
    v_mfma_f32_16x16x32_bf16 a[24:27], v[44:47], v[56:59], a[24:27]
    v_mfma_f32_16x16x32_bf16 a[28:31], v[44:47], v[60:63], a[28:31]
    v_mfma_f32_16x16x32_bf16 a[32:35], v[48:51], v[56:59], a[32:35]
    v_mfma_f32_16x16x32_bf16 a[36:39], v[48:51], v[60:63], a[36:39]
    v_mfma_f32_16x16x32_bf16 a[40:43], v[52:55], v[56:59], a[40:43]
    v_mfma_f32_16x16x32_bf16 a[44:47], v[52:55], v[60:63], a[44:47]
    s_waitcnt lgkmcnt(0)
    s_barrier
    ds_read_b128 v[56:59], v24 offset:0
    ds_read_b128 v[60:63], v24 offset:2048
    ds_read_b128 v[32:35], v14 offset:0
    ds_read_b128 v[36:39], v14 offset:512
    ds_read_b128 v[40:43], v14 offset:4096
    ds_read_b128 v[44:47], v14 offset:4608
    ds_read_b128 v[48:51], v14 offset:8192
    ds_read_b128 v[52:55], v14 offset:8704
    v_mfma_f32_16x16x32_bf16 a[0:3], v[64:67], v[88:91], a[0:3]
    v_mfma_f32_16x16x32_bf16 a[4:7], v[64:67], v[92:95], a[4:7]
    v_mfma_f32_16x16x32_bf16 a[8:11], v[68:71], v[88:91], a[8:11]
    v_mfma_f32_16x16x32_bf16 a[12:15], v[68:71], v[92:95], a[12:15]
    v_mfma_f32_16x16x32_bf16 a[16:19], v[72:75], v[88:91], a[16:19]
    v_mfma_f32_16x16x32_bf16 a[20:23], v[72:75], v[92:95], a[20:23]
    v_mfma_f32_16x16x32_bf16 a[24:27], v[76:79], v[88:91], a[24:27]
    v_mfma_f32_16x16x32_bf16 a[28:31], v[76:79], v[92:95], a[28:31]
    v_mfma_f32_16x16x32_bf16 a[32:35], v[80:83], v[88:91], a[32:35]
    v_mfma_f32_16x16x32_bf16 a[36:39], v[80:83], v[92:95], a[36:39]
    v_mfma_f32_16x16x32_bf16 a[40:43], v[84:87], v[88:91], a[40:43]
    v_mfma_f32_16x16x32_bf16 a[44:47], v[84:87], v[92:95], a[44:47]
    ds_read_b128 v[88:91], v25 offset:0
    ds_read_b128 v[92:95], v25 offset:2048
    ds_read_b128 v[64:67], v15 offset:0
    ds_read_b128 v[68:71], v15 offset:512
    ds_read_b128 v[72:75], v15 offset:4096
    ds_read_b128 v[76:79], v15 offset:4608
    ds_read_b128 v[80:83], v15 offset:8192
    ds_read_b128 v[84:87], v15 offset:8704
    s_waitcnt lgkmcnt(8)
    v_mfma_f32_16x16x32_bf16 a[0:3], v[32:35], v[56:59], a[0:3]
    v_mfma_f32_16x16x32_bf16 a[4:7], v[32:35], v[60:63], a[4:7]
    v_mfma_f32_16x16x32_bf16 a[8:11], v[36:39], v[56:59], a[8:11]
    v_mfma_f32_16x16x32_bf16 a[12:15], v[36:39], v[60:63], a[12:15]
    v_mfma_f32_16x16x32_bf16 a[16:19], v[40:43], v[56:59], a[16:19]
    v_mfma_f32_16x16x32_bf16 a[20:23], v[40:43], v[60:63], a[20:23]
    v_mfma_f32_16x16x32_bf16 a[24:27], v[44:47], v[56:59], a[24:27]
    v_mfma_f32_16x16x32_bf16 a[28:31], v[44:47], v[60:63], a[28:31]
    v_mfma_f32_16x16x32_bf16 a[32:35], v[48:51], v[56:59], a[32:35]
    v_mfma_f32_16x16x32_bf16 a[36:39], v[48:51], v[60:63], a[36:39]
    v_mfma_f32_16x16x32_bf16 a[40:43], v[52:55], v[56:59], a[40:43]
    v_mfma_f32_16x16x32_bf16 a[44:47], v[52:55], v[60:63], a[44:47]
    s_waitcnt lgkmcnt(0)
    s_barrier
    ds_read_b128 v[56:59], v26 offset:0
    ds_read_b128 v[60:63], v26 offset:2048
    ds_read_b128 v[32:35], v16 offset:0
    ds_read_b128 v[36:39], v16 offset:512
    ds_read_b128 v[40:43], v16 offset:4096
    ds_read_b128 v[44:47], v16 offset:4608
    ds_read_b128 v[48:51], v16 offset:8192
    ds_read_b128 v[52:55], v16 offset:8704
    v_mfma_f32_16x16x32_bf16 a[0:3], v[64:67], v[88:91], a[0:3]
    v_mfma_f32_16x16x32_bf16 a[4:7], v[64:67], v[92:95], a[4:7]
    v_mfma_f32_16x16x32_bf16 a[8:11], v[68:71], v[88:91], a[8:11]
    v_mfma_f32_16x16x32_bf16 a[12:15], v[68:71], v[92:95], a[12:15]
    v_mfma_f32_16x16x32_bf16 a[16:19], v[72:75], v[88:91], a[16:19]
    v_mfma_f32_16x16x32_bf16 a[20:23], v[72:75], v[92:95], a[20:23]
    v_mfma_f32_16x16x32_bf16 a[24:27], v[76:79], v[88:91], a[24:27]
    v_mfma_f32_16x16x32_bf16 a[28:31], v[76:79], v[92:95], a[28:31]
    v_mfma_f32_16x16x32_bf16 a[32:35], v[80:83], v[88:91], a[32:35]
    v_mfma_f32_16x16x32_bf16 a[36:39], v[80:83], v[92:95], a[36:39]
    v_mfma_f32_16x16x32_bf16 a[40:43], v[84:87], v[88:91], a[40:43]
    v_mfma_f32_16x16x32_bf16 a[44:47], v[84:87], v[92:95], a[44:47]
    ds_read_b128 v[88:91], v27 offset:0
    ds_read_b128 v[92:95], v27 offset:2048
    ds_read_b128 v[64:67], v17 offset:0
    ds_read_b128 v[68:71], v17 offset:512
    ds_read_b128 v[72:75], v17 offset:4096
    ds_read_b128 v[76:79], v17 offset:4608
    ds_read_b128 v[80:83], v17 offset:8192
    ds_read_b128 v[84:87], v17 offset:8704
    s_waitcnt lgkmcnt(8)
    v_mfma_f32_16x16x32_bf16 a[0:3], v[32:35], v[56:59], a[0:3]
    v_mfma_f32_16x16x32_bf16 a[4:7], v[32:35], v[60:63], a[4:7]
    v_mfma_f32_16x16x32_bf16 a[8:11], v[36:39], v[56:59], a[8:11]
    v_mfma_f32_16x16x32_bf16 a[12:15], v[36:39], v[60:63], a[12:15]
    v_mfma_f32_16x16x32_bf16 a[16:19], v[40:43], v[56:59], a[16:19]
    v_mfma_f32_16x16x32_bf16 a[20:23], v[40:43], v[60:63], a[20:23]
    v_mfma_f32_16x16x32_bf16 a[24:27], v[44:47], v[56:59], a[24:27]
    v_mfma_f32_16x16x32_bf16 a[28:31], v[44:47], v[60:63], a[28:31]
    v_mfma_f32_16x16x32_bf16 a[32:35], v[48:51], v[56:59], a[32:35]
    v_mfma_f32_16x16x32_bf16 a[36:39], v[48:51], v[60:63], a[36:39]
    v_mfma_f32_16x16x32_bf16 a[40:43], v[52:55], v[56:59], a[40:43]
    v_mfma_f32_16x16x32_bf16 a[44:47], v[52:55], v[60:63], a[44:47]
    s_waitcnt lgkmcnt(0)
    s_barrier
    ds_read_b128 v[56:59], v18 offset:0
    ds_read_b128 v[60:63], v18 offset:2048
    ds_read_b128 v[32:35], v8 offset:0
    ds_read_b128 v[36:39], v8 offset:512
    ds_read_b128 v[40:43], v8 offset:4096
    ds_read_b128 v[44:47], v8 offset:4608
    ds_read_b128 v[48:51], v8 offset:8192
    ds_read_b128 v[52:55], v8 offset:8704
    v_mfma_f32_16x16x32_bf16 a[0:3], v[64:67], v[88:91], a[0:3]
    v_mfma_f32_16x16x32_bf16 a[4:7], v[64:67], v[92:95], a[4:7]
    v_mfma_f32_16x16x32_bf16 a[8:11], v[68:71], v[88:91], a[8:11]
    v_mfma_f32_16x16x32_bf16 a[12:15], v[68:71], v[92:95], a[12:15]
    v_mfma_f32_16x16x32_bf16 a[16:19], v[72:75], v[88:91], a[16:19]
    v_mfma_f32_16x16x32_bf16 a[20:23], v[72:75], v[92:95], a[20:23]
    v_mfma_f32_16x16x32_bf16 a[24:27], v[76:79], v[88:91], a[24:27]
    v_mfma_f32_16x16x32_bf16 a[28:31], v[76:79], v[92:95], a[28:31]
    v_mfma_f32_16x16x32_bf16 a[32:35], v[80:83], v[88:91], a[32:35]
    v_mfma_f32_16x16x32_bf16 a[36:39], v[80:83], v[92:95], a[36:39]
    v_mfma_f32_16x16x32_bf16 a[40:43], v[84:87], v[88:91], a[40:43]
    v_mfma_f32_16x16x32_bf16 a[44:47], v[84:87], v[92:95], a[44:47]
    ds_read_b128 v[88:91], v19 offset:0
    ds_read_b128 v[92:95], v19 offset:2048
    ds_read_b128 v[64:67], v9 offset:0
    ds_read_b128 v[68:71], v9 offset:512
    ds_read_b128 v[72:75], v9 offset:4096
    ds_read_b128 v[76:79], v9 offset:4608
    ds_read_b128 v[80:83], v9 offset:8192
    ds_read_b128 v[84:87], v9 offset:8704
    s_waitcnt lgkmcnt(8)
    v_mfma_f32_16x16x32_bf16 a[0:3], v[32:35], v[56:59], a[0:3]
    v_mfma_f32_16x16x32_bf16 a[4:7], v[32:35], v[60:63], a[4:7]
    v_mfma_f32_16x16x32_bf16 a[8:11], v[36:39], v[56:59], a[8:11]
    v_mfma_f32_16x16x32_bf16 a[12:15], v[36:39], v[60:63], a[12:15]
    v_mfma_f32_16x16x32_bf16 a[16:19], v[40:43], v[56:59], a[16:19]
    v_mfma_f32_16x16x32_bf16 a[20:23], v[40:43], v[60:63], a[20:23]
    v_mfma_f32_16x16x32_bf16 a[24:27], v[44:47], v[56:59], a[24:27]
    v_mfma_f32_16x16x32_bf16 a[28:31], v[44:47], v[60:63], a[28:31]
    v_mfma_f32_16x16x32_bf16 a[32:35], v[48:51], v[56:59], a[32:35]
    v_mfma_f32_16x16x32_bf16 a[36:39], v[48:51], v[60:63], a[36:39]
    v_mfma_f32_16x16x32_bf16 a[40:43], v[52:55], v[56:59], a[40:43]
    v_mfma_f32_16x16x32_bf16 a[44:47], v[52:55], v[60:63], a[44:47]
    s_waitcnt lgkmcnt(0)
    s_barrier
    ds_read_b128 v[56:59], v20 offset:0
    ds_read_b128 v[60:63], v20 offset:2048
    ds_read_b128 v[32:35], v10 offset:0
    ds_read_b128 v[36:39], v10 offset:512
    ds_read_b128 v[40:43], v10 offset:4096
    ds_read_b128 v[44:47], v10 offset:4608
    ds_read_b128 v[48:51], v10 offset:8192
    ds_read_b128 v[52:55], v10 offset:8704
    v_mfma_f32_16x16x32_bf16 a[0:3], v[64:67], v[88:91], a[0:3]
    v_mfma_f32_16x16x32_bf16 a[4:7], v[64:67], v[92:95], a[4:7]
    v_mfma_f32_16x16x32_bf16 a[8:11], v[68:71], v[88:91], a[8:11]
    v_mfma_f32_16x16x32_bf16 a[12:15], v[68:71], v[92:95], a[12:15]
    v_mfma_f32_16x16x32_bf16 a[16:19], v[72:75], v[88:91], a[16:19]
    v_mfma_f32_16x16x32_bf16 a[20:23], v[72:75], v[92:95], a[20:23]
    v_mfma_f32_16x16x32_bf16 a[24:27], v[76:79], v[88:91], a[24:27]
    v_mfma_f32_16x16x32_bf16 a[28:31], v[76:79], v[92:95], a[28:31]
    v_mfma_f32_16x16x32_bf16 a[32:35], v[80:83], v[88:91], a[32:35]
    v_mfma_f32_16x16x32_bf16 a[36:39], v[80:83], v[92:95], a[36:39]
    v_mfma_f32_16x16x32_bf16 a[40:43], v[84:87], v[88:91], a[40:43]
    v_mfma_f32_16x16x32_bf16 a[44:47], v[84:87], v[92:95], a[44:47]
    ds_read_b128 v[88:91], v21 offset:0
    ds_read_b128 v[92:95], v21 offset:2048
    ds_read_b128 v[64:67], v11 offset:0
    ds_read_b128 v[68:71], v11 offset:512
    ds_read_b128 v[72:75], v11 offset:4096
    ds_read_b128 v[76:79], v11 offset:4608
    ds_read_b128 v[80:83], v11 offset:8192
    ds_read_b128 v[84:87], v11 offset:8704
    s_waitcnt lgkmcnt(8)
    v_mfma_f32_16x16x32_bf16 a[0:3], v[32:35], v[56:59], a[0:3]
    v_mfma_f32_16x16x32_bf16 a[4:7], v[32:35], v[60:63], a[4:7]
    v_mfma_f32_16x16x32_bf16 a[8:11], v[36:39], v[56:59], a[8:11]
    v_mfma_f32_16x16x32_bf16 a[12:15], v[36:39], v[60:63], a[12:15]
    v_mfma_f32_16x16x32_bf16 a[16:19], v[40:43], v[56:59], a[16:19]
    v_mfma_f32_16x16x32_bf16 a[20:23], v[40:43], v[60:63], a[20:23]
    v_mfma_f32_16x16x32_bf16 a[24:27], v[44:47], v[56:59], a[24:27]
    v_mfma_f32_16x16x32_bf16 a[28:31], v[44:47], v[60:63], a[28:31]
    v_mfma_f32_16x16x32_bf16 a[32:35], v[48:51], v[56:59], a[32:35]
    v_mfma_f32_16x16x32_bf16 a[36:39], v[48:51], v[60:63], a[36:39]
    v_mfma_f32_16x16x32_bf16 a[40:43], v[52:55], v[56:59], a[40:43]
    v_mfma_f32_16x16x32_bf16 a[44:47], v[52:55], v[60:63], a[44:47]
    s_waitcnt lgkmcnt(0)
    s_barrier
    ds_read_b128 v[56:59], v22 offset:0
    ds_read_b128 v[60:63], v22 offset:2048
    ds_read_b128 v[32:35], v12 offset:0
    ds_read_b128 v[36:39], v12 offset:512
    ds_read_b128 v[40:43], v12 offset:4096
    ds_read_b128 v[44:47], v12 offset:4608
    ds_read_b128 v[48:51], v12 offset:8192
    ds_read_b128 v[52:55], v12 offset:8704
    v_mfma_f32_16x16x32_bf16 a[0:3], v[64:67], v[88:91], a[0:3]
    v_mfma_f32_16x16x32_bf16 a[4:7], v[64:67], v[92:95], a[4:7]
    v_mfma_f32_16x16x32_bf16 a[8:11], v[68:71], v[88:91], a[8:11]
    v_mfma_f32_16x16x32_bf16 a[12:15], v[68:71], v[92:95], a[12:15]
    v_mfma_f32_16x16x32_bf16 a[16:19], v[72:75], v[88:91], a[16:19]
    v_mfma_f32_16x16x32_bf16 a[20:23], v[72:75], v[92:95], a[20:23]
    v_mfma_f32_16x16x32_bf16 a[24:27], v[76:79], v[88:91], a[24:27]
    v_mfma_f32_16x16x32_bf16 a[28:31], v[76:79], v[92:95], a[28:31]
    v_mfma_f32_16x16x32_bf16 a[32:35], v[80:83], v[88:91], a[32:35]
    v_mfma_f32_16x16x32_bf16 a[36:39], v[80:83], v[92:95], a[36:39]
    v_mfma_f32_16x16x32_bf16 a[40:43], v[84:87], v[88:91], a[40:43]
    v_mfma_f32_16x16x32_bf16 a[44:47], v[84:87], v[92:95], a[44:47]
    ds_read_b128 v[88:91], v23 offset:0
    ds_read_b128 v[92:95], v23 offset:2048
    ds_read_b128 v[64:67], v13 offset:0
    ds_read_b128 v[68:71], v13 offset:512
    ds_read_b128 v[72:75], v13 offset:4096
    ds_read_b128 v[76:79], v13 offset:4608
    ds_read_b128 v[80:83], v13 offset:8192
    ds_read_b128 v[84:87], v13 offset:8704
    s_waitcnt lgkmcnt(8)
    v_mfma_f32_16x16x32_bf16 a[0:3], v[32:35], v[56:59], a[0:3]
    v_mfma_f32_16x16x32_bf16 a[4:7], v[32:35], v[60:63], a[4:7]
    v_mfma_f32_16x16x32_bf16 a[8:11], v[36:39], v[56:59], a[8:11]
    v_mfma_f32_16x16x32_bf16 a[12:15], v[36:39], v[60:63], a[12:15]
    v_mfma_f32_16x16x32_bf16 a[16:19], v[40:43], v[56:59], a[16:19]
    v_mfma_f32_16x16x32_bf16 a[20:23], v[40:43], v[60:63], a[20:23]
    v_mfma_f32_16x16x32_bf16 a[24:27], v[44:47], v[56:59], a[24:27]
    v_mfma_f32_16x16x32_bf16 a[28:31], v[44:47], v[60:63], a[28:31]
    v_mfma_f32_16x16x32_bf16 a[32:35], v[48:51], v[56:59], a[32:35]
    v_mfma_f32_16x16x32_bf16 a[36:39], v[48:51], v[60:63], a[36:39]
    v_mfma_f32_16x16x32_bf16 a[40:43], v[52:55], v[56:59], a[40:43]
    v_mfma_f32_16x16x32_bf16 a[44:47], v[52:55], v[60:63], a[44:47]
    s_waitcnt lgkmcnt(0)
    s_barrier
    ds_read_b128 v[56:59], v24 offset:0
    ds_read_b128 v[60:63], v24 offset:2048
    ds_read_b128 v[32:35], v14 offset:0
    ds_read_b128 v[36:39], v14 offset:512
    ds_read_b128 v[40:43], v14 offset:4096
    ds_read_b128 v[44:47], v14 offset:4608
    ds_read_b128 v[48:51], v14 offset:8192
    ds_read_b128 v[52:55], v14 offset:8704
    v_mfma_f32_16x16x32_bf16 a[0:3], v[64:67], v[88:91], a[0:3]
    v_mfma_f32_16x16x32_bf16 a[4:7], v[64:67], v[92:95], a[4:7]
    v_mfma_f32_16x16x32_bf16 a[8:11], v[68:71], v[88:91], a[8:11]
    v_mfma_f32_16x16x32_bf16 a[12:15], v[68:71], v[92:95], a[12:15]
    v_mfma_f32_16x16x32_bf16 a[16:19], v[72:75], v[88:91], a[16:19]
    v_mfma_f32_16x16x32_bf16 a[20:23], v[72:75], v[92:95], a[20:23]
    v_mfma_f32_16x16x32_bf16 a[24:27], v[76:79], v[88:91], a[24:27]
    v_mfma_f32_16x16x32_bf16 a[28:31], v[76:79], v[92:95], a[28:31]
    v_mfma_f32_16x16x32_bf16 a[32:35], v[80:83], v[88:91], a[32:35]
    v_mfma_f32_16x16x32_bf16 a[36:39], v[80:83], v[92:95], a[36:39]
    v_mfma_f32_16x16x32_bf16 a[40:43], v[84:87], v[88:91], a[40:43]
    v_mfma_f32_16x16x32_bf16 a[44:47], v[84:87], v[92:95], a[44:47]
    ds_read_b128 v[88:91], v25 offset:0
    ds_read_b128 v[92:95], v25 offset:2048
    ds_read_b128 v[64:67], v15 offset:0
    ds_read_b128 v[68:71], v15 offset:512
    ds_read_b128 v[72:75], v15 offset:4096
    ds_read_b128 v[76:79], v15 offset:4608
    ds_read_b128 v[80:83], v15 offset:8192
    ds_read_b128 v[84:87], v15 offset:8704
    s_waitcnt lgkmcnt(8)
    v_mfma_f32_16x16x32_bf16 a[0:3], v[32:35], v[56:59], a[0:3]
    v_mfma_f32_16x16x32_bf16 a[4:7], v[32:35], v[60:63], a[4:7]
    v_mfma_f32_16x16x32_bf16 a[8:11], v[36:39], v[56:59], a[8:11]
    v_mfma_f32_16x16x32_bf16 a[12:15], v[36:39], v[60:63], a[12:15]
    v_mfma_f32_16x16x32_bf16 a[16:19], v[40:43], v[56:59], a[16:19]
    v_mfma_f32_16x16x32_bf16 a[20:23], v[40:43], v[60:63], a[20:23]
    v_mfma_f32_16x16x32_bf16 a[24:27], v[44:47], v[56:59], a[24:27]
    v_mfma_f32_16x16x32_bf16 a[28:31], v[44:47], v[60:63], a[28:31]
    v_mfma_f32_16x16x32_bf16 a[32:35], v[48:51], v[56:59], a[32:35]
    v_mfma_f32_16x16x32_bf16 a[36:39], v[48:51], v[60:63], a[36:39]
    v_mfma_f32_16x16x32_bf16 a[40:43], v[52:55], v[56:59], a[40:43]
    v_mfma_f32_16x16x32_bf16 a[44:47], v[52:55], v[60:63], a[44:47]
    s_waitcnt lgkmcnt(0)
    s_barrier
    ds_read_b128 v[56:59], v26 offset:0
    ds_read_b128 v[60:63], v26 offset:2048
    ds_read_b128 v[32:35], v16 offset:0
    ds_read_b128 v[36:39], v16 offset:512
    ds_read_b128 v[40:43], v16 offset:4096
    ds_read_b128 v[44:47], v16 offset:4608
    ds_read_b128 v[48:51], v16 offset:8192
    ds_read_b128 v[52:55], v16 offset:8704
    v_mfma_f32_16x16x32_bf16 a[0:3], v[64:67], v[88:91], a[0:3]
    v_mfma_f32_16x16x32_bf16 a[4:7], v[64:67], v[92:95], a[4:7]
    v_mfma_f32_16x16x32_bf16 a[8:11], v[68:71], v[88:91], a[8:11]
    v_mfma_f32_16x16x32_bf16 a[12:15], v[68:71], v[92:95], a[12:15]
    v_mfma_f32_16x16x32_bf16 a[16:19], v[72:75], v[88:91], a[16:19]
    v_mfma_f32_16x16x32_bf16 a[20:23], v[72:75], v[92:95], a[20:23]
    v_mfma_f32_16x16x32_bf16 a[24:27], v[76:79], v[88:91], a[24:27]
    v_mfma_f32_16x16x32_bf16 a[28:31], v[76:79], v[92:95], a[28:31]
    v_mfma_f32_16x16x32_bf16 a[32:35], v[80:83], v[88:91], a[32:35]
    v_mfma_f32_16x16x32_bf16 a[36:39], v[80:83], v[92:95], a[36:39]
    v_mfma_f32_16x16x32_bf16 a[40:43], v[84:87], v[88:91], a[40:43]
    v_mfma_f32_16x16x32_bf16 a[44:47], v[84:87], v[92:95], a[44:47]
    ds_read_b128 v[88:91], v27 offset:0
    ds_read_b128 v[92:95], v27 offset:2048
    ds_read_b128 v[64:67], v17 offset:0
    ds_read_b128 v[68:71], v17 offset:512
    ds_read_b128 v[72:75], v17 offset:4096
    ds_read_b128 v[76:79], v17 offset:4608
    ds_read_b128 v[80:83], v17 offset:8192
    ds_read_b128 v[84:87], v17 offset:8704
    s_waitcnt lgkmcnt(8)
    v_mfma_f32_16x16x32_bf16 a[0:3], v[32:35], v[56:59], a[0:3]
    v_mfma_f32_16x16x32_bf16 a[4:7], v[32:35], v[60:63], a[4:7]
    v_mfma_f32_16x16x32_bf16 a[8:11], v[36:39], v[56:59], a[8:11]
    v_mfma_f32_16x16x32_bf16 a[12:15], v[36:39], v[60:63], a[12:15]
    v_mfma_f32_16x16x32_bf16 a[16:19], v[40:43], v[56:59], a[16:19]
    v_mfma_f32_16x16x32_bf16 a[20:23], v[40:43], v[60:63], a[20:23]
    v_mfma_f32_16x16x32_bf16 a[24:27], v[44:47], v[56:59], a[24:27]
    v_mfma_f32_16x16x32_bf16 a[28:31], v[44:47], v[60:63], a[28:31]
    v_mfma_f32_16x16x32_bf16 a[32:35], v[48:51], v[56:59], a[32:35]
    v_mfma_f32_16x16x32_bf16 a[36:39], v[48:51], v[60:63], a[36:39]
    v_mfma_f32_16x16x32_bf16 a[40:43], v[52:55], v[56:59], a[40:43]
    v_mfma_f32_16x16x32_bf16 a[44:47], v[52:55], v[60:63], a[44:47]
    s_waitcnt lgkmcnt(0)
    v_mfma_f32_16x16x32_bf16 a[0:3], v[64:67], v[88:91], a[0:3]
    v_mfma_f32_16x16x32_bf16 a[4:7], v[64:67], v[92:95], a[4:7]
    v_mfma_f32_16x16x32_bf16 a[8:11], v[68:71], v[88:91], a[8:11]
    v_mfma_f32_16x16x32_bf16 a[12:15], v[68:71], v[92:95], a[12:15]
    v_mfma_f32_16x16x32_bf16 a[16:19], v[72:75], v[88:91], a[16:19]
    v_mfma_f32_16x16x32_bf16 a[20:23], v[72:75], v[92:95], a[20:23]
    v_mfma_f32_16x16x32_bf16 a[24:27], v[76:79], v[88:91], a[24:27]
    v_mfma_f32_16x16x32_bf16 a[28:31], v[76:79], v[92:95], a[28:31]
    v_mfma_f32_16x16x32_bf16 a[32:35], v[80:83], v[88:91], a[32:35]
    v_mfma_f32_16x16x32_bf16 a[36:39], v[80:83], v[92:95], a[36:39]
    v_mfma_f32_16x16x32_bf16 a[40:43], v[84:87], v[88:91], a[40:43]
    v_mfma_f32_16x16x32_bf16 a[44:47], v[84:87], v[92:95], a[44:47]
    s_nop 7
    s_nop 7
    v_accvgpr_read_b32 v96, a0
    v_accvgpr_read_b32 v97, a1
    v_accvgpr_read_b32 v98, a2
    v_accvgpr_read_b32 v99, a3
    v_accvgpr_read_b32 v100, a4
    v_accvgpr_read_b32 v101, a5
    v_accvgpr_read_b32 v102, a6
    v_accvgpr_read_b32 v103, a7
    v_accvgpr_read_b32 v104, a8
    v_accvgpr_read_b32 v105, a9
    v_accvgpr_read_b32 v106, a10
    v_accvgpr_read_b32 v107, a11
    v_accvgpr_read_b32 v108, a12
    v_accvgpr_read_b32 v109, a13
    v_accvgpr_read_b32 v110, a14
    v_accvgpr_read_b32 v111, a15
    v_accvgpr_read_b32 v112, a16
    v_accvgpr_read_b32 v113, a17
    v_accvgpr_read_b32 v114, a18
    v_accvgpr_read_b32 v115, a19
    v_accvgpr_read_b32 v116, a20
    v_accvgpr_read_b32 v117, a21
    v_accvgpr_read_b32 v118, a22
    v_accvgpr_read_b32 v119, a23
    v_accvgpr_read_b32 v120, a24
    v_accvgpr_read_b32 v121, a25
    v_accvgpr_read_b32 v122, a26
    v_accvgpr_read_b32 v123, a27
    v_accvgpr_read_b32 v124, a28
    v_accvgpr_read_b32 v125, a29
    v_accvgpr_read_b32 v126, a30
    v_accvgpr_read_b32 v127, a31
    v_accvgpr_read_b32 v128, a32
    v_accvgpr_read_b32 v129, a33
    v_accvgpr_read_b32 v130, a34
    v_accvgpr_read_b32 v131, a35
    v_accvgpr_read_b32 v132, a36
    v_accvgpr_read_b32 v133, a37
    v_accvgpr_read_b32 v134, a38
    v_accvgpr_read_b32 v135, a39
    v_accvgpr_read_b32 v136, a40
    v_accvgpr_read_b32 v137, a41
    v_accvgpr_read_b32 v138, a42
    v_accvgpr_read_b32 v139, a43
    v_accvgpr_read_b32 v140, a44
    v_accvgpr_read_b32 v141, a45
    v_accvgpr_read_b32 v142, a46
    v_accvgpr_read_b32 v143, a47
    s_waitcnt vmcnt(0)
    s_lshl_b32 s46, s42, 5
    v_add_u32 v4, s46, v2
    s_movk_i32 s46, 3072
    v_mul_lo_u32 v4, v4, s46
    v_lshl_add_u32 v5, v3, 3, v4
    v_lshl_add_u32 v4, v3, 4, v4
    s_mov_b32 s47, 49152
    v_max_f32 v96, 0, v96
    v_max_f32 v97, 0, v97
    v_cvt_pk_bf16_f32 v32, v96, v97
    v_max_f32 v98, 0, v98
    v_max_f32 v99, 0, v99
    v_cvt_pk_bf16_f32 v33, v98, v99
    v_max_f32 v104, 0, v104
    v_max_f32 v105, 0, v105
    v_cvt_pk_bf16_f32 v34, v104, v105
    v_max_f32 v106, 0, v106
    v_max_f32 v107, 0, v107
    v_cvt_pk_bf16_f32 v35, v106, v107
    buffer_store_dwordx4 v[32:35], v4, s[16:19], 0 offen offset:0
    v_max_f32 v112, 0, v112
    v_max_f32 v113, 0, v113
    v_cvt_pk_bf16_f32 v36, v112, v113
    v_max_f32 v114, 0, v114
    v_max_f32 v115, 0, v115
    v_cvt_pk_bf16_f32 v37, v114, v115
    v_max_f32 v120, 0, v120
    v_max_f32 v121, 0, v121
    v_cvt_pk_bf16_f32 v38, v120, v121
    v_max_f32 v122, 0, v122
    v_max_f32 v123, 0, v123
    v_cvt_pk_bf16_f32 v39, v122, v123
    buffer_store_dwordx4 v[36:39], v4, s[16:19], 0 offen offset:64
    v_max_f32 v128, 0, v128
    v_max_f32 v129, 0, v129
    v_cvt_pk_bf16_f32 v40, v128, v129
    v_max_f32 v130, 0, v130
    v_max_f32 v131, 0, v131
    v_cvt_pk_bf16_f32 v41, v130, v131
    v_max_f32 v136, 0, v136
    v_max_f32 v137, 0, v137
    v_cvt_pk_bf16_f32 v42, v136, v137
    v_max_f32 v138, 0, v138
    v_max_f32 v139, 0, v139
    v_cvt_pk_bf16_f32 v43, v138, v139
    buffer_store_dwordx4 v[40:43], v4, s[16:19], 0 offen offset:128
    v_max_f32 v100, 0, v100
    v_max_f32 v101, 0, v101
    v_cvt_pk_bf16_f32 v44, v100, v101
    v_max_f32 v102, 0, v102
    v_max_f32 v103, 0, v103
    v_cvt_pk_bf16_f32 v45, v102, v103
    v_max_f32 v108, 0, v108
    v_max_f32 v109, 0, v109
    v_cvt_pk_bf16_f32 v46, v108, v109
    v_max_f32 v110, 0, v110
    v_max_f32 v111, 0, v111
    v_cvt_pk_bf16_f32 v47, v110, v111
    buffer_store_dwordx4 v[44:47], v4, s[16:19], s47 offen offset:0
    v_max_f32 v116, 0, v116
    v_max_f32 v117, 0, v117
    v_cvt_pk_bf16_f32 v32, v116, v117
    v_max_f32 v118, 0, v118
    v_max_f32 v119, 0, v119
    v_cvt_pk_bf16_f32 v33, v118, v119
    v_max_f32 v124, 0, v124
    v_max_f32 v125, 0, v125
    v_cvt_pk_bf16_f32 v34, v124, v125
    v_max_f32 v126, 0, v126
    v_max_f32 v127, 0, v127
    v_cvt_pk_bf16_f32 v35, v126, v127
    buffer_store_dwordx4 v[32:35], v4, s[16:19], s47 offen offset:64
    v_max_f32 v132, 0, v132
    v_max_f32 v133, 0, v133
    v_cvt_pk_bf16_f32 v36, v132, v133
    v_max_f32 v134, 0, v134
    v_max_f32 v135, 0, v135
    v_cvt_pk_bf16_f32 v37, v134, v135
    v_max_f32 v140, 0, v140
    v_max_f32 v141, 0, v141
    v_cvt_pk_bf16_f32 v38, v140, v141
    v_max_f32 v142, 0, v142
    v_max_f32 v143, 0, v143
    v_cvt_pk_bf16_f32 v39, v142, v143
    buffer_store_dwordx4 v[36:39], v4, s[16:19], s47 offen offset:128
gemmc_kernel_end:
    s_endpgm
.globl gemmd_kernel
.p2align 8
.type gemmd_kernel,@function
gemmd_kernel:
    s_cmp_ge_u32 s2, 256
    s_cbranch_scc1 gemmd_kernel_end
    v_lshrrev_b32 v1, 6, v0
    s_nop 0
    v_readfirstlane_b32 s40, v1
    v_and_b32 v1, 63, v0
    v_and_b32 v2, 15, v1
    v_lshrrev_b32 v3, 4, v1
    s_load_dwordx2 s[48:49], s[0:1], 96
    s_load_dwordx2 s[50:51], s[0:1], 80
    s_waitcnt lgkmcnt(0)
    s_and_b32 s3, s2, 7
    s_lshr_b32 s4, s2, 3
    s_lshr_b32 s5, s4, 2
    s_lshl_b32 s6, s3, 2
    s_and_b32 s7, s4, 3
    s_add_u32 s6, s6, s7
    s_add_u32 s8, s48, 2097152
    s_addc_u32 s9, s49, 0
    s_mov_b32 s10, 245760
    s_mov_b32 s11, 0x00020000
    s_mul_i32 s20, s5, 245760
    s_add_u32 s8, s8, s20
    s_addc_u32 s9, s9, 0
    s_add_u32 s12, s48, 22413312
    s_addc_u32 s13, s49, 0
    s_mov_b32 s14, 196608
    s_mov_b32 s15, 0x00020000
    s_mul_i32 s20, s6, 196608
    s_add_u32 s12, s12, s20
    s_addc_u32 s13, s13, 0
    s_mul_i32 s28, s6, 81920
    s_mul_i32 s29, s5, 160
    s_add_u32 s30, s28, s29
    s_mov_b32 s16, s50
    s_mov_b32 s17, s51
    s_mov_b32 s18, 81920
    s_mov_b32 s19, 0x00020000
    s_add_u32 s16, s16, s30
    s_addc_u32 s17, s17, 0
    s_add_u32 s20, s48, 17170432
    s_addc_u32 s21, s49, 0
    s_mov_b32 s22, 81920
    s_mov_b32 s23, 0x00020000
    s_add_u32 s20, s20, s30
    s_addc_u32 s21, s21, 0
    s_add_u32 s24, s48, 6400
    s_addc_u32 s25, s49, 0
    s_mov_b32 s26, 160
    s_mov_b32 s27, 0x00020000
    s_add_u32 s24, s24, s29
    s_addc_u32 s25, s25, 0
    s_cmp_lt_u32 s40, 4
    s_cbranch_scc1 gemmd_kernel_comp
    s_sub_u32 s40, s40, 4
    v_lshrrev_b32 v4, 3, v1
    v_and_b32 v5, 7, v1
    v_and_b32 v6, 1, v3
    v_xor_b32 v6, v6, v5
    v_xor_b32 v7, v3, v5
    s_movk_i32 s46, 3072
    v_mul_lo_u32 v20, v4, s46
    s_movk_i32 s46, 3072
    v_mul_lo_u32 v21, v4, s46
    s_mul_i32 s44, s40, 2
    s_mul_i32 s45, s40, 24576
    s_mul_i32 s64, s40, 1024
    v_xor_b32 v22, s44, v6
    v_lshl_add_u32 v22, v22, 4, v20
    v_add_u32 v8, s45, v22
    s_add_u32 m0, s64, 0
    s_movk_i32 s46, 0
    buffer_load_dwordx4 v8, s[8:11], s46 offen lds
    s_mul_i32 s44, s40, 2
    s_mul_i32 s45, s40, 24576
    s_add_u32 s45, s45, 98304
    s_mul_i32 s65, s40, 1024
    s_add_u32 s65, s65, 4096
    v_xor_b32 v22, s44, v6
    v_lshl_add_u32 v22, v22, 4, v20
    v_add_u32 v9, s45, v22
    s_add_u32 m0, s65, 0
    s_movk_i32 s46, 0
    buffer_load_dwordx4 v9, s[8:11], s46 offen lds
    s_mov_b32 s44, 0
    s_cmp_eq_u32 s40, 1
    s_cselect_b32 s44, 4, s44
    s_cmp_eq_u32 s40, 2
    s_cselect_b32 s44, 0, s44
    s_cmp_eq_u32 s40, 3
    s_cselect_b32 s44, 2, s44
    s_mov_b32 s45, 196608
    s_cmp_eq_u32 s40, 1
    s_cselect_b32 s45, 221184, s45
    s_cmp_eq_u32 s40, 2
    s_cselect_b32 s45, 128, s45
    s_cmp_eq_u32 s40, 3
    s_cselect_b32 s45, 24704, s45
    s_mul_i32 s66, s40, 1024
    s_add_u32 s66, s66, 8192
    s_mov_b32 s47, 0
    s_cmp_eq_u32 s40, 1
    s_cselect_b32 s47, 0, s47
    s_cmp_eq_u32 s40, 2
    s_cselect_b32 s47, 1, s47
    s_cmp_eq_u32 s40, 3
    s_cselect_b32 s47, 1, s47
    s_cmp_eq_u32 s47, 1
    s_cselect_b64 vcc, -1, 0
    v_cndmask_b32 v22, v7, v6, vcc
    v_xor_b32 v22, s44, v22
    v_lshl_add_u32 v22, v22, 4, v20
    v_add_u32 v10, s45, v22
    s_add_u32 m0, s66, 0
    s_movk_i32 s46, 0
    buffer_load_dwordx4 v10, s[8:11], s46 offen lds
    s_mov_b32 s44, 4
    s_cmp_eq_u32 s40, 1
    s_cselect_b32 s44, 6, s44
    s_cmp_eq_u32 s40, 2
    s_cselect_b32 s44, 0, s44
    s_cmp_eq_u32 s40, 3
    s_cselect_b32 s44, 2, s44
    s_mul_i32 s45, s40, 24576
    s_add_u32 s45, s45, 49280
    s_mul_i32 s67, s40, 1024
    s_add_u32 s67, s67, 12288
    v_xor_b32 v22, s44, v6
    v_lshl_add_u32 v22, v22, 4, v20
    v_add_u32 v11, s45, v22
    s_add_u32 m0, s67, 0
    s_movk_i32 s46, 0
    buffer_load_dwordx4 v11, s[8:11], s46 offen lds
    s_mov_b32 s44, 4
    s_cmp_eq_u32 s40, 1
    s_cselect_b32 s44, 6, s44
    s_cmp_eq_u32 s40, 2
    s_cselect_b32 s44, 0, s44
    s_cmp_eq_u32 s40, 3
    s_cselect_b32 s44, 4, s44
    s_mul_i32 s45, s40, 24576
    s_add_u32 s45, s45, 147584
    s_mul_i32 s68, s40, 1024
    s_add_u32 s68, s68, 16384
    s_mov_b32 s47, 1
    s_cmp_eq_u32 s40, 1
    s_cselect_b32 s47, 1, s47
    s_cmp_eq_u32 s40, 2
    s_cselect_b32 s47, 0, s47
    s_cmp_eq_u32 s40, 3
    s_cselect_b32 s47, 0, s47
    s_cmp_eq_u32 s47, 1
    s_cselect_b64 vcc, -1, 0
    v_cndmask_b32 v22, v7, v6, vcc
    v_xor_b32 v22, s44, v22
    v_lshl_add_u32 v22, v22, 4, v20
    v_add_u32 v12, s45, v22
    s_add_u32 m0, s68, 0
    s_movk_i32 s46, 0
    buffer_load_dwordx4 v12, s[8:11], s46 offen lds
    s_mov_b32 s44, 0
    s_cmp_eq_u32 s40, 1
    s_cselect_b32 s44, 4, s44
    s_cmp_eq_u32 s40, 2
    s_cselect_b32 s44, 0, s44
    s_cmp_eq_u32 s40, 3
    s_cselect_b32 s44, 4, s44
    s_mul_i32 s45, s40, 24576
    s_mul_i32 s69, s40, 1024
    s_add_u32 s69, s69, 20480
    v_xor_b32 v22, s44, v7
    v_lshl_add_u32 v22, v22, 4, v21
    v_add_u32 v13, s45, v22
    s_add_u32 m0, s69, 0
    s_movk_i32 s46, 0
    buffer_load_dwordx4 v13, s[12:15], s46 offen lds
    s_mov_b32 s44, 0
    s_cmp_eq_u32 s40, 1
    s_cselect_b32 s44, 4, s44
    s_cmp_eq_u32 s40, 2
    s_cselect_b32 s44, 0, s44
    s_cmp_eq_u32 s40, 3
    s_cselect_b32 s44, 4, s44
    s_mul_i32 s45, s40, 24576
    s_add_u32 s45, s45, 98304
    s_mul_i32 s70, s40, 1024
    s_add_u32 s70, s70, 24576
    v_xor_b32 v22, s44, v7
    v_lshl_add_u32 v22, v22, 4, v21
    v_add_u32 v14, s45, v22
    s_add_u32 m0, s70, 0
    s_movk_i32 s46, 0
    buffer_load_dwordx4 v14, s[12:15], s46 offen lds
    s_mov_b32 s44, 0
    s_cmp_eq_u32 s40, 1
    s_cselect_b32 s44, 4, s44
    s_cmp_eq_u32 s40, 2
    s_cselect_b32 s44, 0, s44
    s_cmp_eq_u32 s40, 3
    s_cselect_b32 s44, 4, s44
    s_mul_i32 s45, s40, 24576
    s_add_u32 s45, s45, 128
    s_mul_i32 s71, s40, 1024
    s_add_u32 s71, s71, 28672
    v_xor_b32 v22, s44, v7
    v_lshl_add_u32 v22, v22, 4, v21
    v_add_u32 v15, s45, v22
    s_add_u32 m0, s71, 0
    s_movk_i32 s46, 0
    buffer_load_dwordx4 v15, s[12:15], s46 offen lds
    s_mov_b32 s44, 0
    s_cmp_eq_u32 s40, 1
    s_cselect_b32 s44, 4, s44
    s_cmp_eq_u32 s40, 2
    s_cselect_b32 s44, 0, s44
    s_cmp_eq_u32 s40, 3
    s_cselect_b32 s44, 4, s44
    s_mul_i32 s45, s40, 24576
    s_add_u32 s45, s45, 98432
    s_mul_i32 s72, s40, 1024
    s_add_u32 s72, s72, 32768
    v_xor_b32 v22, s44, v7
    v_lshl_add_u32 v22, v22, 4, v21
    v_add_u32 v16, s45, v22
    s_add_u32 m0, s72, 0
    s_movk_i32 s46, 0
    buffer_load_dwordx4 v16, s[12:15], s46 offen lds
    s_add_u32 m0, s64, 36864
    s_movk_i32 s46, 256
    buffer_load_dwordx4 v8, s[8:11], s46 offen lds
    s_add_u32 m0, s65, 36864
    s_movk_i32 s46, 256
    buffer_load_dwordx4 v9, s[8:11], s46 offen lds
    s_add_u32 m0, s66, 36864
    s_movk_i32 s46, 256
    buffer_load_dwordx4 v10, s[8:11], s46 offen lds
    s_add_u32 m0, s67, 36864
    s_movk_i32 s46, 256
    buffer_load_dwordx4 v11, s[8:11], s46 offen lds
    s_add_u32 m0, s68, 36864
    s_movk_i32 s46, 256
    buffer_load_dwordx4 v12, s[8:11], s46 offen lds
    s_add_u32 m0, s69, 36864
    s_movk_i32 s46, 256
    buffer_load_dwordx4 v13, s[12:15], s46 offen lds
    s_add_u32 m0, s70, 36864
    s_movk_i32 s46, 256
    buffer_load_dwordx4 v14, s[12:15], s46 offen lds
    s_add_u32 m0, s71, 36864
    s_movk_i32 s46, 256
    buffer_load_dwordx4 v15, s[12:15], s46 offen lds
    s_add_u32 m0, s72, 36864
    s_movk_i32 s46, 256
    buffer_load_dwordx4 v16, s[12:15], s46 offen lds
    s_waitcnt vmcnt(9)
    s_barrier
    s_add_u32 m0, s64, 73728
    s_movk_i32 s46, 512
    buffer_load_dwordx4 v8, s[8:11], s46 offen lds
    s_add_u32 m0, s65, 73728
    s_movk_i32 s46, 512
    buffer_load_dwordx4 v9, s[8:11], s46 offen lds
    s_add_u32 m0, s66, 73728
    s_movk_i32 s46, 512
    buffer_load_dwordx4 v10, s[8:11], s46 offen lds
    s_add_u32 m0, s67, 73728
    s_movk_i32 s46, 512
    buffer_load_dwordx4 v11, s[8:11], s46 offen lds
    s_add_u32 m0, s68, 73728
    s_movk_i32 s46, 512
    buffer_load_dwordx4 v12, s[8:11], s46 offen lds
    s_add_u32 m0, s69, 73728
    s_movk_i32 s46, 512
    buffer_load_dwordx4 v13, s[12:15], s46 offen lds
    s_add_u32 m0, s70, 73728
    s_movk_i32 s46, 512
    buffer_load_dwordx4 v14, s[12:15], s46 offen lds
    s_add_u32 m0, s71, 73728
    s_movk_i32 s46, 512
    buffer_load_dwordx4 v15, s[12:15], s46 offen lds
    s_add_u32 m0, s72, 73728
    s_movk_i32 s46, 512
    buffer_load_dwordx4 v16, s[12:15], s46 offen lds
    s_add_u32 m0, s64, 110592
    s_movk_i32 s46, 768
    buffer_load_dwordx4 v8, s[8:11], s46 offen lds
    s_add_u32 m0, s65, 110592
    s_movk_i32 s46, 768
    buffer_load_dwordx4 v9, s[8:11], s46 offen lds
    s_add_u32 m0, s66, 110592
    s_movk_i32 s46, 768
    buffer_load_dwordx4 v10, s[8:11], s46 offen lds
    s_add_u32 m0, s67, 110592
    s_movk_i32 s46, 768
    buffer_load_dwordx4 v11, s[8:11], s46 offen lds
    s_add_u32 m0, s68, 110592
    s_movk_i32 s46, 768
    buffer_load_dwordx4 v12, s[8:11], s46 offen lds
    s_add_u32 m0, s69, 110592
    s_movk_i32 s46, 768
    buffer_load_dwordx4 v13, s[12:15], s46 offen lds
    s_add_u32 m0, s70, 110592
    s_movk_i32 s46, 768
    buffer_load_dwordx4 v14, s[12:15], s46 offen lds
    s_add_u32 m0, s71, 110592
    s_movk_i32 s46, 768
    buffer_load_dwordx4 v15, s[12:15], s46 offen lds
    s_add_u32 m0, s72, 110592
    s_movk_i32 s46, 768
    buffer_load_dwordx4 v16, s[12:15], s46 offen lds
    s_waitcnt vmcnt(18)
    s_barrier
    s_add_u32 m0, s64, 0
    s_movk_i32 s46, 1024
    buffer_load_dwordx4 v8, s[8:11], s46 offen lds
    s_add_u32 m0, s65, 0
    s_movk_i32 s46, 1024
    buffer_load_dwordx4 v9, s[8:11], s46 offen lds
    s_add_u32 m0, s66, 0
    s_movk_i32 s46, 1024
    buffer_load_dwordx4 v10, s[8:11], s46 offen lds
    s_add_u32 m0, s67, 0
    s_movk_i32 s46, 1024
    buffer_load_dwordx4 v11, s[8:11], s46 offen lds
    s_add_u32 m0, s68, 0
    s_movk_i32 s46, 1024
    buffer_load_dwordx4 v12, s[8:11], s46 offen lds
    s_add_u32 m0, s69, 0
    s_movk_i32 s46, 1024
    buffer_load_dwordx4 v13, s[12:15], s46 offen lds
    s_add_u32 m0, s70, 0
    s_movk_i32 s46, 1024
    buffer_load_dwordx4 v14, s[12:15], s46 offen lds
    s_add_u32 m0, s71, 0
    s_movk_i32 s46, 1024
    buffer_load_dwordx4 v15, s[12:15], s46 offen lds
    s_add_u32 m0, s72, 0
    s_movk_i32 s46, 1024
    buffer_load_dwordx4 v16, s[12:15], s46 offen lds
    s_waitcnt vmcnt(18)
    s_barrier
    s_add_u32 m0, s64, 36864
    s_movk_i32 s46, 1280
    buffer_load_dwordx4 v8, s[8:11], s46 offen lds
    s_add_u32 m0, s65, 36864
    s_movk_i32 s46, 1280
    buffer_load_dwordx4 v9, s[8:11], s46 offen lds
    s_add_u32 m0, s66, 36864
    s_movk_i32 s46, 1280
    buffer_load_dwordx4 v10, s[8:11], s46 offen lds
    s_add_u32 m0, s67, 36864
    s_movk_i32 s46, 1280
    buffer_load_dwordx4 v11, s[8:11], s46 offen lds
    s_add_u32 m0, s68, 36864
    s_movk_i32 s46, 1280
    buffer_load_dwordx4 v12, s[8:11], s46 offen lds
    s_add_u32 m0, s69, 36864
    s_movk_i32 s46, 1280
    buffer_load_dwordx4 v13, s[12:15], s46 offen lds
    s_add_u32 m0, s70, 36864
    s_movk_i32 s46, 1280
    buffer_load_dwordx4 v14, s[12:15], s46 offen lds
    s_add_u32 m0, s71, 36864
    s_movk_i32 s46, 1280
    buffer_load_dwordx4 v15, s[12:15], s46 offen lds
    s_add_u32 m0, s72, 36864
    s_movk_i32 s46, 1280
    buffer_load_dwordx4 v16, s[12:15], s46 offen lds
    s_waitcnt vmcnt(18)
    s_barrier
    s_add_u32 m0, s64, 73728
    s_movk_i32 s46, 1536
    buffer_load_dwordx4 v8, s[8:11], s46 offen lds
    s_add_u32 m0, s65, 73728
    s_movk_i32 s46, 1536
    buffer_load_dwordx4 v9, s[8:11], s46 offen lds
    s_add_u32 m0, s66, 73728
    s_movk_i32 s46, 1536
    buffer_load_dwordx4 v10, s[8:11], s46 offen lds
    s_add_u32 m0, s67, 73728
    s_movk_i32 s46, 1536
    buffer_load_dwordx4 v11, s[8:11], s46 offen lds
    s_add_u32 m0, s68, 73728
    s_movk_i32 s46, 1536
    buffer_load_dwordx4 v12, s[8:11], s46 offen lds
    s_add_u32 m0, s69, 73728
    s_movk_i32 s46, 1536
    buffer_load_dwordx4 v13, s[12:15], s46 offen lds
    s_add_u32 m0, s70, 73728
    s_movk_i32 s46, 1536
    buffer_load_dwordx4 v14, s[12:15], s46 offen lds
    s_add_u32 m0, s71, 73728
    s_movk_i32 s46, 1536
    buffer_load_dwordx4 v15, s[12:15], s46 offen lds
    s_add_u32 m0, s72, 73728
    s_movk_i32 s46, 1536
    buffer_load_dwordx4 v16, s[12:15], s46 offen lds
    s_waitcnt vmcnt(18)
    s_barrier
    s_add_u32 m0, s64, 110592
    s_movk_i32 s46, 1792
    buffer_load_dwordx4 v8, s[8:11], s46 offen lds
    s_add_u32 m0, s65, 110592
    s_movk_i32 s46, 1792
    buffer_load_dwordx4 v9, s[8:11], s46 offen lds
    s_add_u32 m0, s66, 110592
    s_movk_i32 s46, 1792
    buffer_load_dwordx4 v10, s[8:11], s46 offen lds
    s_add_u32 m0, s67, 110592
    s_movk_i32 s46, 1792
    buffer_load_dwordx4 v11, s[8:11], s46 offen lds
    s_add_u32 m0, s68, 110592
    s_movk_i32 s46, 1792
    buffer_load_dwordx4 v12, s[8:11], s46 offen lds
    s_add_u32 m0, s69, 110592
    s_movk_i32 s46, 1792
    buffer_load_dwordx4 v13, s[12:15], s46 offen lds
    s_add_u32 m0, s70, 110592
    s_movk_i32 s46, 1792
    buffer_load_dwordx4 v14, s[12:15], s46 offen lds
    s_add_u32 m0, s71, 110592
    s_movk_i32 s46, 1792
    buffer_load_dwordx4 v15, s[12:15], s46 offen lds
    s_add_u32 m0, s72, 110592
    s_movk_i32 s46, 1792
    buffer_load_dwordx4 v16, s[12:15], s46 offen lds
    s_waitcnt vmcnt(18)
    s_barrier
    s_add_u32 m0, s64, 0
    s_movk_i32 s46, 2048
    buffer_load_dwordx4 v8, s[8:11], s46 offen lds
    s_add_u32 m0, s65, 0
    s_movk_i32 s46, 2048
    buffer_load_dwordx4 v9, s[8:11], s46 offen lds
    s_add_u32 m0, s66, 0
    s_movk_i32 s46, 2048
    buffer_load_dwordx4 v10, s[8:11], s46 offen lds
    s_add_u32 m0, s67, 0
    s_movk_i32 s46, 2048
    buffer_load_dwordx4 v11, s[8:11], s46 offen lds
    s_add_u32 m0, s68, 0
    s_movk_i32 s46, 2048
    buffer_load_dwordx4 v12, s[8:11], s46 offen lds
    s_add_u32 m0, s69, 0
    s_movk_i32 s46, 2048
    buffer_load_dwordx4 v13, s[12:15], s46 offen lds
    s_add_u32 m0, s70, 0
    s_movk_i32 s46, 2048
    buffer_load_dwordx4 v14, s[12:15], s46 offen lds
    s_add_u32 m0, s71, 0
    s_movk_i32 s46, 2048
    buffer_load_dwordx4 v15, s[12:15], s46 offen lds
    s_add_u32 m0, s72, 0
    s_movk_i32 s46, 2048
    buffer_load_dwordx4 v16, s[12:15], s46 offen lds
    s_waitcnt vmcnt(18)
    s_barrier
    s_add_u32 m0, s64, 36864
    s_movk_i32 s46, 2304
    buffer_load_dwordx4 v8, s[8:11], s46 offen lds
    s_add_u32 m0, s65, 36864
    s_movk_i32 s46, 2304
    buffer_load_dwordx4 v9, s[8:11], s46 offen lds
    s_add_u32 m0, s66, 36864
    s_movk_i32 s46, 2304
    buffer_load_dwordx4 v10, s[8:11], s46 offen lds
    s_add_u32 m0, s67, 36864
    s_movk_i32 s46, 2304
    buffer_load_dwordx4 v11, s[8:11], s46 offen lds
    s_add_u32 m0, s68, 36864
    s_movk_i32 s46, 2304
    buffer_load_dwordx4 v12, s[8:11], s46 offen lds
    s_add_u32 m0, s69, 36864
    s_movk_i32 s46, 2304
    buffer_load_dwordx4 v13, s[12:15], s46 offen lds
    s_add_u32 m0, s70, 36864
    s_movk_i32 s46, 2304
    buffer_load_dwordx4 v14, s[12:15], s46 offen lds
    s_add_u32 m0, s71, 36864
    s_movk_i32 s46, 2304
    buffer_load_dwordx4 v15, s[12:15], s46 offen lds
    s_add_u32 m0, s72, 36864
    s_movk_i32 s46, 2304
    buffer_load_dwordx4 v16, s[12:15], s46 offen lds
    s_waitcnt vmcnt(18)
    s_barrier
    s_add_u32 m0, s64, 73728
    s_movk_i32 s46, 2560
    buffer_load_dwordx4 v8, s[8:11], s46 offen lds
    s_add_u32 m0, s65, 73728
    s_movk_i32 s46, 2560
    buffer_load_dwordx4 v9, s[8:11], s46 offen lds
    s_add_u32 m0, s66, 73728
    s_movk_i32 s46, 2560
    buffer_load_dwordx4 v10, s[8:11], s46 offen lds
    s_add_u32 m0, s67, 73728
    s_movk_i32 s46, 2560
    buffer_load_dwordx4 v11, s[8:11], s46 offen lds
    s_add_u32 m0, s68, 73728
    s_movk_i32 s46, 2560
    buffer_load_dwordx4 v12, s[8:11], s46 offen lds
    s_add_u32 m0, s69, 73728
    s_movk_i32 s46, 2560
    buffer_load_dwordx4 v13, s[12:15], s46 offen lds
    s_add_u32 m0, s70, 73728
    s_movk_i32 s46, 2560
    buffer_load_dwordx4 v14, s[12:15], s46 offen lds
    s_add_u32 m0, s71, 73728
    s_movk_i32 s46, 2560
    buffer_load_dwordx4 v15, s[12:15], s46 offen lds
    s_add_u32 m0, s72, 73728
    s_movk_i32 s46, 2560
    buffer_load_dwordx4 v16, s[12:15], s46 offen lds
    s_waitcnt vmcnt(18)
    s_barrier
    s_add_u32 m0, s64, 110592
    s_movk_i32 s46, 2816
    buffer_load_dwordx4 v8, s[8:11], s46 offen lds
    s_add_u32 m0, s65, 110592
    s_movk_i32 s46, 2816
    buffer_load_dwordx4 v9, s[8:11], s46 offen lds
    s_add_u32 m0, s66, 110592
    s_movk_i32 s46, 2816
    buffer_load_dwordx4 v10, s[8:11], s46 offen lds
    s_add_u32 m0, s67, 110592
    s_movk_i32 s46, 2816
    buffer_load_dwordx4 v11, s[8:11], s46 offen lds
    s_add_u32 m0, s68, 110592
    s_movk_i32 s46, 2816
    buffer_load_dwordx4 v12, s[8:11], s46 offen lds
    s_add_u32 m0, s69, 110592
    s_movk_i32 s46, 2816
    buffer_load_dwordx4 v13, s[12:15], s46 offen lds
    s_add_u32 m0, s70, 110592
    s_movk_i32 s46, 2816
    buffer_load_dwordx4 v14, s[12:15], s46 offen lds
    s_add_u32 m0, s71, 110592
    s_movk_i32 s46, 2816
    buffer_load_dwordx4 v15, s[12:15], s46 offen lds
    s_add_u32 m0, s72, 110592
    s_movk_i32 s46, 2816
    buffer_load_dwordx4 v16, s[12:15], s46 offen lds
    s_waitcnt vmcnt(18)
    s_barrier
    s_waitcnt vmcnt(9)
    s_barrier
    s_waitcnt vmcnt(0)
    s_barrier
    s_endpgm
gemmd_kernel_comp:
    s_and_b32 s42, s40, 1
    s_lshr_b32 s43, s40, 1
    v_lshrrev_b32 v4, 1, v2
    v_xor_b32 v4, v4, v3
    s_lshl_b32 s46, s43, 2
    v_xor_b32 v4, s46, v4
    v_and_b32 v5, 12, v2
    v_lshlrev_b32 v5, 1, v5
    v_and_b32 v6, 3, v2
    v_or_b32 v5, v5, v6
    v_xor_b32 v6, 0, v4
    v_lshlrev_b32 v6, 4, v6
    v_lshl_add_u32 v6, v5, 7, v6
    v_add_u32 v8, 0, v6
    v_add_u32 v10, 36864, v6
    v_add_u32 v12, 73728, v6
    v_add_u32 v14, 110592, v6
    v_xor_b32 v6, 0, v4
    v_lshlrev_b32 v6, 4, v6
    v_lshl_add_u32 v6, v2, 7, v6
    v_add_u32 v9, 0, v6
    v_add_u32 v11, 36864, v6
    v_add_u32 v13, 73728, v6
    v_add_u32 v15, 110592, v6
    s_lshl_b32 s46, s42, 12
    s_add_u32 s46, s46, 20480
    v_xor_b32 v6, 0, v4
    v_lshlrev_b32 v6, 4, v6
    v_lshl_add_u32 v6, v2, 7, v6
    v_add_u32 v6, s46, v6
    v_add_u32 v16, 0, v6
    v_add_u32 v17, 36864, v6
    v_add_u32 v18, 73728, v6
    v_add_u32 v19, 110592, v6
    v_lshlrev_b32 v4, 4, v3
    v_lshlrev_b32 v5, 3, v3
    buffer_load_dwordx4 v[120:123], v4, s[24:27], 0 offen
    buffer_load_dwordx4 v[124:127], v4, s[24:27], 0 offen offset:64
    buffer_load_dwordx2 v[128:129], v5, s[24:27], 0 offen offset:128
    s_lshl_b32 s46, s42, 5
    s_lshl_b32 s47, s43, 4
    s_add_u32 s46, s46, s47
    v_add_u32 v4, s46, v2
    s_movk_i32 s46, 1280
    v_mul_lo_u32 v4, v4, s46
    v_lshl_add_u32 v145, v3, 3, v4
    v_lshl_add_u32 v144, v3, 4, v4
    buffer_load_dwordx4 v[132:135], v144, s[20:23], 0 offen
    buffer_load_dwordx4 v[136:139], v144, s[20:23], 0 offen offset:64
    buffer_load_dwordx2 v[140:141], v145, s[20:23], 0 offen offset:128
    s_barrier
    ds_read_b128 v[44:47], v16 offset:0
    ds_read_b128 v[48:51], v16 offset:2048
    ds_read_b128 v[24:27], v8 offset:0
    ds_read_b128 v[28:31], v8 offset:512
    ds_read_b128 v[32:35], v8 offset:4096
    ds_read_b128 v[36:39], v8 offset:4608
    ds_read_b128 v[40:43], v9 offset:8192
    ds_read_b128 v[72:75], v16 offset:8192
    ds_read_b128 v[76:79], v16 offset:10240
    ds_read_b128 v[52:55], v8 offset:10240
    ds_read_b128 v[56:59], v8 offset:10752
    ds_read_b128 v[60:63], v8 offset:14336
    ds_read_b128 v[64:67], v8 offset:14848
    ds_read_b128 v[68:71], v9 offset:18432
    s_waitcnt lgkmcnt(7)
    v_mfma_f32_16x16x32_bf16 a[0:3], v[24:27], v[44:47], 0
    v_mfma_f32_16x16x32_bf16 a[4:7], v[24:27], v[48:51], 0
    v_mfma_f32_16x16x32_bf16 a[8:11], v[28:31], v[44:47], 0
    v_mfma_f32_16x16x32_bf16 a[12:15], v[28:31], v[48:51], 0
    v_mfma_f32_16x16x32_bf16 a[16:19], v[32:35], v[44:47], 0
    v_mfma_f32_16x16x32_bf16 a[20:23], v[32:35], v[48:51], 0
    v_mfma_f32_16x16x32_bf16 a[24:27], v[36:39], v[44:47], 0
    v_mfma_f32_16x16x32_bf16 a[28:31], v[36:39], v[48:51], 0
    v_mfma_f32_16x16x32_bf16 a[32:35], v[40:43], v[44:47], 0
    v_mfma_f32_16x16x32_bf16 a[36:39], v[40:43], v[48:51], 0
    s_waitcnt lgkmcnt(0)
    s_barrier
    ds_read_b128 v[44:47], v17 offset:0
    ds_read_b128 v[48:51], v17 offset:2048
    ds_read_b128 v[24:27], v10 offset:0
    ds_read_b128 v[28:31], v10 offset:512
    ds_read_b128 v[32:35], v10 offset:4096
    ds_read_b128 v[36:39], v10 offset:4608
    ds_read_b128 v[40:43], v11 offset:8192
    v_mfma_f32_16x16x32_bf16 a[0:3], v[52:55], v[72:75], a[0:3]
    v_mfma_f32_16x16x32_bf16 a[4:7], v[52:55], v[76:79], a[4:7]
    v_mfma_f32_16x16x32_bf16 a[8:11], v[56:59], v[72:75], a[8:11]
    v_mfma_f32_16x16x32_bf16 a[12:15], v[56:59], v[76:79], a[12:15]
    v_mfma_f32_16x16x32_bf16 a[16:19], v[60:63], v[72:75], a[16:19]
    v_mfma_f32_16x16x32_bf16 a[20:23], v[60:63], v[76:79], a[20:23]
    v_mfma_f32_16x16x32_bf16 a[24:27], v[64:67], v[72:75], a[24:27]
    v_mfma_f32_16x16x32_bf16 a[28:31], v[64:67], v[76:79], a[28:31]
    v_mfma_f32_16x16x32_bf16 a[32:35], v[68:71], v[72:75], a[32:35]
    v_mfma_f32_16x16x32_bf16 a[36:39], v[68:71], v[76:79], a[36:39]
    ds_read_b128 v[72:75], v17 offset:8192
    ds_read_b128 v[76:79], v17 offset:10240
    ds_read_b128 v[52:55], v10 offset:10240
    ds_read_b128 v[56:59], v10 offset:10752
    ds_read_b128 v[60:63], v10 offset:14336
    ds_read_b128 v[64:67], v10 offset:14848
    ds_read_b128 v[68:71], v11 offset:18432
    s_waitcnt lgkmcnt(7)
    v_mfma_f32_16x16x32_bf16 a[0:3], v[24:27], v[44:47], a[0:3]
    v_mfma_f32_16x16x32_bf16 a[4:7], v[24:27], v[48:51], a[4:7]
    v_mfma_f32_16x16x32_bf16 a[8:11], v[28:31], v[44:47], a[8:11]
    v_mfma_f32_16x16x32_bf16 a[12:15], v[28:31], v[48:51], a[12:15]
    v_mfma_f32_16x16x32_bf16 a[16:19], v[32:35], v[44:47], a[16:19]
    v_mfma_f32_16x16x32_bf16 a[20:23], v[32:35], v[48:51], a[20:23]
    v_mfma_f32_16x16x32_bf16 a[24:27], v[36:39], v[44:47], a[24:27]
    v_mfma_f32_16x16x32_bf16 a[28:31], v[36:39], v[48:51], a[28:31]
    v_mfma_f32_16x16x32_bf16 a[32:35], v[40:43], v[44:47], a[32:35]
    v_mfma_f32_16x16x32_bf16 a[36:39], v[40:43], v[48:51], a[36:39]
    s_waitcnt lgkmcnt(0)
    s_barrier
    ds_read_b128 v[44:47], v18 offset:0
    ds_read_b128 v[48:51], v18 offset:2048
    ds_read_b128 v[24:27], v12 offset:0
    ds_read_b128 v[28:31], v12 offset:512
    ds_read_b128 v[32:35], v12 offset:4096
    ds_read_b128 v[36:39], v12 offset:4608
    ds_read_b128 v[40:43], v13 offset:8192
    v_mfma_f32_16x16x32_bf16 a[0:3], v[52:55], v[72:75], a[0:3]
    v_mfma_f32_16x16x32_bf16 a[4:7], v[52:55], v[76:79], a[4:7]
    v_mfma_f32_16x16x32_bf16 a[8:11], v[56:59], v[72:75], a[8:11]
    v_mfma_f32_16x16x32_bf16 a[12:15], v[56:59], v[76:79], a[12:15]
    v_mfma_f32_16x16x32_bf16 a[16:19], v[60:63], v[72:75], a[16:19]
    v_mfma_f32_16x16x32_bf16 a[20:23], v[60:63], v[76:79], a[20:23]
    v_mfma_f32_16x16x32_bf16 a[24:27], v[64:67], v[72:75], a[24:27]
    v_mfma_f32_16x16x32_bf16 a[28:31], v[64:67], v[76:79], a[28:31]
    v_mfma_f32_16x16x32_bf16 a[32:35], v[68:71], v[72:75], a[32:35]
    v_mfma_f32_16x16x32_bf16 a[36:39], v[68:71], v[76:79], a[36:39]
    ds_read_b128 v[72:75], v18 offset:8192
    ds_read_b128 v[76:79], v18 offset:10240
    ds_read_b128 v[52:55], v12 offset:10240
    ds_read_b128 v[56:59], v12 offset:10752
    ds_read_b128 v[60:63], v12 offset:14336
    ds_read_b128 v[64:67], v12 offset:14848
    ds_read_b128 v[68:71], v13 offset:18432
    s_waitcnt lgkmcnt(7)
    v_mfma_f32_16x16x32_bf16 a[0:3], v[24:27], v[44:47], a[0:3]
    v_mfma_f32_16x16x32_bf16 a[4:7], v[24:27], v[48:51], a[4:7]
    v_mfma_f32_16x16x32_bf16 a[8:11], v[28:31], v[44:47], a[8:11]
    v_mfma_f32_16x16x32_bf16 a[12:15], v[28:31], v[48:51], a[12:15]
    v_mfma_f32_16x16x32_bf16 a[16:19], v[32:35], v[44:47], a[16:19]
    v_mfma_f32_16x16x32_bf16 a[20:23], v[32:35], v[48:51], a[20:23]
    v_mfma_f32_16x16x32_bf16 a[24:27], v[36:39], v[44:47], a[24:27]
    v_mfma_f32_16x16x32_bf16 a[28:31], v[36:39], v[48:51], a[28:31]
    v_mfma_f32_16x16x32_bf16 a[32:35], v[40:43], v[44:47], a[32:35]
    v_mfma_f32_16x16x32_bf16 a[36:39], v[40:43], v[48:51], a[36:39]
    s_waitcnt lgkmcnt(0)
    s_barrier
    ds_read_b128 v[44:47], v19 offset:0
    ds_read_b128 v[48:51], v19 offset:2048
    ds_read_b128 v[24:27], v14 offset:0
    ds_read_b128 v[28:31], v14 offset:512
    ds_read_b128 v[32:35], v14 offset:4096
    ds_read_b128 v[36:39], v14 offset:4608
    ds_read_b128 v[40:43], v15 offset:8192
    v_mfma_f32_16x16x32_bf16 a[0:3], v[52:55], v[72:75], a[0:3]
    v_mfma_f32_16x16x32_bf16 a[4:7], v[52:55], v[76:79], a[4:7]
    v_mfma_f32_16x16x32_bf16 a[8:11], v[56:59], v[72:75], a[8:11]
    v_mfma_f32_16x16x32_bf16 a[12:15], v[56:59], v[76:79], a[12:15]
    v_mfma_f32_16x16x32_bf16 a[16:19], v[60:63], v[72:75], a[16:19]
    v_mfma_f32_16x16x32_bf16 a[20:23], v[60:63], v[76:79], a[20:23]
    v_mfma_f32_16x16x32_bf16 a[24:27], v[64:67], v[72:75], a[24:27]
    v_mfma_f32_16x16x32_bf16 a[28:31], v[64:67], v[76:79], a[28:31]
    v_mfma_f32_16x16x32_bf16 a[32:35], v[68:71], v[72:75], a[32:35]
    v_mfma_f32_16x16x32_bf16 a[36:39], v[68:71], v[76:79], a[36:39]
    ds_read_b128 v[72:75], v19 offset:8192
    ds_read_b128 v[76:79], v19 offset:10240
    ds_read_b128 v[52:55], v14 offset:10240
    ds_read_b128 v[56:59], v14 offset:10752
    ds_read_b128 v[60:63], v14 offset:14336
    ds_read_b128 v[64:67], v14 offset:14848
    ds_read_b128 v[68:71], v15 offset:18432
    s_waitcnt lgkmcnt(7)
    v_mfma_f32_16x16x32_bf16 a[0:3], v[24:27], v[44:47], a[0:3]
    v_mfma_f32_16x16x32_bf16 a[4:7], v[24:27], v[48:51], a[4:7]
    v_mfma_f32_16x16x32_bf16 a[8:11], v[28:31], v[44:47], a[8:11]
    v_mfma_f32_16x16x32_bf16 a[12:15], v[28:31], v[48:51], a[12:15]
    v_mfma_f32_16x16x32_bf16 a[16:19], v[32:35], v[44:47], a[16:19]
    v_mfma_f32_16x16x32_bf16 a[20:23], v[32:35], v[48:51], a[20:23]
    v_mfma_f32_16x16x32_bf16 a[24:27], v[36:39], v[44:47], a[24:27]
    v_mfma_f32_16x16x32_bf16 a[28:31], v[36:39], v[48:51], a[28:31]
    v_mfma_f32_16x16x32_bf16 a[32:35], v[40:43], v[44:47], a[32:35]
    v_mfma_f32_16x16x32_bf16 a[36:39], v[40:43], v[48:51], a[36:39]
    s_waitcnt lgkmcnt(0)
    s_barrier
    ds_read_b128 v[44:47], v16 offset:0
    ds_read_b128 v[48:51], v16 offset:2048
    ds_read_b128 v[24:27], v8 offset:0
    ds_read_b128 v[28:31], v8 offset:512
    ds_read_b128 v[32:35], v8 offset:4096
    ds_read_b128 v[36:39], v8 offset:4608
    ds_read_b128 v[40:43], v9 offset:8192
    v_mfma_f32_16x16x32_bf16 a[0:3], v[52:55], v[72:75], a[0:3]
    v_mfma_f32_16x16x32_bf16 a[4:7], v[52:55], v[76:79], a[4:7]
    v_mfma_f32_16x16x32_bf16 a[8:11], v[56:59], v[72:75], a[8:11]
    v_mfma_f32_16x16x32_bf16 a[12:15], v[56:59], v[76:79], a[12:15]
    v_mfma_f32_16x16x32_bf16 a[16:19], v[60:63], v[72:75], a[16:19]
    v_mfma_f32_16x16x32_bf16 a[20:23], v[60:63], v[76:79], a[20:23]
    v_mfma_f32_16x16x32_bf16 a[24:27], v[64:67], v[72:75], a[24:27]
    v_mfma_f32_16x16x32_bf16 a[28:31], v[64:67], v[76:79], a[28:31]
    v_mfma_f32_16x16x32_bf16 a[32:35], v[68:71], v[72:75], a[32:35]
    v_mfma_f32_16x16x32_bf16 a[36:39], v[68:71], v[76:79], a[36:39]
    ds_read_b128 v[72:75], v16 offset:8192
    ds_read_b128 v[76:79], v16 offset:10240
    ds_read_b128 v[52:55], v8 offset:10240
    ds_read_b128 v[56:59], v8 offset:10752
    ds_read_b128 v[60:63], v8 offset:14336
    ds_read_b128 v[64:67], v8 offset:14848
    ds_read_b128 v[68:71], v9 offset:18432
    s_waitcnt lgkmcnt(7)
    v_mfma_f32_16x16x32_bf16 a[0:3], v[24:27], v[44:47], a[0:3]
    v_mfma_f32_16x16x32_bf16 a[4:7], v[24:27], v[48:51], a[4:7]
    v_mfma_f32_16x16x32_bf16 a[8:11], v[28:31], v[44:47], a[8:11]
    v_mfma_f32_16x16x32_bf16 a[12:15], v[28:31], v[48:51], a[12:15]
    v_mfma_f32_16x16x32_bf16 a[16:19], v[32:35], v[44:47], a[16:19]
    v_mfma_f32_16x16x32_bf16 a[20:23], v[32:35], v[48:51], a[20:23]
    v_mfma_f32_16x16x32_bf16 a[24:27], v[36:39], v[44:47], a[24:27]
    v_mfma_f32_16x16x32_bf16 a[28:31], v[36:39], v[48:51], a[28:31]
    v_mfma_f32_16x16x32_bf16 a[32:35], v[40:43], v[44:47], a[32:35]
    v_mfma_f32_16x16x32_bf16 a[36:39], v[40:43], v[48:51], a[36:39]
    s_waitcnt lgkmcnt(0)
    s_barrier
    ds_read_b128 v[44:47], v17 offset:0
    ds_read_b128 v[48:51], v17 offset:2048
    ds_read_b128 v[24:27], v10 offset:0
    ds_read_b128 v[28:31], v10 offset:512
    ds_read_b128 v[32:35], v10 offset:4096
    ds_read_b128 v[36:39], v10 offset:4608
    ds_read_b128 v[40:43], v11 offset:8192
    v_mfma_f32_16x16x32_bf16 a[0:3], v[52:55], v[72:75], a[0:3]
    v_mfma_f32_16x16x32_bf16 a[4:7], v[52:55], v[76:79], a[4:7]
    v_mfma_f32_16x16x32_bf16 a[8:11], v[56:59], v[72:75], a[8:11]
    v_mfma_f32_16x16x32_bf16 a[12:15], v[56:59], v[76:79], a[12:15]
    v_mfma_f32_16x16x32_bf16 a[16:19], v[60:63], v[72:75], a[16:19]
    v_mfma_f32_16x16x32_bf16 a[20:23], v[60:63], v[76:79], a[20:23]
    v_mfma_f32_16x16x32_bf16 a[24:27], v[64:67], v[72:75], a[24:27]
    v_mfma_f32_16x16x32_bf16 a[28:31], v[64:67], v[76:79], a[28:31]
    v_mfma_f32_16x16x32_bf16 a[32:35], v[68:71], v[72:75], a[32:35]
    v_mfma_f32_16x16x32_bf16 a[36:39], v[68:71], v[76:79], a[36:39]
    ds_read_b128 v[72:75], v17 offset:8192
    ds_read_b128 v[76:79], v17 offset:10240
    ds_read_b128 v[52:55], v10 offset:10240
    ds_read_b128 v[56:59], v10 offset:10752
    ds_read_b128 v[60:63], v10 offset:14336
    ds_read_b128 v[64:67], v10 offset:14848
    ds_read_b128 v[68:71], v11 offset:18432
    s_waitcnt lgkmcnt(7)
    v_mfma_f32_16x16x32_bf16 a[0:3], v[24:27], v[44:47], a[0:3]
    v_mfma_f32_16x16x32_bf16 a[4:7], v[24:27], v[48:51], a[4:7]
    v_mfma_f32_16x16x32_bf16 a[8:11], v[28:31], v[44:47], a[8:11]
    v_mfma_f32_16x16x32_bf16 a[12:15], v[28:31], v[48:51], a[12:15]
    v_mfma_f32_16x16x32_bf16 a[16:19], v[32:35], v[44:47], a[16:19]
    v_mfma_f32_16x16x32_bf16 a[20:23], v[32:35], v[48:51], a[20:23]
    v_mfma_f32_16x16x32_bf16 a[24:27], v[36:39], v[44:47], a[24:27]
    v_mfma_f32_16x16x32_bf16 a[28:31], v[36:39], v[48:51], a[28:31]
    v_mfma_f32_16x16x32_bf16 a[32:35], v[40:43], v[44:47], a[32:35]
    v_mfma_f32_16x16x32_bf16 a[36:39], v[40:43], v[48:51], a[36:39]
    s_waitcnt lgkmcnt(0)
    s_barrier
    ds_read_b128 v[44:47], v18 offset:0
    ds_read_b128 v[48:51], v18 offset:2048
    ds_read_b128 v[24:27], v12 offset:0
    ds_read_b128 v[28:31], v12 offset:512
    ds_read_b128 v[32:35], v12 offset:4096
    ds_read_b128 v[36:39], v12 offset:4608
    ds_read_b128 v[40:43], v13 offset:8192
    v_mfma_f32_16x16x32_bf16 a[0:3], v[52:55], v[72:75], a[0:3]
    v_mfma_f32_16x16x32_bf16 a[4:7], v[52:55], v[76:79], a[4:7]
    v_mfma_f32_16x16x32_bf16 a[8:11], v[56:59], v[72:75], a[8:11]
    v_mfma_f32_16x16x32_bf16 a[12:15], v[56:59], v[76:79], a[12:15]
    v_mfma_f32_16x16x32_bf16 a[16:19], v[60:63], v[72:75], a[16:19]
    v_mfma_f32_16x16x32_bf16 a[20:23], v[60:63], v[76:79], a[20:23]
    v_mfma_f32_16x16x32_bf16 a[24:27], v[64:67], v[72:75], a[24:27]
    v_mfma_f32_16x16x32_bf16 a[28:31], v[64:67], v[76:79], a[28:31]
    v_mfma_f32_16x16x32_bf16 a[32:35], v[68:71], v[72:75], a[32:35]
    v_mfma_f32_16x16x32_bf16 a[36:39], v[68:71], v[76:79], a[36:39]
    ds_read_b128 v[72:75], v18 offset:8192
    ds_read_b128 v[76:79], v18 offset:10240
    ds_read_b128 v[52:55], v12 offset:10240
    ds_read_b128 v[56:59], v12 offset:10752
    ds_read_b128 v[60:63], v12 offset:14336
    ds_read_b128 v[64:67], v12 offset:14848
    ds_read_b128 v[68:71], v13 offset:18432
    s_waitcnt lgkmcnt(7)
    v_mfma_f32_16x16x32_bf16 a[0:3], v[24:27], v[44:47], a[0:3]
    v_mfma_f32_16x16x32_bf16 a[4:7], v[24:27], v[48:51], a[4:7]
    v_mfma_f32_16x16x32_bf16 a[8:11], v[28:31], v[44:47], a[8:11]
    v_mfma_f32_16x16x32_bf16 a[12:15], v[28:31], v[48:51], a[12:15]
    v_mfma_f32_16x16x32_bf16 a[16:19], v[32:35], v[44:47], a[16:19]
    v_mfma_f32_16x16x32_bf16 a[20:23], v[32:35], v[48:51], a[20:23]
    v_mfma_f32_16x16x32_bf16 a[24:27], v[36:39], v[44:47], a[24:27]
    v_mfma_f32_16x16x32_bf16 a[28:31], v[36:39], v[48:51], a[28:31]
    v_mfma_f32_16x16x32_bf16 a[32:35], v[40:43], v[44:47], a[32:35]
    v_mfma_f32_16x16x32_bf16 a[36:39], v[40:43], v[48:51], a[36:39]
    s_waitcnt lgkmcnt(0)
    s_barrier
    ds_read_b128 v[44:47], v19 offset:0
    ds_read_b128 v[48:51], v19 offset:2048
    ds_read_b128 v[24:27], v14 offset:0
    ds_read_b128 v[28:31], v14 offset:512
    ds_read_b128 v[32:35], v14 offset:4096
    ds_read_b128 v[36:39], v14 offset:4608
    ds_read_b128 v[40:43], v15 offset:8192
    v_mfma_f32_16x16x32_bf16 a[0:3], v[52:55], v[72:75], a[0:3]
    v_mfma_f32_16x16x32_bf16 a[4:7], v[52:55], v[76:79], a[4:7]
    v_mfma_f32_16x16x32_bf16 a[8:11], v[56:59], v[72:75], a[8:11]
    v_mfma_f32_16x16x32_bf16 a[12:15], v[56:59], v[76:79], a[12:15]
    v_mfma_f32_16x16x32_bf16 a[16:19], v[60:63], v[72:75], a[16:19]
    v_mfma_f32_16x16x32_bf16 a[20:23], v[60:63], v[76:79], a[20:23]
    v_mfma_f32_16x16x32_bf16 a[24:27], v[64:67], v[72:75], a[24:27]
    v_mfma_f32_16x16x32_bf16 a[28:31], v[64:67], v[76:79], a[28:31]
    v_mfma_f32_16x16x32_bf16 a[32:35], v[68:71], v[72:75], a[32:35]
    v_mfma_f32_16x16x32_bf16 a[36:39], v[68:71], v[76:79], a[36:39]
    ds_read_b128 v[72:75], v19 offset:8192
    ds_read_b128 v[76:79], v19 offset:10240
    ds_read_b128 v[52:55], v14 offset:10240
    ds_read_b128 v[56:59], v14 offset:10752
    ds_read_b128 v[60:63], v14 offset:14336
    ds_read_b128 v[64:67], v14 offset:14848
    ds_read_b128 v[68:71], v15 offset:18432
    s_waitcnt lgkmcnt(7)
    v_mfma_f32_16x16x32_bf16 a[0:3], v[24:27], v[44:47], a[0:3]
    v_mfma_f32_16x16x32_bf16 a[4:7], v[24:27], v[48:51], a[4:7]
    v_mfma_f32_16x16x32_bf16 a[8:11], v[28:31], v[44:47], a[8:11]
    v_mfma_f32_16x16x32_bf16 a[12:15], v[28:31], v[48:51], a[12:15]
    v_mfma_f32_16x16x32_bf16 a[16:19], v[32:35], v[44:47], a[16:19]
    v_mfma_f32_16x16x32_bf16 a[20:23], v[32:35], v[48:51], a[20:23]
    v_mfma_f32_16x16x32_bf16 a[24:27], v[36:39], v[44:47], a[24:27]
    v_mfma_f32_16x16x32_bf16 a[28:31], v[36:39], v[48:51], a[28:31]
    v_mfma_f32_16x16x32_bf16 a[32:35], v[40:43], v[44:47], a[32:35]
    v_mfma_f32_16x16x32_bf16 a[36:39], v[40:43], v[48:51], a[36:39]
    s_waitcnt lgkmcnt(0)
    s_barrier
    ds_read_b128 v[44:47], v16 offset:0
    ds_read_b128 v[48:51], v16 offset:2048
    ds_read_b128 v[24:27], v8 offset:0
    ds_read_b128 v[28:31], v8 offset:512
    ds_read_b128 v[32:35], v8 offset:4096
    ds_read_b128 v[36:39], v8 offset:4608
    ds_read_b128 v[40:43], v9 offset:8192
    v_mfma_f32_16x16x32_bf16 a[0:3], v[52:55], v[72:75], a[0:3]
    v_mfma_f32_16x16x32_bf16 a[4:7], v[52:55], v[76:79], a[4:7]
    v_mfma_f32_16x16x32_bf16 a[8:11], v[56:59], v[72:75], a[8:11]
    v_mfma_f32_16x16x32_bf16 a[12:15], v[56:59], v[76:79], a[12:15]
    v_mfma_f32_16x16x32_bf16 a[16:19], v[60:63], v[72:75], a[16:19]
    v_mfma_f32_16x16x32_bf16 a[20:23], v[60:63], v[76:79], a[20:23]
    v_mfma_f32_16x16x32_bf16 a[24:27], v[64:67], v[72:75], a[24:27]
    v_mfma_f32_16x16x32_bf16 a[28:31], v[64:67], v[76:79], a[28:31]
    v_mfma_f32_16x16x32_bf16 a[32:35], v[68:71], v[72:75], a[32:35]
    v_mfma_f32_16x16x32_bf16 a[36:39], v[68:71], v[76:79], a[36:39]
    ds_read_b128 v[72:75], v16 offset:8192
    ds_read_b128 v[76:79], v16 offset:10240
    ds_read_b128 v[52:55], v8 offset:10240
    ds_read_b128 v[56:59], v8 offset:10752
    ds_read_b128 v[60:63], v8 offset:14336
    ds_read_b128 v[64:67], v8 offset:14848
    ds_read_b128 v[68:71], v9 offset:18432
    s_waitcnt lgkmcnt(7)
    v_mfma_f32_16x16x32_bf16 a[0:3], v[24:27], v[44:47], a[0:3]
    v_mfma_f32_16x16x32_bf16 a[4:7], v[24:27], v[48:51], a[4:7]
    v_mfma_f32_16x16x32_bf16 a[8:11], v[28:31], v[44:47], a[8:11]
    v_mfma_f32_16x16x32_bf16 a[12:15], v[28:31], v[48:51], a[12:15]
    v_mfma_f32_16x16x32_bf16 a[16:19], v[32:35], v[44:47], a[16:19]
    v_mfma_f32_16x16x32_bf16 a[20:23], v[32:35], v[48:51], a[20:23]
    v_mfma_f32_16x16x32_bf16 a[24:27], v[36:39], v[44:47], a[24:27]
    v_mfma_f32_16x16x32_bf16 a[28:31], v[36:39], v[48:51], a[28:31]
    v_mfma_f32_16x16x32_bf16 a[32:35], v[40:43], v[44:47], a[32:35]
    v_mfma_f32_16x16x32_bf16 a[36:39], v[40:43], v[48:51], a[36:39]
    s_waitcnt lgkmcnt(0)
    s_barrier
    ds_read_b128 v[44:47], v17 offset:0
    ds_read_b128 v[48:51], v17 offset:2048
    ds_read_b128 v[24:27], v10 offset:0
    ds_read_b128 v[28:31], v10 offset:512
    ds_read_b128 v[32:35], v10 offset:4096
    ds_read_b128 v[36:39], v10 offset:4608
    ds_read_b128 v[40:43], v11 offset:8192
    v_mfma_f32_16x16x32_bf16 a[0:3], v[52:55], v[72:75], a[0:3]
    v_mfma_f32_16x16x32_bf16 a[4:7], v[52:55], v[76:79], a[4:7]
    v_mfma_f32_16x16x32_bf16 a[8:11], v[56:59], v[72:75], a[8:11]
    v_mfma_f32_16x16x32_bf16 a[12:15], v[56:59], v[76:79], a[12:15]
    v_mfma_f32_16x16x32_bf16 a[16:19], v[60:63], v[72:75], a[16:19]
    v_mfma_f32_16x16x32_bf16 a[20:23], v[60:63], v[76:79], a[20:23]
    v_mfma_f32_16x16x32_bf16 a[24:27], v[64:67], v[72:75], a[24:27]
    v_mfma_f32_16x16x32_bf16 a[28:31], v[64:67], v[76:79], a[28:31]
    v_mfma_f32_16x16x32_bf16 a[32:35], v[68:71], v[72:75], a[32:35]
    v_mfma_f32_16x16x32_bf16 a[36:39], v[68:71], v[76:79], a[36:39]
    ds_read_b128 v[72:75], v17 offset:8192
    ds_read_b128 v[76:79], v17 offset:10240
    ds_read_b128 v[52:55], v10 offset:10240
    ds_read_b128 v[56:59], v10 offset:10752
    ds_read_b128 v[60:63], v10 offset:14336
    ds_read_b128 v[64:67], v10 offset:14848
    ds_read_b128 v[68:71], v11 offset:18432
    s_waitcnt lgkmcnt(7)
    v_mfma_f32_16x16x32_bf16 a[0:3], v[24:27], v[44:47], a[0:3]
    v_mfma_f32_16x16x32_bf16 a[4:7], v[24:27], v[48:51], a[4:7]
    v_mfma_f32_16x16x32_bf16 a[8:11], v[28:31], v[44:47], a[8:11]
    v_mfma_f32_16x16x32_bf16 a[12:15], v[28:31], v[48:51], a[12:15]
    v_mfma_f32_16x16x32_bf16 a[16:19], v[32:35], v[44:47], a[16:19]
    v_mfma_f32_16x16x32_bf16 a[20:23], v[32:35], v[48:51], a[20:23]
    v_mfma_f32_16x16x32_bf16 a[24:27], v[36:39], v[44:47], a[24:27]
    v_mfma_f32_16x16x32_bf16 a[28:31], v[36:39], v[48:51], a[28:31]
    v_mfma_f32_16x16x32_bf16 a[32:35], v[40:43], v[44:47], a[32:35]
    v_mfma_f32_16x16x32_bf16 a[36:39], v[40:43], v[48:51], a[36:39]
    s_waitcnt lgkmcnt(0)
    s_barrier
    ds_read_b128 v[44:47], v18 offset:0
    ds_read_b128 v[48:51], v18 offset:2048
    ds_read_b128 v[24:27], v12 offset:0
    ds_read_b128 v[28:31], v12 offset:512
    ds_read_b128 v[32:35], v12 offset:4096
    ds_read_b128 v[36:39], v12 offset:4608
    ds_read_b128 v[40:43], v13 offset:8192
    v_mfma_f32_16x16x32_bf16 a[0:3], v[52:55], v[72:75], a[0:3]
    v_mfma_f32_16x16x32_bf16 a[4:7], v[52:55], v[76:79], a[4:7]
    v_mfma_f32_16x16x32_bf16 a[8:11], v[56:59], v[72:75], a[8:11]
    v_mfma_f32_16x16x32_bf16 a[12:15], v[56:59], v[76:79], a[12:15]
    v_mfma_f32_16x16x32_bf16 a[16:19], v[60:63], v[72:75], a[16:19]
    v_mfma_f32_16x16x32_bf16 a[20:23], v[60:63], v[76:79], a[20:23]
    v_mfma_f32_16x16x32_bf16 a[24:27], v[64:67], v[72:75], a[24:27]
    v_mfma_f32_16x16x32_bf16 a[28:31], v[64:67], v[76:79], a[28:31]
    v_mfma_f32_16x16x32_bf16 a[32:35], v[68:71], v[72:75], a[32:35]
    v_mfma_f32_16x16x32_bf16 a[36:39], v[68:71], v[76:79], a[36:39]
    ds_read_b128 v[72:75], v18 offset:8192
    ds_read_b128 v[76:79], v18 offset:10240
    ds_read_b128 v[52:55], v12 offset:10240
    ds_read_b128 v[56:59], v12 offset:10752
    ds_read_b128 v[60:63], v12 offset:14336
    ds_read_b128 v[64:67], v12 offset:14848
    ds_read_b128 v[68:71], v13 offset:18432
    s_waitcnt lgkmcnt(7)
    v_mfma_f32_16x16x32_bf16 a[0:3], v[24:27], v[44:47], a[0:3]
    v_mfma_f32_16x16x32_bf16 a[4:7], v[24:27], v[48:51], a[4:7]
    v_mfma_f32_16x16x32_bf16 a[8:11], v[28:31], v[44:47], a[8:11]
    v_mfma_f32_16x16x32_bf16 a[12:15], v[28:31], v[48:51], a[12:15]
    v_mfma_f32_16x16x32_bf16 a[16:19], v[32:35], v[44:47], a[16:19]
    v_mfma_f32_16x16x32_bf16 a[20:23], v[32:35], v[48:51], a[20:23]
    v_mfma_f32_16x16x32_bf16 a[24:27], v[36:39], v[44:47], a[24:27]
    v_mfma_f32_16x16x32_bf16 a[28:31], v[36:39], v[48:51], a[28:31]
    v_mfma_f32_16x16x32_bf16 a[32:35], v[40:43], v[44:47], a[32:35]
    v_mfma_f32_16x16x32_bf16 a[36:39], v[40:43], v[48:51], a[36:39]
    s_waitcnt lgkmcnt(0)
    s_barrier
    ds_read_b128 v[44:47], v19 offset:0
    ds_read_b128 v[48:51], v19 offset:2048
    ds_read_b128 v[24:27], v14 offset:0
    ds_read_b128 v[28:31], v14 offset:512
    ds_read_b128 v[32:35], v14 offset:4096
    ds_read_b128 v[36:39], v14 offset:4608
    ds_read_b128 v[40:43], v15 offset:8192
    v_mfma_f32_16x16x32_bf16 a[0:3], v[52:55], v[72:75], a[0:3]
    v_mfma_f32_16x16x32_bf16 a[4:7], v[52:55], v[76:79], a[4:7]
    v_mfma_f32_16x16x32_bf16 a[8:11], v[56:59], v[72:75], a[8:11]
    v_mfma_f32_16x16x32_bf16 a[12:15], v[56:59], v[76:79], a[12:15]
    v_mfma_f32_16x16x32_bf16 a[16:19], v[60:63], v[72:75], a[16:19]
    v_mfma_f32_16x16x32_bf16 a[20:23], v[60:63], v[76:79], a[20:23]
    v_mfma_f32_16x16x32_bf16 a[24:27], v[64:67], v[72:75], a[24:27]
    v_mfma_f32_16x16x32_bf16 a[28:31], v[64:67], v[76:79], a[28:31]
    v_mfma_f32_16x16x32_bf16 a[32:35], v[68:71], v[72:75], a[32:35]
    v_mfma_f32_16x16x32_bf16 a[36:39], v[68:71], v[76:79], a[36:39]
    ds_read_b128 v[72:75], v19 offset:8192
    ds_read_b128 v[76:79], v19 offset:10240
    ds_read_b128 v[52:55], v14 offset:10240
    ds_read_b128 v[56:59], v14 offset:10752
    ds_read_b128 v[60:63], v14 offset:14336
    ds_read_b128 v[64:67], v14 offset:14848
    ds_read_b128 v[68:71], v15 offset:18432
    s_waitcnt lgkmcnt(7)
    v_mfma_f32_16x16x32_bf16 a[0:3], v[24:27], v[44:47], a[0:3]
    v_mfma_f32_16x16x32_bf16 a[4:7], v[24:27], v[48:51], a[4:7]
    v_mfma_f32_16x16x32_bf16 a[8:11], v[28:31], v[44:47], a[8:11]
    v_mfma_f32_16x16x32_bf16 a[12:15], v[28:31], v[48:51], a[12:15]
    v_mfma_f32_16x16x32_bf16 a[16:19], v[32:35], v[44:47], a[16:19]
    v_mfma_f32_16x16x32_bf16 a[20:23], v[32:35], v[48:51], a[20:23]
    v_mfma_f32_16x16x32_bf16 a[24:27], v[36:39], v[44:47], a[24:27]
    v_mfma_f32_16x16x32_bf16 a[28:31], v[36:39], v[48:51], a[28:31]
    v_mfma_f32_16x16x32_bf16 a[32:35], v[40:43], v[44:47], a[32:35]
    v_mfma_f32_16x16x32_bf16 a[36:39], v[40:43], v[48:51], a[36:39]
    s_waitcnt lgkmcnt(0)
    v_mfma_f32_16x16x32_bf16 a[0:3], v[52:55], v[72:75], a[0:3]
    v_mfma_f32_16x16x32_bf16 a[4:7], v[52:55], v[76:79], a[4:7]
    v_mfma_f32_16x16x32_bf16 a[8:11], v[56:59], v[72:75], a[8:11]
    v_mfma_f32_16x16x32_bf16 a[12:15], v[56:59], v[76:79], a[12:15]
    v_mfma_f32_16x16x32_bf16 a[16:19], v[60:63], v[72:75], a[16:19]
    v_mfma_f32_16x16x32_bf16 a[20:23], v[60:63], v[76:79], a[20:23]
    v_mfma_f32_16x16x32_bf16 a[24:27], v[64:67], v[72:75], a[24:27]
    v_mfma_f32_16x16x32_bf16 a[28:31], v[64:67], v[76:79], a[28:31]
    v_mfma_f32_16x16x32_bf16 a[32:35], v[68:71], v[72:75], a[32:35]
    v_mfma_f32_16x16x32_bf16 a[36:39], v[68:71], v[76:79], a[36:39]
    s_nop 7
    s_nop 7
    s_barrier
    v_lshlrev_b32 v4, 4, v1
    s_mul_i32 s46, s40, 5120
    v_add_u32 v5, s46, v4
    s_xor_b32 s47, s40, 2
    s_mul_i32 s46, s47, 5120
    v_add_u32 v4, s46, v4
    s_cmp_eq_u32 s43, 0
    s_cbranch_scc1 gemmd_kernel_k0
    ds_write_b128 v5, a[0:3] offset:0
    ds_write_b128 v5, a[8:11] offset:1024
    ds_write_b128 v5, a[16:19] offset:2048
    ds_write_b128 v5, a[24:27] offset:3072
    ds_write_b128 v5, a[32:35] offset:4096
    v_accvgpr_read_b32 v80, a4
    v_accvgpr_read_b32 v81, a5
    v_accvgpr_read_b32 v82, a6
    v_accvgpr_read_b32 v83, a7
    v_accvgpr_read_b32 v84, a12
    v_accvgpr_read_b32 v85, a13
    v_accvgpr_read_b32 v86, a14
    v_accvgpr_read_b32 v87, a15
    v_accvgpr_read_b32 v88, a20
    v_accvgpr_read_b32 v89, a21
    v_accvgpr_read_b32 v90, a22
    v_accvgpr_read_b32 v91, a23
    v_accvgpr_read_b32 v92, a28
    v_accvgpr_read_b32 v93, a29
    v_accvgpr_read_b32 v94, a30
    v_accvgpr_read_b32 v95, a31
    v_accvgpr_read_b32 v96, a36
    v_accvgpr_read_b32 v97, a37
    v_accvgpr_read_b32 v98, a38
    v_accvgpr_read_b32 v99, a39
    s_branch gemmd_kernel_k1
gemmd_kernel_k0:
    ds_write_b128 v5, a[4:7] offset:0
    ds_write_b128 v5, a[12:15] offset:1024
    ds_write_b128 v5, a[20:23] offset:2048
    ds_write_b128 v5, a[28:31] offset:3072
    ds_write_b128 v5, a[36:39] offset:4096
    v_accvgpr_read_b32 v80, a0
    v_accvgpr_read_b32 v81, a1
    v_accvgpr_read_b32 v82, a2
    v_accvgpr_read_b32 v83, a3
    v_accvgpr_read_b32 v84, a8
    v_accvgpr_read_b32 v85, a9
    v_accvgpr_read_b32 v86, a10
    v_accvgpr_read_b32 v87, a11
    v_accvgpr_read_b32 v88, a16
    v_accvgpr_read_b32 v89, a17
    v_accvgpr_read_b32 v90, a18
    v_accvgpr_read_b32 v91, a19
    v_accvgpr_read_b32 v92, a24
    v_accvgpr_read_b32 v93, a25
    v_accvgpr_read_b32 v94, a26
    v_accvgpr_read_b32 v95, a27
    v_accvgpr_read_b32 v96, a32
    v_accvgpr_read_b32 v97, a33
    v_accvgpr_read_b32 v98, a34
    v_accvgpr_read_b32 v99, a35
gemmd_kernel_k1:
    s_waitcnt lgkmcnt(0)
    s_barrier
    ds_read_b128 v[24:27], v4 offset:0
    ds_read_b128 v[28:31], v4 offset:1024
    ds_read_b128 v[32:35], v4 offset:2048
    ds_read_b128 v[36:39], v4 offset:3072
    ds_read_b128 v[40:43], v4 offset:4096
    s_waitcnt lgkmcnt(0)
    v_add_f32 v80, v80, v24
    v_add_f32 v81, v81, v25
    v_add_f32 v82, v82, v26
    v_add_f32 v83, v83, v27
    v_add_f32 v84, v84, v28
    v_add_f32 v85, v85, v29
    v_add_f32 v86, v86, v30
    v_add_f32 v87, v87, v31
    v_add_f32 v88, v88, v32
    v_add_f32 v89, v89, v33
    v_add_f32 v90, v90, v34
    v_add_f32 v91, v91, v35
    v_add_f32 v92, v92, v36
    v_add_f32 v93, v93, v37
    v_add_f32 v94, v94, v38
    v_add_f32 v95, v95, v39
    v_add_f32 v96, v96, v40
    v_add_f32 v97, v97, v41
    v_add_f32 v98, v98, v42
    v_add_f32 v99, v99, v43
    s_waitcnt vmcnt(0)
    v_cvt_pk_bf16_f32 v24, v80, v81
    v_lshlrev_b32 v48, 16, v24
    v_and_b32 v49, 0xffff0000, v24
    v_lshlrev_b32 v50, 16, v120
    v_and_b32 v51, 0xffff0000, v120
    v_mul_f32 v48, v48, v50
    v_mul_f32 v49, v49, v51
    v_cvt_pk_bf16_f32 v52, v48, v49
    v_lshlrev_b32 v48, 16, v52
    v_and_b32 v49, 0xffff0000, v52
    v_lshlrev_b32 v50, 16, v132
    v_and_b32 v51, 0xffff0000, v132
    v_add_f32 v48, v48, v50
    v_add_f32 v49, v49, v51
    v_cvt_pk_bf16_f32 v24, v48, v49
    v_cvt_pk_bf16_f32 v25, v82, v83
    v_lshlrev_b32 v48, 16, v25
    v_and_b32 v49, 0xffff0000, v25
    v_lshlrev_b32 v50, 16, v121
    v_and_b32 v51, 0xffff0000, v121
    v_mul_f32 v48, v48, v50
    v_mul_f32 v49, v49, v51
    v_cvt_pk_bf16_f32 v52, v48, v49
    v_lshlrev_b32 v48, 16, v52
    v_and_b32 v49, 0xffff0000, v52
    v_lshlrev_b32 v50, 16, v133
    v_and_b32 v51, 0xffff0000, v133
    v_add_f32 v48, v48, v50
    v_add_f32 v49, v49, v51
    v_cvt_pk_bf16_f32 v25, v48, v49
    v_cvt_pk_bf16_f32 v26, v84, v85
    v_lshlrev_b32 v48, 16, v26
    v_and_b32 v49, 0xffff0000, v26
    v_lshlrev_b32 v50, 16, v122
    v_and_b32 v51, 0xffff0000, v122
    v_mul_f32 v48, v48, v50
    v_mul_f32 v49, v49, v51
    v_cvt_pk_bf16_f32 v52, v48, v49
    v_lshlrev_b32 v48, 16, v52
    v_and_b32 v49, 0xffff0000, v52
    v_lshlrev_b32 v50, 16, v134
    v_and_b32 v51, 0xffff0000, v134
    v_add_f32 v48, v48, v50
    v_add_f32 v49, v49, v51
    v_cvt_pk_bf16_f32 v26, v48, v49
    v_cvt_pk_bf16_f32 v27, v86, v87
    v_lshlrev_b32 v48, 16, v27
    v_and_b32 v49, 0xffff0000, v27
    v_lshlrev_b32 v50, 16, v123
    v_and_b32 v51, 0xffff0000, v123
    v_mul_f32 v48, v48, v50
    v_mul_f32 v49, v49, v51
    v_cvt_pk_bf16_f32 v52, v48, v49
    v_lshlrev_b32 v48, 16, v52
    v_and_b32 v49, 0xffff0000, v52
    v_lshlrev_b32 v50, 16, v135
    v_and_b32 v51, 0xffff0000, v135
    v_add_f32 v48, v48, v50
    v_add_f32 v49, v49, v51
    v_cvt_pk_bf16_f32 v27, v48, v49
    buffer_store_dwordx4 v[24:27], v144, s[16:19], 0 offen offset:0
    v_cvt_pk_bf16_f32 v28, v88, v89
    v_lshlrev_b32 v48, 16, v28
    v_and_b32 v49, 0xffff0000, v28
    v_lshlrev_b32 v50, 16, v124
    v_and_b32 v51, 0xffff0000, v124
    v_mul_f32 v48, v48, v50
    v_mul_f32 v49, v49, v51
    v_cvt_pk_bf16_f32 v52, v48, v49
    v_lshlrev_b32 v48, 16, v52
    v_and_b32 v49, 0xffff0000, v52
    v_lshlrev_b32 v50, 16, v136
    v_and_b32 v51, 0xffff0000, v136
    v_add_f32 v48, v48, v50
    v_add_f32 v49, v49, v51
    v_cvt_pk_bf16_f32 v28, v48, v49
    v_cvt_pk_bf16_f32 v29, v90, v91
    v_lshlrev_b32 v48, 16, v29
    v_and_b32 v49, 0xffff0000, v29
    v_lshlrev_b32 v50, 16, v125
    v_and_b32 v51, 0xffff0000, v125
    v_mul_f32 v48, v48, v50
    v_mul_f32 v49, v49, v51
    v_cvt_pk_bf16_f32 v52, v48, v49
    v_lshlrev_b32 v48, 16, v52
    v_and_b32 v49, 0xffff0000, v52
    v_lshlrev_b32 v50, 16, v137
    v_and_b32 v51, 0xffff0000, v137
    v_add_f32 v48, v48, v50
    v_add_f32 v49, v49, v51
    v_cvt_pk_bf16_f32 v29, v48, v49
    v_cvt_pk_bf16_f32 v30, v92, v93
    v_lshlrev_b32 v48, 16, v30
    v_and_b32 v49, 0xffff0000, v30
    v_lshlrev_b32 v50, 16, v126
    v_and_b32 v51, 0xffff0000, v126
    v_mul_f32 v48, v48, v50
    v_mul_f32 v49, v49, v51
    v_cvt_pk_bf16_f32 v52, v48, v49
    v_lshlrev_b32 v48, 16, v52
    v_and_b32 v49, 0xffff0000, v52
    v_lshlrev_b32 v50, 16, v138
    v_and_b32 v51, 0xffff0000, v138
    v_add_f32 v48, v48, v50
    v_add_f32 v49, v49, v51
    v_cvt_pk_bf16_f32 v30, v48, v49
    v_cvt_pk_bf16_f32 v31, v94, v95
    v_lshlrev_b32 v48, 16, v31
    v_and_b32 v49, 0xffff0000, v31
    v_lshlrev_b32 v50, 16, v127
    v_and_b32 v51, 0xffff0000, v127
    v_mul_f32 v48, v48, v50
    v_mul_f32 v49, v49, v51
    v_cvt_pk_bf16_f32 v52, v48, v49
    v_lshlrev_b32 v48, 16, v52
    v_and_b32 v49, 0xffff0000, v52
    v_lshlrev_b32 v50, 16, v139
    v_and_b32 v51, 0xffff0000, v139
    v_add_f32 v48, v48, v50
    v_add_f32 v49, v49, v51
    v_cvt_pk_bf16_f32 v31, v48, v49
    buffer_store_dwordx4 v[28:31], v144, s[16:19], 0 offen offset:64
    v_cvt_pk_bf16_f32 v32, v96, v97
    v_lshlrev_b32 v48, 16, v32
    v_and_b32 v49, 0xffff0000, v32
    v_lshlrev_b32 v50, 16, v128
    v_and_b32 v51, 0xffff0000, v128
    v_mul_f32 v48, v48, v50
    v_mul_f32 v49, v49, v51
    v_cvt_pk_bf16_f32 v52, v48, v49
    v_lshlrev_b32 v48, 16, v52
    v_and_b32 v49, 0xffff0000, v52
    v_lshlrev_b32 v50, 16, v140
    v_and_b32 v51, 0xffff0000, v140
    v_add_f32 v48, v48, v50
    v_add_f32 v49, v49, v51
    v_cvt_pk_bf16_f32 v32, v48, v49
    v_cvt_pk_bf16_f32 v33, v98, v99
    v_lshlrev_b32 v48, 16, v33
    v_and_b32 v49, 0xffff0000, v33
    v_lshlrev_b32 v50, 16, v129
    v_and_b32 v51, 0xffff0000, v129
    v_mul_f32 v48, v48, v50
    v_mul_f32 v49, v49, v51
    v_cvt_pk_bf16_f32 v52, v48, v49
    v_lshlrev_b32 v48, 16, v52
    v_and_b32 v49, 0xffff0000, v52
    v_lshlrev_b32 v50, 16, v141
    v_and_b32 v51, 0xffff0000, v141
    v_add_f32 v48, v48, v50
    v_add_f32 v49, v49, v51
    v_cvt_pk_bf16_f32 v33, v48, v49
    buffer_store_dwordx2 v[32:33], v145, s[16:19], 0 offen offset:128
gemmd_kernel_end:
    s_endpgm
.p2align 4
code_end_label:
.section .rodata,"a"
.p2align 6
.amdhsa_kernel prep_kernel
  .amdhsa_next_free_vgpr 72
  .amdhsa_next_free_sgpr 40
  .amdhsa_accum_offset 72
  .amdhsa_group_segment_fixed_size 0
  .amdhsa_kernarg_size 104
  .amdhsa_user_sgpr_count 2
  .amdhsa_user_sgpr_kernarg_segment_ptr 1
  .amdhsa_system_sgpr_workgroup_id_x 1
  .amdhsa_float_denorm_mode_32 3
  .amdhsa_float_denorm_mode_16_64 3
.end_amdhsa_kernel
.p2align 6
.amdhsa_kernel gemma_kernel
  .amdhsa_next_free_vgpr 160
  .amdhsa_next_free_sgpr 64
  .amdhsa_accum_offset 120
  .amdhsa_group_segment_fixed_size 0
  .amdhsa_kernarg_size 104
  .amdhsa_user_sgpr_count 2
  .amdhsa_user_sgpr_kernarg_segment_ptr 1
  .amdhsa_system_sgpr_workgroup_id_x 1
  .amdhsa_float_denorm_mode_32 3
  .amdhsa_float_denorm_mode_16_64 3
.end_amdhsa_kernel
.p2align 6
.amdhsa_kernel gemmb_kernel
  .amdhsa_next_free_vgpr 200
  .amdhsa_next_free_sgpr 102
  .amdhsa_accum_offset 160
  .amdhsa_group_segment_fixed_size 0
  .amdhsa_kernarg_size 104
  .amdhsa_user_sgpr_count 2
  .amdhsa_user_sgpr_kernarg_segment_ptr 1
  .amdhsa_system_sgpr_workgroup_id_x 1
  .amdhsa_float_denorm_mode_32 3
  .amdhsa_float_denorm_mode_16_64 3
.end_amdhsa_kernel
.p2align 6
.amdhsa_kernel ln2_kernel
  .amdhsa_next_free_vgpr 152
  .amdhsa_next_free_sgpr 40
  .amdhsa_accum_offset 152
  .amdhsa_group_segment_fixed_size 0
  .amdhsa_kernarg_size 104
  .amdhsa_user_sgpr_count 2
  .amdhsa_user_sgpr_kernarg_segment_ptr 1
  .amdhsa_system_sgpr_workgroup_id_x 1
  .amdhsa_float_denorm_mode_32 3
  .amdhsa_float_denorm_mode_16_64 3
.end_amdhsa_kernel
.p2align 6
.amdhsa_kernel gemmc_kernel
  .amdhsa_next_free_vgpr 192
  .amdhsa_next_free_sgpr 102
  .amdhsa_accum_offset 144
  .amdhsa_group_segment_fixed_size 0
  .amdhsa_kernarg_size 104
  .amdhsa_user_sgpr_count 2
  .amdhsa_user_sgpr_kernarg_segment_ptr 1
  .amdhsa_system_sgpr_workgroup_id_x 1
  .amdhsa_float_denorm_mode_32 3
  .amdhsa_float_denorm_mode_16_64 3
.end_amdhsa_kernel
.p2align 6
.amdhsa_kernel gemmd_kernel
  .amdhsa_next_free_vgpr 192
  .amdhsa_next_free_sgpr 102
  .amdhsa_accum_offset 152
  .amdhsa_group_segment_fixed_size 0
  .amdhsa_kernarg_size 104
  .amdhsa_user_sgpr_count 2
  .amdhsa_user_sgpr_kernarg_segment_ptr 1
  .amdhsa_system_sgpr_workgroup_id_x 1
  .amdhsa_float_denorm_mode_32 3
  .amdhsa_float_denorm_mode_16_64 3
.end_amdhsa_kernel
```
